```python
import torch

def _softmax(x, axis=-1):
    return torch.softmax(x, dim=axis)
def _gelu(x):
    return torch.nn.functional.gelu(x, approximate="tanh")
def _silu(x):
    return torch.nn.functional.silu(x)
def _sigmoid(x):
    return torch.sigmoid(x)
def _layernorm(x, axis=-1, eps=1e-5):
    m = x.mean(dim=axis, keepdim=True)
    v = x.var(dim=axis, keepdim=True, unbiased=False)
    return (x - m) / torch.sqrt(v + eps)
def _scatter_add(tgt, idx, src, axis=0):
    return tgt.clone().index_add_(axis, idx, src)
def _segment_sum(src, seg, n):
    out = torch.zeros((n,) + src.shape[1:], dtype=src.dtype)
    return out.index_add_(0, seg, src)
def _pad(x, pw):
    flat = tuple(v for pair in reversed(pw) for v in pair)
    return torch.nn.functional.pad(x, flat)

kernel_name = 'parallel_sum__ssm_conv_s5__mixer_token_mlp__prompt'

def setup_inputs():

    _w = (lambda a: (lambda t: t.to(torch.bfloat16) if t.is_floating_point() else t)(torch.as_tensor(a)))
    def _A_setup():
        B, S, D = 1, 2048, 1024
        P = D
        Lambda_re = -0.5 * (lambda _x: torch.exp(torch.as_tensor(_x)))((lambda *s: torch.randn(*s, dtype=torch.bfloat16) * 0.1)(P))
        Lambda_im = (lambda *s: torch.randn(*s, dtype=torch.bfloat16) * 0.4)(P) * 1.0
        B_re = (lambda *s: torch.randn(*s, dtype=torch.bfloat16) * 0.2)(P, D) * (D ** -0.5)
        B_im = (lambda *s: torch.randn(*s, dtype=torch.bfloat16) * 0.2)(P, D) * (D ** -0.5)
        C_re = (lambda *s: torch.randn(*s, dtype=torch.bfloat16) * 0.2)(D, P) * (P ** -0.5)
        C_im = (lambda *s: torch.randn(*s, dtype=torch.bfloat16) * 0.2)(D, P) * (P ** -0.5)
        log_dt = (lambda *s: torch.randn(*s, dtype=torch.bfloat16) * 0.1)(P) * 0.3 - 2.0
        Dskip = (lambda *s: torch.randn(*s, dtype=torch.bfloat16) * 0.05)(D)
        return {
            "x": _w((lambda *s: torch.randn(*s, dtype=torch.bfloat16) * 0.05)(B, S, D)),
            "Lambda_re": _w(Lambda_re),
            "Lambda_im": _w(Lambda_im),
            "B_re": _w(B_re),
            "B_im": _w(B_im),
            "C_re": _w(C_re),
            "C_im": _w(C_im),
            "log_dt": _w(log_dt),
            "Dskip": _w(Dskip),
        }
    _A_in = _A_setup()

    def _B_setup():
        B, S, D, F = 1, 2048, 1024, 3584
        return {
            "x": _w((lambda *s: torch.randn(*s, dtype=torch.bfloat16) * 0.05)(B, S, D)),
            "w1": _w((lambda *s: torch.randn(*s, dtype=torch.bfloat16) * 0.8)(S, F) * (S ** -0.5)),
            "b1": _w((lambda *s: torch.randn(*s, dtype=torch.bfloat16) * 3.2)(F) * 0.02),
            "w2": _w((lambda *s: torch.randn(*s, dtype=torch.bfloat16) * 0.4)(F, S) * (F ** -0.5)),
            "b2": _w((lambda *s: torch.randn(*s, dtype=torch.bfloat16) * 1.6)(S) * 0.02),
        }
    _B_in = _B_setup()

    return {
        "A_x": _A_in["x"],
        "A_Lambda_re": _A_in["Lambda_re"],
        "A_Lambda_im": _A_in["Lambda_im"],
        "A_B_re": _A_in["B_re"],
        "A_B_im": _A_in["B_im"],
        "A_C_re": _A_in["C_re"],
        "A_C_im": _A_in["C_im"],
        "A_log_dt": _A_in["log_dt"],
        "A_Dskip": _A_in["Dskip"],
        "B_x": _B_in["x"],
        "B_w1": _B_in["w1"],
        "B_b1": _B_in["b1"],
        "B_w2": _B_in["w2"],
        "B_b2": _B_in["b2"],
    }

def reference(A_x, A_Lambda_re, A_Lambda_im, A_B_re, A_B_im, A_C_re, A_C_im, A_log_dt, A_Dskip, B_x, B_w1, B_b1, B_w2, B_b2):
    def _A_ref(x, Lambda_re, Lambda_im, B_re, B_im, C_re, C_im, log_dt, Dskip):
        Bsz, L, H = x.shape
        Lam = Lambda_re + 1j * Lambda_im
        Bmat = B_re + 1j * B_im
        Cmat = C_re + 1j * C_im
        dt = torch.exp(log_dt)
        Lam_bar = torch.exp(dt * Lam)
        B_bar = ((Lam_bar - 1.0) / Lam)[:, None] * Bmat
        Bu = torch.einsum("bld,pd->blp", x + 0j, B_bar)
        h = torch.zeros_like(Bu[:, 0, :])
        hs = []
        for t in range(L):
            h = Lam_bar[None, :] * h + Bu[:, t, :]
            hs.append(h)
        hseq = torch.stack(hs, 1)
        y = 2.0 * torch.einsum("blp,dp->bld", hseq, Cmat).real + x * Dskip[None, None, :]
        return y

    def _B_ref(x, w1, b1, w2, b2):
        B, S, D = x.shape
        h = _layernorm(x, axis=-1)
        u = torch.einsum("bsd,sf->bdf", h, w1) + b1
        u = _gelu(u)
        y = torch.einsum("bdf,fs->bds", u, w2) + b2
        return (lambda x, *d: x.permute(*d))(y, 0, 2, 1)

    x = A_x
    xn = _layernorm(x, axis=-1)
    return x + _A_ref(xn, A_Lambda_re, A_Lambda_im, A_B_re, A_B_im, A_C_re, A_C_im, A_log_dt, A_Dskip) + _B_ref(xn, B_w1, B_b1, B_w2, B_b2)
```

```asm
; @launch grid=(256,1,1) block=(512,1,1) lds=163840
.amdgcn_target "amdgcn-amd-amdhsa--gfx950"
.text
.globl parallel_sum__ssm_conv_s5__mixer_token_mlp__prompt_kernel
.p2align 8
.type parallel_sum__ssm_conv_s5__mixer_token_mlp__prompt_kernel,@function
parallel_sum__ssm_conv_s5__mixer_token_mlp__prompt_kernel:
s_cmp_ge_u32 s2, 256
s_cbranch_scc1 L_end
s_xor_b32 s2, s2, 3
s_load_dwordx16 s[4:19], s[0:1], 0
s_load_dwordx16 s[20:35], s[0:1], 64
s_load_dwordx2 s[36:37], s[0:1], 128
v_lshrrev_b32 v2, 6, v0
v_and_b32 v1, 63, v0
v_readfirstlane_b32 s38, v2
v_lshlrev_b32 v2, 4, v1
v_mov_b32 v4, 0
s_lshl_b32 s48, s2, 3
s_add_u32 s48, s48, s38
s_lshl_b32 s48, s48, 11
s_and_b32 s49, s48, 0x1fffff
s_lshr_b32 s50, s48, 10
s_mov_b32 s58, 0x400000
s_mov_b32 s59, 0x20000
s_mov_b32 s62, 0x200000
s_mov_b32 s63, 0x20000
s_mov_b32 s66, 4096
s_mov_b32 s67, 0x20000
s_cmp_lt_u32 s2, 128
s_waitcnt lgkmcnt(0)
s_mov_b32 s56, s4
s_mov_b32 s57, s5
buffer_load_dwordx4 v[64:67], v2, s[56:59], s48 offen
buffer_load_dwordx4 v[68:71], v2, s[56:59], s48 offen offset:1024
s_cselect_b32 s60, s10, s12
s_cselect_b32 s61, s11, s13
s_mov_b32 s64, s30
s_mov_b32 s65, s31
buffer_load_dwordx4 v[72:75], v2, s[60:63], s49 offen
buffer_load_dwordx4 v[76:79], v2, s[60:63], s49 offen offset:1024
buffer_load_ushort v83, v4, s[64:67], s50 offen
s_getpc_b64 s[96:97]
L_pc:
s_lshr_b32 s98, s2, 3
s_lshl_b32 s98, s98, 3
s_add_u32 s98, s98, s38
s_mul_i32 s98, s98, 384
s_min_u32 s98, s98, (L_end-parallel_sum__ssm_conv_s5__mixer_token_mlp__prompt_kernel-384)&~127
s_sub_u32 s96, s96, L_pc-parallel_sum__ssm_conv_s5__mixer_token_mlp__prompt_kernel
s_subb_u32 s97, s97, 0
s_and_b32 s3, s38, 3
s_lshr_b32 s22, s3, 1
s_and_b32 s23, s3, 1
s_lshr_b32 s40, s2, 3
s_and_b32 s39, s2, 7
s_and_b32 s41, s39, 3
s_lshl_b32 s41, s41, 2
s_and_b32 s48, s40, 3
s_add_u32 s41, s41, s48
s_lshr_b32 s42, s39, 2
s_lshl_b32 s42, s42, 3
s_lshr_b32 s48, s40, 2
s_add_u32 s42, s42, s48
s_and_b32 s43, s39, 1
s_lshl_b32 s43, s43, 2
s_and_b32 s48, s40, 3
s_add_u32 s43, s43, s48
s_lshr_b32 s44, s39, 1
s_mul_i32 s44, s44, 7
s_lshr_b32 s48, s40, 2
s_add_u32 s44, s44, s48
s_lshr_b32 s45, s39, 1
s_lshr_b32 s46, s40, 1
s_and_b32 s47, s39, 1
s_lshl_b32 s47, s47, 1
s_and_b32 s48, s40, 1
s_add_u32 s47, s47, s48
s_cmp_lt_u32 s38, 4
s_cbranch_scc1 L_compute
s_load_dwordx2 s[30:31], s[96:97], s98 offset:60
s_load_dwordx2 s[30:31], s[96:97], s98 offset:188
s_load_dwordx2 s[30:31], s[96:97], s98 offset:316
s_lshl_b32 s0, s3, 12
s_add_u32 s53, s0, 98304
s_cmp_eq_u32 s23, 0
s_cselect_b32 s60, s10, s12
s_cselect_b32 s61, s11, s13
s_lshl_b32 s51, s41, 7
v_lshrrev_b32 v57, 3, v1
v_and_b32 v3, 7, v1
v_lshrrev_b32 v4, 4, v1
v_xor_b32 v3, v3, v4
s_lshl_b32 s48, s3, 5
s_add_u32 s48, s48, s51
v_add_u32 v57, s48, v57
s_and_b32 s48, s3, 1
s_lshl_b32 s48, s48, 2
v_xor_b32 v3, s48, v3
v_lshlrev_b32 v57, 11, v57
v_lshl_add_u32 v8, v3, 4, v57
v_lshl_add_u32 v57, v3, 4, v57
v_add_u32 v9, 0x3c00, v57
v_add_u32 v10, 0x7800, v8
v_add_u32 v11, 0xb400, v57
s_lshl_b32 s51, s42, 6
v_lshrrev_b32 v57, 3, v1
v_and_b32 v3, 7, v1
v_lshrrev_b32 v4, 4, v1
v_xor_b32 v3, v3, v4
s_lshr_b32 s48, s3, 1
s_lshl_b32 s48, s48, 5
s_add_u32 s48, s48, s51
v_add_u32 v57, s48, v57
v_lshlrev_b32 v57, 11, v57
v_lshl_add_u32 v12, v3, 4, v57
v_xor_b32 v3, 4, v3
v_lshl_add_u32 v57, v3, 4, v57
v_add_u32 v13, 0x3c00, v57
v_add_u32 v14, 0x7800, v12
v_add_u32 v15, 0xb400, v57
s_and_b32 s54, s2, 7
s_lshl_b32 s54, s54, 8
s_mov_b32 s55, s54
s_mov_b32 m0, s53
s_add_u32 s1, s53, 16384
buffer_load_dwordx4 v8, s[56:59], s54 offen offset:0 lds
buffer_load_dwordx4 v9, s[56:59], s54 offen offset:1024 lds
buffer_load_dwordx4 v10, s[56:59], s54 offen offset:2048 lds
buffer_load_dwordx4 v11, s[56:59], s54 offen offset:3072 lds
s_mov_b32 m0, s1
s_nop 0
buffer_load_dwordx4 v12, s[60:63], s55 offen offset:0 lds
buffer_load_dwordx4 v13, s[60:63], s55 offen offset:1024 lds
buffer_load_dwordx4 v14, s[60:63], s55 offen offset:2048 lds
buffer_load_dwordx4 v15, s[60:63], s55 offen offset:3072 lds
s_add_u32 s54, s54, 128
s_and_b32 s54, s54, 2047
s_mov_b32 s55, s54
s_add_u32 s53, s53, 32768
s_cmp_ge_u32 s53, 131072
s_cselect_b32 s53, s0, s53
s_mov_b32 s64, s6
s_mov_b32 s65, s7
s_mov_b32 s66, 0x800
s_mov_b32 s67, 0x20000
s_mov_b32 s68, s8
s_mov_b32 s69, s9
s_mov_b32 s70, 0x800
s_mov_b32 s71, 0x20000
s_mov_b32 s72, s18
s_mov_b32 s73, s19
s_mov_b32 s74, 0x800
s_mov_b32 s75, 0x20000
s_add_u32 s96, s36, 0x1820000
s_addc_u32 s97, s37, 0
s_mov_b32 s98, 0x20000
s_mov_b32 s99, 0x20000
v_and_b32 v3, 31, v1
v_lshlrev_b32 v52, 3, v3
v_lshlrev_b32 v3, 1, v3
s_lshl_b32 s51, s42, 1
s_add_u32 s51, s51, s23
s_lshl_b32 s48, s51, 6
buffer_load_ushort v58, v3, s[64:67], s48 offen
buffer_load_ushort v59, v3, s[68:71], s48 offen
buffer_load_ushort v60, v3, s[72:75], s48 offen
s_lshl_b32 s51, s51, 4
s_add_u32 s51, s51, s41
s_lshl_b32 s51, s51, 8
v_mov_b32 v6, -1
v_mov_b32 v7, -1
s_cmp_lg_u32 s22, 0
s_cbranch_scc1 Lm_1
buffer_store_dwordx2 v[6:7], v52, s[96:99], s51 offen sc1
Lm_1:
s_waitcnt vmcnt(11)
s_mov_b32 m0, s53
s_add_u32 s1, s53, 16384
buffer_load_dwordx4 v8, s[56:59], s54 offen offset:0 lds
s_mov_b32 s49, 0x3f803f80
s_mov_b32 s50, 0x3f80
s_mov_b32 s51, 0x3f800000
v_dot2_f32_bf16 v80, v64, s49, 0
v_dot2_f32_bf16 v81, v64, v64, 0
v_dot2_f32_bf16 v82, v72, s49, 0
v_dot2_f32_bf16 v80, v65, s49, v80
v_dot2_f32_bf16 v81, v65, v65, v81
v_dot2_f32_bf16 v82, v73, s49, v82
v_dot2_f32_bf16 v80, v66, s49, v80
v_dot2_f32_bf16 v81, v66, v66, v81
v_dot2_f32_bf16 v82, v74, s49, v82
v_dot2_f32_bf16 v80, v67, s49, v80
v_dot2_f32_bf16 v81, v67, v67, v81
v_dot2_f32_bf16 v82, v75, s49, v82
buffer_load_dwordx4 v9, s[56:59], s54 offen offset:1024 lds
v_dot2_f32_bf16 v80, v68, s49, v80
v_dot2_f32_bf16 v81, v68, v68, v81
v_dot2_f32_bf16 v82, v76, s49, v82
v_dot2_f32_bf16 v80, v69, s49, v80
v_dot2_f32_bf16 v81, v69, v69, v81
v_dot2_f32_bf16 v82, v77, s49, v82
v_dot2_f32_bf16 v80, v70, s49, v80
v_dot2_f32_bf16 v81, v70, v70, v81
v_dot2_f32_bf16 v82, v78, s49, v82
v_dot2_f32_bf16 v80, v71, s49, v80
v_dot2_f32_bf16 v81, v71, v71, v81
v_dot2_f32_bf16 v82, v79, s49, v82
s_nop 3
v_add_f32 v80, v80, v80 quad_perm:[1,0,3,2] row_mask:0xf bank_mask:0xf
v_add_f32 v81, v81, v81 quad_perm:[1,0,3,2] row_mask:0xf bank_mask:0xf
buffer_load_dwordx4 v10, s[56:59], s54 offen offset:2048 lds
v_add_f32 v82, v82, v82 quad_perm:[1,0,3,2] row_mask:0xf bank_mask:0xf
v_add_f32 v80, v80, v80 quad_perm:[2,3,0,1] row_mask:0xf bank_mask:0xf
v_add_f32 v81, v81, v81 quad_perm:[2,3,0,1] row_mask:0xf bank_mask:0xf
v_add_f32 v82, v82, v82 quad_perm:[2,3,0,1] row_mask:0xf bank_mask:0xf
v_add_f32 v80, v80, v80 row_half_mirror row_mask:0xf bank_mask:0xf
v_add_f32 v81, v81, v81 row_half_mirror row_mask:0xf bank_mask:0xf
v_add_f32 v82, v82, v82 row_half_mirror row_mask:0xf bank_mask:0xf
v_add_f32 v80, v80, v80 row_mirror row_mask:0xf bank_mask:0xf
v_add_f32 v81, v81, v81 row_mirror row_mask:0xf bank_mask:0xf
v_add_f32 v82, v82, v82 row_mirror row_mask:0xf bank_mask:0xf
v_mov_b32 v84, v80
v_mov_b32 v85, v81
v_mov_b32 v86, v82
v_permlane16_swap_b32 v84, v80
v_permlane16_swap_b32 v85, v81
buffer_load_dwordx4 v11, s[56:59], s54 offen offset:3072 lds
v_permlane16_swap_b32 v86, v82
v_add_f32 v80, v80, v84
v_add_f32 v81, v81, v85
v_add_f32 v82, v82, v86
v_mov_b32 v84, v80
v_mov_b32 v85, v81
v_mov_b32 v86, v82
v_permlane32_swap_b32 v84, v80
v_permlane32_swap_b32 v85, v81
v_permlane32_swap_b32 v86, v82
v_add_f32 v80, v80, v84
v_add_f32 v81, v81, v85
v_add_f32 v82, v82, v86
v_mul_f32 v80, 0x3a800000, v80
v_mul_f32 v81, 0x3a800000, v81
s_mov_b32 m0, s1
s_nop 0
buffer_load_dwordx4 v12, s[60:63], s55 offen offset:0 lds
v_fma_f32 v81, -v80, v80, v81
v_max_f32 v81, 0, v81
v_cvt_pk_bf16_f32 v81, 0, v81
v_add_f32 v81, 0x3727c5ac, v81
v_cvt_pk_bf16_f32 v81, 0, v81
v_sqrt_f32 v81, v81
v_cvt_pk_bf16_f32 v80, 0, v80
v_xor_b32 v89, 0x80000000, v80
v_cvt_pk_bf16_f32 v81, 0, v81
v_rcp_f32 v81, v81
v_dot2_f32_bf16 v96, v64, s50, v89
v_dot2_f32_bf16 v97, v64, s51, v89
v_dot2_f32_bf16 v98, v65, s50, v89
v_dot2_f32_bf16 v99, v65, s51, v89
v_dot2_f32_bf16 v100, v66, s50, v89
buffer_load_dwordx4 v13, s[60:63], s55 offen offset:1024 lds
v_dot2_f32_bf16 v101, v66, s51, v89
v_dot2_f32_bf16 v102, v67, s50, v89
v_dot2_f32_bf16 v103, v67, s51, v89
v_dot2_f32_bf16 v104, v68, s50, v89
v_dot2_f32_bf16 v105, v68, s51, v89
v_dot2_f32_bf16 v106, v69, s50, v89
v_dot2_f32_bf16 v107, v69, s51, v89
v_dot2_f32_bf16 v108, v70, s50, v89
v_dot2_f32_bf16 v109, v70, s51, v89
v_dot2_f32_bf16 v110, v71, s50, v89
v_dot2_f32_bf16 v111, v71, s51, v89
v_mov_b32 v87, v80
v_mov_b32 v88, v81
s_nop 1
v_cvt_pk_bf16_f32 v96, 0, v96
buffer_load_dwordx4 v14, s[60:63], s55 offen offset:2048 lds
v_cvt_pk_bf16_f32 v97, 0, v97
v_cvt_pk_bf16_f32 v98, 0, v98
v_cvt_pk_bf16_f32 v99, 0, v99
v_cvt_pk_bf16_f32 v100, 0, v100
v_cvt_pk_bf16_f32 v101, 0, v101
v_cvt_pk_bf16_f32 v102, 0, v102
v_cvt_pk_bf16_f32 v103, 0, v103
v_cvt_pk_bf16_f32 v104, 0, v104
v_cvt_pk_bf16_f32 v105, 0, v105
v_cvt_pk_bf16_f32 v106, 0, v106
v_cvt_pk_bf16_f32 v107, 0, v107
v_cvt_pk_bf16_f32 v108, 0, v108
v_cvt_pk_bf16_f32 v109, 0, v109
v_cvt_pk_bf16_f32 v110, 0, v110
v_cvt_pk_bf16_f32 v111, 0, v111
buffer_load_dwordx4 v15, s[60:63], s55 offen offset:3072 lds
v_pk_mul_f32 v[96:97], v[96:97], v[80:81] op_sel:[0,1] op_sel_hi:[1,1]
v_pk_mul_f32 v[98:99], v[98:99], v[80:81] op_sel:[0,1] op_sel_hi:[1,1]
v_pk_mul_f32 v[100:101], v[100:101], v[80:81] op_sel:[0,1] op_sel_hi:[1,1]
v_pk_mul_f32 v[102:103], v[102:103], v[80:81] op_sel:[0,1] op_sel_hi:[1,1]
v_pk_mul_f32 v[104:105], v[104:105], v[80:81] op_sel:[0,1] op_sel_hi:[1,1]
v_pk_mul_f32 v[106:107], v[106:107], v[80:81] op_sel:[0,1] op_sel_hi:[1,1]
v_pk_mul_f32 v[108:109], v[108:109], v[80:81] op_sel:[0,1] op_sel_hi:[1,1]
v_pk_mul_f32 v[110:111], v[110:111], v[80:81] op_sel:[0,1] op_sel_hi:[1,1]
v_cvt_pk_bf16_f32 v64, v96, v97
s_add_u32 s54, s54, 128
s_and_b32 s54, s54, 2047
s_mov_b32 s55, s54
s_add_u32 s53, s53, 32768
s_cmp_ge_u32 s53, 131072
s_cselect_b32 s53, s0, s53
s_mov_b32 m0, s53
s_add_u32 s1, s53, 16384
buffer_load_dwordx4 v8, s[56:59], s54 offen offset:0 lds
v_cvt_pk_bf16_f32 v65, v98, v99
v_cvt_pk_bf16_f32 v66, v100, v101
v_cvt_pk_bf16_f32 v67, v102, v103
v_cvt_pk_bf16_f32 v68, v104, v105
v_cvt_pk_bf16_f32 v69, v106, v107
v_cvt_pk_bf16_f32 v70, v108, v109
v_cvt_pk_bf16_f32 v71, v110, v111
v_dot2_f32_bf16 v80, v64, s49, 0
v_dot2_f32_bf16 v81, v64, v64, 0
v_dot2_f32_bf16 v80, v65, s49, v80
v_dot2_f32_bf16 v81, v65, v65, v81
v_dot2_f32_bf16 v80, v66, s49, v80
v_dot2_f32_bf16 v81, v66, v66, v81
v_dot2_f32_bf16 v80, v67, s49, v80
v_dot2_f32_bf16 v81, v67, v67, v81
buffer_load_dwordx4 v9, s[56:59], s54 offen offset:1024 lds
v_dot2_f32_bf16 v80, v68, s49, v80
v_dot2_f32_bf16 v81, v68, v68, v81
v_dot2_f32_bf16 v80, v69, s49, v80
v_dot2_f32_bf16 v81, v69, v69, v81
v_dot2_f32_bf16 v80, v70, s49, v80
v_dot2_f32_bf16 v81, v70, v70, v81
v_dot2_f32_bf16 v80, v71, s49, v80
v_dot2_f32_bf16 v81, v71, v71, v81
s_nop 3
v_add_f32 v80, v80, v80 quad_perm:[1,0,3,2] row_mask:0xf bank_mask:0xf
v_add_f32 v81, v81, v81 quad_perm:[1,0,3,2] row_mask:0xf bank_mask:0xf
s_nop 0
v_add_f32 v80, v80, v80 quad_perm:[2,3,0,1] row_mask:0xf bank_mask:0xf
v_add_f32 v81, v81, v81 quad_perm:[2,3,0,1] row_mask:0xf bank_mask:0xf
s_nop 0
buffer_load_dwordx4 v10, s[56:59], s54 offen offset:2048 lds
v_add_f32 v80, v80, v80 row_half_mirror row_mask:0xf bank_mask:0xf
v_add_f32 v81, v81, v81 row_half_mirror row_mask:0xf bank_mask:0xf
s_nop 0
v_add_f32 v80, v80, v80 row_mirror row_mask:0xf bank_mask:0xf
v_add_f32 v81, v81, v81 row_mirror row_mask:0xf bank_mask:0xf
s_nop 0
v_mov_b32 v84, v80
v_mov_b32 v85, v81
s_nop 0
v_permlane16_swap_b32 v84, v80
v_permlane16_swap_b32 v85, v81
s_nop 0
v_add_f32 v80, v80, v84
v_add_f32 v81, v81, v85
s_nop 0
buffer_load_dwordx4 v11, s[56:59], s54 offen offset:3072 lds
v_mov_b32 v84, v80
v_mov_b32 v85, v81
s_nop 0
v_permlane32_swap_b32 v84, v80
v_permlane32_swap_b32 v85, v81
s_nop 0
v_add_f32 v80, v80, v84
v_add_f32 v81, v81, v85
s_nop 0
v_mul_f32 v80, 0x3a800000, v80
v_mul_f32 v81, 0x3a800000, v81
v_fma_f32 v81, -v80, v80, v81
v_max_f32 v81, 0, v81
v_cvt_pk_bf16_f32 v81, 0, v81
v_add_f32 v81, 0x3727c5ac, v81
s_mov_b32 m0, s1
s_nop 0
buffer_load_dwordx4 v12, s[60:63], s55 offen offset:0 lds
v_cvt_pk_bf16_f32 v81, 0, v81
v_sqrt_f32 v81, v81
v_cvt_pk_bf16_f32 v80, 0, v80
v_xor_b32 v89, 0x80000000, v80
v_cvt_pk_bf16_f32 v81, 0, v81
v_rcp_f32 v81, v81
v_dot2_f32_bf16 v96, v64, s50, v89
v_dot2_f32_bf16 v97, v64, s51, v89
v_dot2_f32_bf16 v98, v65, s50, v89
v_dot2_f32_bf16 v99, v65, s51, v89
v_dot2_f32_bf16 v100, v66, s50, v89
v_dot2_f32_bf16 v101, v66, s51, v89
v_dot2_f32_bf16 v102, v67, s50, v89
v_dot2_f32_bf16 v103, v67, s51, v89
v_dot2_f32_bf16 v104, v68, s50, v89
buffer_load_dwordx4 v13, s[60:63], s55 offen offset:1024 lds
v_dot2_f32_bf16 v105, v68, s51, v89
v_dot2_f32_bf16 v106, v69, s50, v89
v_dot2_f32_bf16 v107, v69, s51, v89
v_dot2_f32_bf16 v108, v70, s50, v89
v_dot2_f32_bf16 v109, v70, s51, v89
v_dot2_f32_bf16 v110, v71, s50, v89
v_dot2_f32_bf16 v111, v71, s51, v89
s_nop 1
v_cvt_pk_bf16_f32 v96, 0, v96
v_cvt_pk_bf16_f32 v97, 0, v97
v_cvt_pk_bf16_f32 v98, 0, v98
v_cvt_pk_bf16_f32 v99, 0, v99
v_cvt_pk_bf16_f32 v100, 0, v100
v_cvt_pk_bf16_f32 v101, 0, v101
v_cvt_pk_bf16_f32 v102, 0, v102
buffer_load_dwordx4 v14, s[60:63], s55 offen offset:2048 lds
v_cvt_pk_bf16_f32 v103, 0, v103
v_cvt_pk_bf16_f32 v104, 0, v104
v_cvt_pk_bf16_f32 v105, 0, v105
v_cvt_pk_bf16_f32 v106, 0, v106
v_cvt_pk_bf16_f32 v107, 0, v107
v_cvt_pk_bf16_f32 v108, 0, v108
v_cvt_pk_bf16_f32 v109, 0, v109
v_cvt_pk_bf16_f32 v110, 0, v110
v_cvt_pk_bf16_f32 v111, 0, v111
v_pk_mul_f32 v[96:97], v[96:97], v[80:81] op_sel:[0,1] op_sel_hi:[1,1]
v_pk_mul_f32 v[98:99], v[98:99], v[80:81] op_sel:[0,1] op_sel_hi:[1,1]
v_pk_mul_f32 v[100:101], v[100:101], v[80:81] op_sel:[0,1] op_sel_hi:[1,1]
v_pk_mul_f32 v[102:103], v[102:103], v[80:81] op_sel:[0,1] op_sel_hi:[1,1]
v_pk_mul_f32 v[104:105], v[104:105], v[80:81] op_sel:[0,1] op_sel_hi:[1,1]
v_pk_mul_f32 v[106:107], v[106:107], v[80:81] op_sel:[0,1] op_sel_hi:[1,1]
buffer_load_dwordx4 v15, s[60:63], s55 offen offset:3072 lds
v_pk_mul_f32 v[108:109], v[108:109], v[80:81] op_sel:[0,1] op_sel_hi:[1,1]
v_pk_mul_f32 v[110:111], v[110:111], v[80:81] op_sel:[0,1] op_sel_hi:[1,1]
v_cvt_pk_bf16_f32 v64, v96, v97
v_cvt_pk_bf16_f32 v65, v98, v99
v_cvt_pk_bf16_f32 v66, v100, v101
v_cvt_pk_bf16_f32 v67, v102, v103
v_cvt_pk_bf16_f32 v68, v104, v105
v_cvt_pk_bf16_f32 v69, v106, v107
v_cvt_pk_bf16_f32 v70, v108, v109
v_cvt_pk_bf16_f32 v71, v110, v111
s_add_u32 s54, s54, 128
s_and_b32 s54, s54, 2047
s_mov_b32 s55, s54
s_add_u32 s53, s53, 32768
s_cmp_ge_u32 s53, 131072
s_cselect_b32 s53, s0, s53
s_mul_i32 s49, s38, 2176
s_add_u32 s49, s49, 0x20000
v_add_u32 v3, s49, v2
ds_write_b128 v3, v[64:67]
ds_write_b128 v3, v[68:71] offset:1024
v_lshrrev_b32 v84, 16, v87
v_lshl_or_b32 v84, v83, 16, v84
v_cmp_eq_u32 vcc, 1, v1
v_cndmask_b32 v87, v87, v88, vcc
v_cmp_eq_u32 vcc, 2, v1
v_cndmask_b32 v87, v87, v82, vcc
v_cmp_eq_u32 vcc, 3, v1
v_cndmask_b32 v87, v87, v84, vcc
v_cmp_eq_u32 vcc, 4, v1
v_cndmask_b32 v87, v87, v88, vcc
s_lshl_b32 s49, s38, 2
s_add_u32 s49, s49, 0x24400
v_lshl_add_u32 v3, v1, 5, s49
s_lshl_b32 s50, s38, 3
s_add_u32 s50, s50, 0x24474
v_lshl_add_u32 v4, v1, 2, s50
v_cmp_lt_u32 vcc, 2, v1
v_cndmask_b32 v3, v3, v4, vcc
s_mov_b64 exec, 31
ds_write_b32 v3, v87
s_mov_b64 exec, -1
s_waitcnt vmcnt(16) lgkmcnt(0)
s_barrier
s_mov_b32 m0, s53
s_add_u32 s1, s53, 16384
buffer_load_dwordx4 v8, s[56:59], s54 offen offset:0 lds
v_lshlrev_b32 v58, 16, v58
v_lshlrev_b32 v59, 16, v59
v_lshlrev_b32 v60, 16, v60
v_mul_f32 v60, 0x3fb8aa3b, v60
v_exp_f32 v60, v60
s_nop 0
v_cvt_pk_bf16_f32 v60, 0, v60
v_mul_f32 v61, v60, v58
buffer_load_dwordx4 v9, s[56:59], s54 offen offset:1024 lds
v_mul_f32 v62, v60, v59
v_mul_f32 v61, 0x3fb8aa3b, v61
v_exp_f32 v61, v61
v_mul_f32 v62, 0x3e22f983, v62
v_rndne_f32 v63, v62
v_sub_f32 v62, v62, v63
v_cos_f32 v63, v62
v_sin_f32 v60, v62
buffer_load_dwordx4 v10, s[56:59], s54 offen offset:2048 lds
s_nop 0
v_mul_f32 v192, v61, v63
v_mul_f32 v193, v61, v60
v_add_f32 v63, -1.0, v192
v_mul_f32 v60, v58, v58
v_fmac_f32 v60, v59, v59
v_rcp_f32 v60, v60
v_mul_f32 v194, v63, v58
buffer_load_dwordx4 v11, s[56:59], s54 offen offset:3072 lds
v_fmac_f32 v194, v193, v59
v_mul_f32 v195, v193, v58
v_fma_f32 v195, -v63, v59, v195
v_add_f32 v60, v60, v60
v_mul_f32 v194, v194, v60
v_mul_f32 v195, v195, v60
v_mov_b32 v196, v192
v_mov_b32 v197, v193
s_mov_b32 m0, s1
s_nop 0
buffer_load_dwordx4 v12, s[60:63], s55 offen offset:0 lds
v_mul_f32 v58, v196, v197
v_mul_f32 v196, v196, v196
v_fma_f32 v196, -v197, v197, v196
v_add_f32 v197, v58, v58
v_mul_f32 v58, v196, v197
v_mul_f32 v196, v196, v196
v_fma_f32 v196, -v197, v197, v196
v_add_f32 v197, v58, v58
buffer_load_dwordx4 v13, s[60:63], s55 offen offset:1024 lds
v_mul_f32 v58, v196, v197
v_mul_f32 v196, v196, v196
v_fma_f32 v196, -v197, v197, v196
v_add_f32 v197, v58, v58
v_mul_f32 v58, v196, v197
v_mul_f32 v196, v196, v196
v_fma_f32 v196, -v197, v197, v196
v_add_f32 v197, v58, v58
buffer_load_dwordx4 v14, s[60:63], s55 offen offset:2048 lds
v_mul_f32 v58, v196, v197
v_mul_f32 v196, v196, v196
v_fma_f32 v196, -v197, v197, v196
v_add_f32 v197, v58, v58
s_lshl_b32 s48, s23, 10
s_add_u32 s48, s48, 0x24500
v_lshl_add_u32 v59, v52, 2, s48
ds_write_b128 v59, v[192:195]
buffer_load_dwordx4 v15, s[60:63], s55 offen offset:3072 lds
ds_write_b64 v59, v[196:197] offset:16
s_add_u32 s54, s54, 128
s_and_b32 s54, s54, 2047
s_mov_b32 s55, s54
s_add_u32 s53, s53, 32768
s_cmp_ge_u32 s53, 131072
s_cselect_b32 s53, s0, s53
s_waitcnt vmcnt(16) lgkmcnt(0)
s_barrier
s_mov_b32 m0, s53
s_add_u32 s1, s53, 16384
buffer_load_dwordx4 v8, s[56:59], s54 offen offset:0 lds
s_mov_b32 s64, s24
s_mov_b32 s65, s25
s_mov_b32 s66, 0xe00000
s_mov_b32 s67, 0x20000
s_add_u32 s68, s36, 0x3ff000
s_addc_u32 s69, s37, 0
s_mov_b32 s70, 0x401000
buffer_load_dwordx4 v9, s[56:59], s54 offen offset:1024 lds
s_mov_b32 s71, 0x20000
s_lshl_b32 s51, s44, 7
v_lshrrev_b32 v57, 4, v1
v_and_b32 v3, 15, v1
v_lshlrev_b32 v4, 2, v57
v_xor_b32 v3, v3, v4
s_lshl_b32 s48, s3, 4
buffer_load_dwordx4 v10, s[56:59], s54 offen offset:2048 lds
v_add_u32 v57, s48, v57
s_lshl_b32 s49, s51, 1
v_lshlrev_b32 v3, 4, v3
v_add_u32 v3, s49, v3
v_mul_u32_u24 v57, 7168, v57
v_add_u32 v16, v57, v3
v_add_u32 v17, 0x6c00, v16
buffer_load_dwordx4 v11, s[56:59], s54 offen offset:3072 lds
v_add_u32 v18, 0xd800, v16
v_add_u32 v19, 0x14400, v16
s_lshl_b32 s51, s43, 7
v_add_u32 v57, s51, v1
v_lshlrev_b32 v57, 4, v57
s_mul_i32 s48, s3, 32768
v_add_u32 v57, s48, v57
s_mov_b32 m0, s1
s_nop 0
buffer_load_dwordx4 v12, s[60:63], s55 offen offset:0 lds
v_add_u32 v20, 0x1000, v57
v_add_u32 v21, 0x1000, v57
v_add_u32 v22, 0x4800, v57
v_add_u32 v23, 0x4800, v57
s_add_u32 s88, s36, 0x1900000
s_addc_u32 s89, s37, 0
s_mov_b32 s90, 0x20000
buffer_load_dwordx4 v13, s[60:63], s55 offen offset:1024 lds
s_mov_b32 s91, 0x20000
s_mov_b32 s92, s34
s_mov_b32 s93, s35
s_mov_b32 s94, 0x100
s_mov_b32 s95, 0x20000
v_lshlrev_b32 v54, 2, v1
v_mov_b32 v6, 1
buffer_load_dwordx4 v14, s[60:63], s55 offen offset:2048 lds
s_lshl_b32 s48, s2, 2
v_lshl_add_u32 v7, v1, 10, s48
s_and_b32 s52, s2, 3
s_lshl_b32 s52, s52, 10
s_lshl_b32 s6, s2, 2
s_add_u32 s6, s6, s3
s_mul_i32 s6, s6, 384
buffer_load_dwordx4 v15, s[60:63], s55 offen offset:3072 lds
s_add_u32 s6, s6, 0x0
s_buffer_load_dwordx2 s[8:9], s[64:67], s6 offset:60
s_buffer_load_dwordx2 s[8:9], s[64:67], s6 offset:188
s_buffer_load_dwordx2 s[8:9], s[64:67], s6 offset:316
s_add_u32 s6, s6, 0x60000
s_add_u32 s54, s54, 128
s_and_b32 s54, s54, 2047
s_mov_b32 s55, s54
s_add_u32 s53, s53, 32768
s_cmp_ge_u32 s53, 131072
s_cselect_b32 s53, s0, s53
s_waitcnt vmcnt(16)
s_barrier
s_cmp_lg_u32 s3, 0
s_cbranch_scc1 Lw_20
s_mov_b64 exec, 0xf
buffer_load_dword v53, v54, s[92:95], 0 offen offset:0 sc1
s_mov_b64 exec, -1
Lw_20:
s_mov_b32 m0, s53
s_add_u32 s1, s53, 16384
buffer_load_dwordx4 v8, s[56:59], s54 offen offset:0 lds
v_mov_b32 v44, v196
v_mov_b32 v45, v197
v_mul_f32 v58, v44, v45
v_mul_f32 v44, v44, v44
buffer_load_dwordx4 v9, s[56:59], s54 offen offset:1024 lds
v_fma_f32 v44, -v45, v45, v44
v_add_f32 v45, v58, v58
v_mov_b32 v46, v44
v_mov_b32 v47, v45
buffer_load_dwordx4 v10, s[56:59], s54 offen offset:2048 lds
v_mul_f32 v58, v46, v47
v_mul_f32 v46, v46, v46
v_fma_f32 v46, -v47, v47, v46
v_add_f32 v47, v58, v58
buffer_load_dwordx4 v11, s[56:59], s54 offen offset:3072 lds
v_mov_b32 v48, v46
v_mov_b32 v49, v47
v_mul_f32 v58, v48, v49
v_mul_f32 v48, v48, v48
s_mov_b32 m0, s1
s_nop 0
buffer_load_dwordx4 v12, s[60:63], s55 offen offset:0 lds
v_fma_f32 v48, -v49, v49, v48
v_add_f32 v49, v58, v58
v_mul_f32 v58, v48, v49
v_mul_f32 v48, v48, v48
buffer_load_dwordx4 v13, s[60:63], s55 offen offset:1024 lds
v_fma_f32 v48, -v49, v49, v48
v_add_f32 v49, v58, v58
v_mul_f32 v58, v48, v49
v_mul_f32 v48, v48, v48
buffer_load_dwordx4 v14, s[60:63], s55 offen offset:2048 lds
v_fma_f32 v48, -v49, v49, v48
v_add_f32 v49, v58, v58
s_buffer_load_dwordx2 s[8:9], s[64:67], s6 offset:60
s_buffer_load_dwordx2 s[8:9], s[64:67], s6 offset:188
buffer_load_dwordx4 v15, s[60:63], s55 offen offset:3072 lds
s_buffer_load_dwordx2 s[8:9], s[64:67], s6 offset:316
s_add_u32 s6, s6, 0x60000
s_add_u32 s54, s54, 128
s_and_b32 s54, s54, 2047
s_mov_b32 s55, s54
s_add_u32 s53, s53, 32768
s_cmp_ge_u32 s53, 131072
s_cselect_b32 s53, s0, s53
s_waitcnt vmcnt(16)
s_barrier
s_mov_b32 m0, s53
s_add_u32 s1, s53, 16384
buffer_load_dwordx4 v8, s[56:59], s54 offen offset:0 lds
s_cmp_lt_u32 s45, 2
s_cselect_b32 s72, s14, s16
s_cselect_b32 s73, s15, s17
s_mov_b32 s74, 0x200000
s_mov_b32 s75, 0x20000
s_add_u32 s76, s36, 0x1000000
buffer_load_dwordx4 v9, s[56:59], s54 offen offset:1024 lds
s_addc_u32 s77, s37, 0
s_mov_b32 s78, 0x800000
s_mov_b32 s79, 0x20000
s_lshl_b32 s51, s47, 8
v_lshrrev_b32 v57, 3, v1
v_and_b32 v3, 7, v1
buffer_load_dwordx4 v10, s[56:59], s54 offen offset:2048 lds
v_lshrrev_b32 v4, 4, v1
v_xor_b32 v3, v3, v4
s_lshl_b32 s48, s3, 5
s_add_u32 s48, s48, s51
v_add_u32 v57, s48, v57
s_and_b32 s48, s3, 1
buffer_load_dwordx4 v11, s[56:59], s54 offen offset:3072 lds
s_lshl_b32 s48, s48, 2
v_xor_b32 v3, s48, v3
v_lshlrev_b32 v57, 11, v57
v_lshl_add_u32 v24, v3, 4, v57
v_lshl_add_u32 v57, v3, 4, v57
v_add_u32 v25, 0x3c00, v57
s_mov_b32 m0, s1
s_nop 0
buffer_load_dwordx4 v12, s[60:63], s55 offen offset:0 lds
v_add_u32 v26, 0x7800, v24
v_add_u32 v27, 0xb400, v57
s_and_b32 s49, s45, 1
s_xor_b32 s49, s49, s3
s_lshl_b32 s48, s46, 14
s_lshl_b32 s49, s49, 12
buffer_load_dwordx4 v13, s[60:63], s55 offen offset:1024 lds
s_add_u32 s48, s48, s49
v_xor_b32 v57, 0, v1
v_lshlrev_b32 v57, 4, v57
v_add_u32 v28, s48, v57
v_xor_b32 v57, 4, v1
v_lshlrev_b32 v57, 4, v57
buffer_load_dwordx4 v14, s[60:63], s55 offen offset:2048 lds
v_add_u32 v29, s48, v57
v_xor_b32 v57, 8, v1
v_lshlrev_b32 v57, 4, v57
v_add_u32 v30, s48, v57
v_xor_b32 v57, 12, v1
v_lshlrev_b32 v57, 4, v57
buffer_load_dwordx4 v15, s[60:63], s55 offen offset:3072 lds
v_add_u32 v31, s48, v57
s_buffer_load_dwordx2 s[8:9], s[64:67], s6 offset:60
s_buffer_load_dwordx2 s[8:9], s[64:67], s6 offset:188
s_buffer_load_dwordx2 s[8:9], s[64:67], s6 offset:316
s_add_u32 s6, s6, 0x60000
s_add_u32 s54, s54, 128
s_and_b32 s54, s54, 2047
s_mov_b32 s55, s54
s_add_u32 s53, s53, 32768
s_cmp_ge_u32 s53, 131072
s_cselect_b32 s53, s0, s53
s_waitcnt vmcnt(16)
s_barrier
s_mov_b32 m0, s53
s_add_u32 s1, s53, 16384
buffer_load_dwordx4 v8, s[56:59], s54 offen offset:0 lds
s_add_u32 s80, s36, 0x7ff000
s_addc_u32 s81, s37, 0
s_mov_b32 s82, 0x701000
s_mov_b32 s83, 0x20000
s_mov_b32 s84, s28
s_mov_b32 s85, s29
s_mov_b32 s86, 0xe00000
s_mov_b32 s87, 0x20000
buffer_load_dwordx4 v9, s[56:59], s54 offen offset:1024 lds
s_lshl_b32 s51, s47, 8
s_lshl_b32 s50, s22, 2
v_add_u32 v57, s51, v1
v_lshlrev_b32 v57, 4, v57
s_mul_i32 s48, s50, 32768
v_add_u32 v57, s48, v57
v_add_u32 v32, 0x1000, v57
v_add_u32 v33, 0x1000, v57
buffer_load_dwordx4 v10, s[56:59], s54 offen offset:2048 lds
v_add_u32 v34, 0x4800, v57
v_add_u32 v35, 0x4800, v57
s_lshl_b32 s51, s46, 7
v_lshrrev_b32 v57, 4, v1
v_and_b32 v3, 15, v1
v_lshlrev_b32 v4, 2, v57
v_xor_b32 v3, v3, v4
s_lshl_b32 s50, s22, 2
buffer_load_dwordx4 v11, s[56:59], s54 offen offset:3072 lds
s_lshl_b32 s48, s50, 4
v_add_u32 v57, s48, v57
s_lshl_b32 s49, s51, 1
v_lshlrev_b32 v3, 4, v3
v_add_u32 v3, s49, v3
v_mul_u32_u24 v57, 4096, v57
v_add_u32 v36, v57, v3
v_xor_b32 v57, 32, v36
s_mov_b32 m0, s1
s_nop 0
buffer_load_dwordx4 v12, s[60:63], s55 offen offset:0 lds
v_add_u32 v37, 0x3c00, v36
v_add_u32 v38, 0x7800, v57
v_add_u32 v39, 0xb400, v57
s_lshl_b32 s30, s46, 1
s_and_b32 s48, s45, 1
s_add_u32 s30, s30, s48
s_lshl_b32 s30, s30, 7
s_add_u32 s30, s30, 4096
buffer_load_dwordx4 v13, s[60:63], s55 offen offset:1024 lds
s_lshl_b32 s31, s47, 11
s_mul_i32 s48, s45, 224
s_add_u32 s31, s31, s48
s_add_u32 s31, s31, 8192
v_lshlrev_b32 v55, 5, v1
s_and_b32 s48, s41, 7
s_lshl_b32 s48, s48, 4
s_and_b32 s49, s42, 7
buffer_load_dwordx4 v14, s[60:63], s55 offen offset:2048 lds
s_add_u32 s48, s48, s49
s_lshl_b32 s48, s48, 4
s_add_u32 s48, s48, 4096
v_and_b32 v56, 3, v1
v_lshlrev_b32 v56, 2, v56
v_bfe_u32 v57, v1, 2, 1
v_lshl_add_u32 v56, v57, 11, v56
v_bfe_u32 v57, v1, 3, 1
buffer_load_dwordx4 v15, s[60:63], s55 offen offset:3072 lds
v_lshl_add_u32 v56, v57, 7, v56
v_add_u32 v56, s48, v56
s_buffer_load_dwordx2 s[8:9], s[64:67], s6 offset:60
s_buffer_load_dwordx2 s[8:9], s[64:67], s6 offset:188
s_buffer_load_dwordx2 s[8:9], s[64:67], s6 offset:316
s_add_u32 s6, s6, 0x60000
s_add_u32 s54, s54, 128
s_and_b32 s54, s54, 2047
s_mov_b32 s55, s54
s_add_u32 s53, s53, 32768
s_cmp_ge_u32 s53, 131072
s_cselect_b32 s53, s0, s53
s_waitcnt vmcnt(16)
s_barrier
s_mov_b32 m0, s53
s_add_u32 s1, s53, 16384
buffer_load_dwordx4 v8, s[56:59], s54 offen offset:0 lds
s_buffer_load_dwordx2 s[8:9], s[64:67], s6 offset:60
buffer_load_dwordx4 v9, s[56:59], s54 offen offset:1024 lds
s_buffer_load_dwordx2 s[8:9], s[64:67], s6 offset:188
buffer_load_dwordx4 v10, s[56:59], s54 offen offset:2048 lds
s_buffer_load_dwordx2 s[8:9], s[64:67], s6 offset:316
buffer_load_dwordx4 v11, s[56:59], s54 offen offset:3072 lds
s_add_u32 s6, s6, 0x60000
s_mov_b32 m0, s1
s_nop 0
buffer_load_dwordx4 v12, s[60:63], s55 offen offset:0 lds
buffer_load_dwordx4 v13, s[60:63], s55 offen offset:1024 lds
buffer_load_dwordx4 v14, s[60:63], s55 offen offset:2048 lds
buffer_load_dwordx4 v15, s[60:63], s55 offen offset:3072 lds
s_add_u32 s54, s54, 128
s_and_b32 s54, s54, 2047
s_mov_b32 s55, s54
s_add_u32 s53, s53, 32768
s_cmp_ge_u32 s53, 131072
s_cselect_b32 s53, s0, s53
s_waitcnt vmcnt(16)
s_barrier
s_mov_b32 m0, s53
s_add_u32 s1, s53, 16384
buffer_load_dwordx4 v8, s[56:59], s54 offen offset:0 lds
s_buffer_load_dwordx2 s[8:9], s[64:67], s6 offset:60
buffer_load_dwordx4 v9, s[56:59], s54 offen offset:1024 lds
s_buffer_load_dwordx2 s[8:9], s[64:67], s6 offset:188
buffer_load_dwordx4 v10, s[56:59], s54 offen offset:2048 lds
s_buffer_load_dwordx2 s[8:9], s[64:67], s6 offset:316
buffer_load_dwordx4 v11, s[56:59], s54 offen offset:3072 lds
s_add_u32 s6, s6, 0x60000
s_mov_b32 m0, s1
s_nop 0
buffer_load_dwordx4 v12, s[60:63], s55 offen offset:0 lds
buffer_load_dwordx4 v13, s[60:63], s55 offen offset:1024 lds
buffer_load_dwordx4 v14, s[60:63], s55 offen offset:2048 lds
buffer_load_dwordx4 v15, s[60:63], s55 offen offset:3072 lds
s_add_u32 s54, s54, 128
s_and_b32 s54, s54, 2047
s_mov_b32 s55, s54
s_add_u32 s53, s53, 32768
s_cmp_ge_u32 s53, 131072
s_cselect_b32 s53, s0, s53
s_waitcnt vmcnt(16)
s_barrier
s_cmp_lg_u32 s3, 0
s_cbranch_scc1 Lw_23
s_mov_b64 exec, 0xf
s_mov_b32 s50, 32768
s_waitcnt vmcnt(40)
Lcp_21:
v_cmp_ne_u32 vcc, 1, v53
s_nop 1
s_cbranch_vccz Lco_22
s_sleep 8
buffer_load_dword v53, v54, s[92:95], 0 offen offset:0 sc1
s_waitcnt vmcnt(0)
s_sub_u32 s50, s50, 1
s_cbranch_scc0 Lcp_21
Lco_22:
s_mov_b64 exec, -1
s_mov_b64 exec, 15
buffer_store_dword v6, v7, s[88:91], 0 offen sc1
s_mov_b64 exec, -1
Lw_23:
s_mov_b32 m0, s53
s_add_u32 s1, s53, 16384
buffer_load_dwordx4 v8, s[56:59], s54 offen offset:0 lds
s_buffer_load_dwordx2 s[8:9], s[64:67], s6 offset:60
buffer_load_dwordx4 v9, s[56:59], s54 offen offset:1024 lds
s_buffer_load_dwordx2 s[8:9], s[64:67], s6 offset:188
buffer_load_dwordx4 v10, s[56:59], s54 offen offset:2048 lds
s_buffer_load_dwordx2 s[8:9], s[64:67], s6 offset:316
buffer_load_dwordx4 v11, s[56:59], s54 offen offset:3072 lds
s_add_u32 s6, s6, 0x60000
s_mov_b32 m0, s1
s_nop 0
buffer_load_dwordx4 v12, s[60:63], s55 offen offset:0 lds
buffer_load_dwordx4 v13, s[60:63], s55 offen offset:1024 lds
buffer_load_dwordx4 v14, s[60:63], s55 offen offset:2048 lds
buffer_load_dwordx4 v15, s[60:63], s55 offen offset:3072 lds
s_add_u32 s54, s54, 128
s_and_b32 s54, s54, 2047
s_mov_b32 s55, s54
s_add_u32 s53, s53, 32768
s_cmp_ge_u32 s53, 131072
s_cselect_b32 s53, s0, s53
s_mov_b32 s7, 3
Lr_25:
s_waitcnt vmcnt(16)
s_barrier
s_mov_b32 m0, s53
s_add_u32 s1, s53, 16384
buffer_load_dwordx4 v8, s[56:59], s54 offen offset:0 lds
s_buffer_load_dwordx2 s[8:9], s[64:67], s6 offset:60
buffer_load_dwordx4 v9, s[56:59], s54 offen offset:1024 lds
s_buffer_load_dwordx2 s[8:9], s[64:67], s6 offset:188
buffer_load_dwordx4 v10, s[56:59], s54 offen offset:2048 lds
s_buffer_load_dwordx2 s[8:9], s[64:67], s6 offset:316
buffer_load_dwordx4 v11, s[56:59], s54 offen offset:3072 lds
s_add_u32 s6, s6, 0x60000
s_mov_b32 m0, s1
s_nop 0
buffer_load_dwordx4 v12, s[60:63], s55 offen offset:0 lds
buffer_load_dwordx4 v13, s[60:63], s55 offen offset:1024 lds
buffer_load_dwordx4 v14, s[60:63], s55 offen offset:2048 lds
buffer_load_dwordx4 v15, s[60:63], s55 offen offset:3072 lds
s_add_u32 s54, s54, 128
s_and_b32 s54, s54, 2047
s_mov_b32 s55, s54
s_add_u32 s53, s53, 32768
s_cmp_ge_u32 s53, 131072
s_cselect_b32 s53, s0, s53
s_sub_u32 s7, s7, 1
s_cmp_lg_u32 s7, 0
s_cbranch_scc1 Lr_25
s_waitcnt vmcnt(16)
s_barrier
s_cmp_lg_u32 s3, 0
s_cbranch_scc1 Lw_24
buffer_load_dwordx4 v[40:43], v2, s[88:91], s52 offen sc1
Lw_24:
s_mov_b32 m0, s53
s_add_u32 s1, s53, 16384
buffer_load_dwordx4 v8, s[56:59], s54 offen offset:0 lds
s_buffer_load_dwordx2 s[8:9], s[64:67], s6 offset:60
buffer_load_dwordx4 v9, s[56:59], s54 offen offset:1024 lds
s_buffer_load_dwordx2 s[8:9], s[64:67], s6 offset:188
buffer_load_dwordx4 v10, s[56:59], s54 offen offset:2048 lds
s_buffer_load_dwordx2 s[8:9], s[64:67], s6 offset:316
buffer_load_dwordx4 v11, s[56:59], s54 offen offset:3072 lds
s_add_u32 s6, s6, 0x60000
s_mov_b32 m0, s1
s_nop 0
buffer_load_dwordx4 v12, s[60:63], s55 offen offset:0 lds
buffer_load_dwordx4 v13, s[60:63], s55 offen offset:1024 lds
buffer_load_dwordx4 v14, s[60:63], s55 offen offset:2048 lds
buffer_load_dwordx4 v15, s[60:63], s55 offen offset:3072 lds
s_add_u32 s54, s54, 128
s_and_b32 s54, s54, 2047
s_mov_b32 s55, s54
s_add_u32 s53, s53, 32768
s_cmp_ge_u32 s53, 131072
s_cselect_b32 s53, s0, s53
s_waitcnt vmcnt(16)
s_barrier
s_mov_b32 m0, s53
s_add_u32 s1, s53, 16384
buffer_load_dwordx4 v8, s[56:59], s54 offen offset:0 lds
s_buffer_load_dwordx2 s[8:9], s[64:67], s6 offset:60
buffer_load_dwordx4 v9, s[56:59], s54 offen offset:1024 lds
s_buffer_load_dwordx2 s[8:9], s[64:67], s6 offset:188
buffer_load_dwordx4 v10, s[56:59], s54 offen offset:2048 lds
s_buffer_load_dwordx2 s[8:9], s[64:67], s6 offset:316
buffer_load_dwordx4 v11, s[56:59], s54 offen offset:3072 lds
s_add_u32 s6, s6, 0x60000
s_mov_b32 m0, s1
s_nop 0
buffer_load_dwordx4 v12, s[60:63], s55 offen offset:0 lds
buffer_load_dwordx4 v13, s[60:63], s55 offen offset:1024 lds
buffer_load_dwordx4 v14, s[60:63], s55 offen offset:2048 lds
buffer_load_dwordx4 v15, s[60:63], s55 offen offset:3072 lds
s_add_u32 s54, s54, 128
s_and_b32 s54, s54, 2047
s_mov_b32 s55, s54
s_add_u32 s53, s53, 32768
s_cmp_ge_u32 s53, 131072
s_cselect_b32 s53, s0, s53
s_cmp_lg_u32 s3, 0
s_cbranch_scc1 Lw_28
s_mov_b32 s50, 32768
s_waitcnt vmcnt(16)
Lap_26:
v_and_b32 v40, v40, v41
v_and_b32 v42, v42, v43
v_and_b32 v40, v40, v42
v_cmp_ne_u32 vcc, 1, v40
s_nop 1
s_cbranch_vccz Lao_27
s_sleep 8
buffer_load_dwordx4 v[40:43], v2, s[88:91], s52 offen sc1
s_waitcnt vmcnt(0)
s_sub_u32 s50, s50, 1
s_cbranch_scc0 Lap_26
Lao_27:
Lw_28:
s_cmp_ge_u32 s40, 28
s_cbranch_scc1 Lsp_29
s_waitcnt vmcnt(16)
s_barrier
s_mov_b32 s54, 0
s_mov_b32 s55, 0
s_mov_b32 m0, s53
s_add_u32 s1, s53, 16384
buffer_load_dwordx4 v16, s[64:67], s54 offen offset:0 lds
s_buffer_load_dwordx2 s[8:9], s[64:67], s6 offset:60
buffer_load_dwordx4 v17, s[64:67], s54 offen offset:1024 lds
s_buffer_load_dwordx2 s[8:9], s[64:67], s6 offset:188
buffer_load_dwordx4 v18, s[64:67], s54 offen offset:2048 lds
s_buffer_load_dwordx2 s[8:9], s[64:67], s6 offset:316
buffer_load_dwordx4 v19, s[64:67], s54 offen offset:3072 lds
s_add_u32 s6, s6, 0x60000
s_mov_b32 m0, s1
s_nop 0
buffer_load_dwordx4 v20, s[68:71], s55 offen offset:0 lds
buffer_load_dwordx4 v21, s[68:71], s55 offen offset:1024 lds
buffer_load_dwordx4 v22, s[68:71], s55 offen offset:2048 lds
buffer_load_dwordx4 v23, s[68:71], s55 offen offset:3072 lds
s_add_u32 s54, s54, 0x70000
s_add_u32 s55, s55, 0x20000
s_add_u32 s53, s53, 32768
s_cmp_ge_u32 s53, 131072
s_cselect_b32 s53, s0, s53
s_waitcnt vmcnt(16)
s_barrier
s_mov_b32 m0, s53
s_add_u32 s1, s53, 16384
buffer_load_dwordx4 v16, s[64:67], s54 offen offset:0 lds
s_buffer_load_dwordx2 s[8:9], s[64:67], s6 offset:60
buffer_load_dwordx4 v17, s[64:67], s54 offen offset:1024 lds
s_buffer_load_dwordx2 s[8:9], s[64:67], s6 offset:188
buffer_load_dwordx4 v18, s[64:67], s54 offen offset:2048 lds
s_buffer_load_dwordx2 s[8:9], s[64:67], s6 offset:316
buffer_load_dwordx4 v19, s[64:67], s54 offen offset:3072 lds
s_add_u32 s6, s6, 0x60000
s_mov_b32 m0, s1
s_nop 0
buffer_load_dwordx4 v20, s[68:71], s55 offen offset:0 lds
buffer_load_dwordx4 v21, s[68:71], s55 offen offset:1024 lds
buffer_load_dwordx4 v22, s[68:71], s55 offen offset:2048 lds
buffer_load_dwordx4 v23, s[68:71], s55 offen offset:3072 lds
s_add_u32 s54, s54, 0x70000
s_add_u32 s55, s55, 0x20000
s_add_u32 s53, s53, 32768
s_cmp_ge_u32 s53, 131072
s_cselect_b32 s53, s0, s53
s_waitcnt vmcnt(16)
s_barrier
s_mov_b32 m0, s53
s_add_u32 s1, s53, 16384
buffer_load_dwordx4 v16, s[64:67], s54 offen offset:0 lds
s_buffer_load_dwordx2 s[8:9], s[64:67], s6 offset:60
buffer_load_dwordx4 v17, s[64:67], s54 offen offset:1024 lds
s_buffer_load_dwordx2 s[8:9], s[64:67], s6 offset:188
buffer_load_dwordx4 v18, s[64:67], s54 offen offset:2048 lds
s_buffer_load_dwordx2 s[8:9], s[64:67], s6 offset:316
buffer_load_dwordx4 v19, s[64:67], s54 offen offset:3072 lds
s_add_u32 s6, s6, 0x60000
s_mov_b32 m0, s1
s_nop 0
buffer_load_dwordx4 v20, s[68:71], s55 offen offset:0 lds
buffer_load_dwordx4 v21, s[68:71], s55 offen offset:1024 lds
buffer_load_dwordx4 v22, s[68:71], s55 offen offset:2048 lds
buffer_load_dwordx4 v23, s[68:71], s55 offen offset:3072 lds
s_add_u32 s54, s54, 0x70000
s_add_u32 s55, s55, 0x20000
s_add_u32 s53, s53, 32768
s_cmp_ge_u32 s53, 131072
s_cselect_b32 s53, s0, s53
s_waitcnt vmcnt(16)
s_barrier
s_mov_b32 m0, s53
s_add_u32 s1, s53, 16384
buffer_load_dwordx4 v16, s[64:67], s54 offen offset:0 lds
s_lshl_b32 s6, s2, 2
buffer_load_dwordx4 v17, s[64:67], s54 offen offset:1024 lds
s_add_u32 s6, s6, s3
buffer_load_dwordx4 v18, s[64:67], s54 offen offset:2048 lds
s_mul_i32 s6, s6, 384
buffer_load_dwordx4 v19, s[64:67], s54 offen offset:3072 lds
s_add_u32 s6, s6, 0x5a0000
s_mov_b32 m0, s1
s_nop 0
buffer_load_dwordx4 v20, s[68:71], s55 offen offset:0 lds
s_buffer_load_dwordx2 s[8:9], s[64:67], s6 offset:60
buffer_load_dwordx4 v21, s[68:71], s55 offen offset:1024 lds
s_buffer_load_dwordx2 s[8:9], s[64:67], s6 offset:188
buffer_load_dwordx4 v22, s[68:71], s55 offen offset:2048 lds
s_buffer_load_dwordx2 s[8:9], s[64:67], s6 offset:316
buffer_load_dwordx4 v23, s[68:71], s55 offen offset:3072 lds
s_add_u32 s6, s6, 0x54000
s_add_u32 s54, s54, 0x70000
s_add_u32 s55, s55, 0x20000
s_add_u32 s53, s53, 32768
s_cmp_ge_u32 s53, 131072
s_cselect_b32 s53, s0, s53
s_waitcnt vmcnt(16)
s_barrier
s_mov_b32 m0, s53
s_add_u32 s1, s53, 16384
buffer_load_dwordx4 v16, s[64:67], s54 offen offset:0 lds
s_buffer_load_dwordx2 s[8:9], s[64:67], s6 offset:60
buffer_load_dwordx4 v17, s[64:67], s54 offen offset:1024 lds
s_buffer_load_dwordx2 s[8:9], s[64:67], s6 offset:188
buffer_load_dwordx4 v18, s[64:67], s54 offen offset:2048 lds
s_buffer_load_dwordx2 s[8:9], s[64:67], s6 offset:316
buffer_load_dwordx4 v19, s[64:67], s54 offen offset:3072 lds
s_add_u32 s6, s6, 0x54000
s_mov_b32 m0, s1
s_nop 0
buffer_load_dwordx4 v20, s[68:71], s55 offen offset:0 lds
buffer_load_dwordx4 v21, s[68:71], s55 offen offset:1024 lds
buffer_load_dwordx4 v22, s[68:71], s55 offen offset:2048 lds
buffer_load_dwordx4 v23, s[68:71], s55 offen offset:3072 lds
s_add_u32 s54, s54, 0x70000
s_add_u32 s55, s55, 0x20000
s_add_u32 s53, s53, 32768
s_cmp_ge_u32 s53, 131072
s_cselect_b32 s53, s0, s53
s_waitcnt vmcnt(16)
s_barrier
s_mov_b32 m0, s53
s_add_u32 s1, s53, 16384
buffer_load_dwordx4 v16, s[64:67], s54 offen offset:0 lds
buffer_load_dwordx4 v17, s[64:67], s54 offen offset:1024 lds
buffer_load_dwordx4 v18, s[64:67], s54 offen offset:2048 lds
buffer_load_dwordx4 v19, s[64:67], s54 offen offset:3072 lds
s_mov_b32 m0, s1
s_nop 0
buffer_load_dwordx4 v20, s[68:71], s55 offen offset:0 lds
buffer_load_dwordx4 v21, s[68:71], s55 offen offset:1024 lds
buffer_load_dwordx4 v22, s[68:71], s55 offen offset:2048 lds
buffer_load_dwordx4 v23, s[68:71], s55 offen offset:3072 lds
s_add_u32 s54, s54, 0x70000
s_add_u32 s55, s55, 0x20000
s_add_u32 s53, s53, 32768
s_cmp_ge_u32 s53, 131072
s_cselect_b32 s53, s0, s53
s_waitcnt vmcnt(16)
s_barrier
s_mov_b32 m0, s53
s_add_u32 s1, s53, 16384
buffer_load_dwordx4 v16, s[64:67], s54 offen offset:0 lds
buffer_load_dwordx4 v17, s[64:67], s54 offen offset:1024 lds
buffer_load_dwordx4 v18, s[64:67], s54 offen offset:2048 lds
buffer_load_dwordx4 v19, s[64:67], s54 offen offset:3072 lds
s_mov_b32 m0, s1
s_nop 0
buffer_load_dwordx4 v20, s[68:71], s55 offen offset:0 lds
buffer_load_dwordx4 v21, s[68:71], s55 offen offset:1024 lds
buffer_load_dwordx4 v22, s[68:71], s55 offen offset:2048 lds
buffer_load_dwordx4 v23, s[68:71], s55 offen offset:3072 lds
s_add_u32 s54, s54, 0x70000
s_add_u32 s55, s55, 0x20000
s_add_u32 s53, s53, 32768
s_cmp_ge_u32 s53, 131072
s_cselect_b32 s53, s0, s53
s_waitcnt vmcnt(16)
s_barrier
s_cmp_lg_u32 s22, 0
s_cbranch_scc1 Lm_34
s_lshl_b32 s48, s23, 8
s_add_u32 s48, s48, 0x24d00
v_add_u32 v57, s48, v52
ds_read_b64 v[50:51], v57
ds_read_b64 v[58:59], v57 offset:512
Lm_34:
s_mov_b32 m0, s53
s_add_u32 s1, s53, 16384
buffer_load_dwordx4 v16, s[64:67], s54 offen offset:0 lds
buffer_load_dwordx4 v17, s[64:67], s54 offen offset:1024 lds
buffer_load_dwordx4 v18, s[64:67], s54 offen offset:2048 lds
buffer_load_dwordx4 v19, s[64:67], s54 offen offset:3072 lds
s_mov_b32 m0, s1
s_nop 0
buffer_load_dwordx4 v20, s[68:71], s55 offen offset:0 lds
buffer_load_dwordx4 v21, s[68:71], s55 offen offset:1024 lds
buffer_load_dwordx4 v22, s[68:71], s55 offen offset:2048 lds
buffer_load_dwordx4 v23, s[68:71], s55 offen offset:3072 lds
s_add_u32 s54, s54, 0x70000
s_add_u32 s55, s55, 0x20000
s_add_u32 s53, s53, 32768
s_cmp_ge_u32 s53, 131072
s_cselect_b32 s53, s0, s53
s_cmp_lg_u32 s22, 0
s_cbranch_scc1 Lm_35
s_waitcnt lgkmcnt(0)
v_fma_f32 v60, v44, v50, v58
v_fma_f32 v61, v44, v51, v59
v_fma_f32 v60, -v45, v51, v60
v_fma_f32 v61, v45, v50, v61
s_lshl_b32 s51, s42, 1
s_add_u32 s51, s51, s23
s_lshl_b32 s51, s51, 12
s_lshl_b32 s48, s41, 8
s_add_u32 s51, s51, s48
buffer_store_dwordx2 v[60:61], v52, s[96:99], s51 offen sc1
Lm_35:
s_waitcnt vmcnt(16)
s_barrier
s_mov_b32 m0, s53
s_add_u32 s1, s53, 16384
buffer_load_dwordx4 v16, s[64:67], s54 offen offset:0 lds
s_lshl_b32 s6, s2, 2
s_add_u32 s6, s6, s3
buffer_load_dwordx4 v17, s[64:67], s54 offen offset:1024 lds
s_mul_i32 s6, s6, 768
s_add_u32 s6, s6, 0xa10000
buffer_load_dwordx4 v18, s[64:67], s54 offen offset:2048 lds
s_buffer_load_dwordx2 s[8:9], s[64:67], s6 offset:60
s_buffer_load_dwordx2 s[8:9], s[64:67], s6 offset:188
buffer_load_dwordx4 v19, s[64:67], s54 offen offset:3072 lds
s_buffer_load_dwordx2 s[8:9], s[64:67], s6 offset:316
s_buffer_load_dwordx2 s[8:9], s[64:67], s6 offset:444
s_mov_b32 m0, s1
s_nop 0
buffer_load_dwordx4 v20, s[68:71], s55 offen offset:0 lds
s_buffer_load_dwordx2 s[8:9], s[64:67], s6 offset:572
s_buffer_load_dwordx2 s[8:9], s[64:67], s6 offset:700
buffer_load_dwordx4 v21, s[68:71], s55 offen offset:1024 lds
s_add_u32 s6, s6, 0xa8000
buffer_load_dwordx4 v22, s[68:71], s55 offen offset:2048 lds
buffer_load_dwordx4 v23, s[68:71], s55 offen offset:3072 lds
s_add_u32 s54, s54, 0x70000
s_add_u32 s55, s55, 0x20000
s_add_u32 s53, s53, 32768
s_cmp_ge_u32 s53, 131072
s_cselect_b32 s53, s0, s53
s_mov_b32 s7, 4
Lr_54:
s_waitcnt vmcnt(16)
s_barrier
s_mov_b32 m0, s53
s_add_u32 s1, s53, 16384
buffer_load_dwordx4 v16, s[64:67], s54 offen offset:0 lds
s_buffer_load_dwordx2 s[8:9], s[64:67], s6 offset:60
buffer_load_dwordx4 v17, s[64:67], s54 offen offset:1024 lds
s_buffer_load_dwordx2 s[8:9], s[64:67], s6 offset:188
buffer_load_dwordx4 v18, s[64:67], s54 offen offset:2048 lds
s_buffer_load_dwordx2 s[8:9], s[64:67], s6 offset:316
buffer_load_dwordx4 v19, s[64:67], s54 offen offset:3072 lds
s_buffer_load_dwordx2 s[8:9], s[64:67], s6 offset:444
s_mov_b32 m0, s1
s_nop 0
buffer_load_dwordx4 v20, s[68:71], s55 offen offset:0 lds
s_buffer_load_dwordx2 s[8:9], s[64:67], s6 offset:572
buffer_load_dwordx4 v21, s[68:71], s55 offen offset:1024 lds
s_buffer_load_dwordx2 s[8:9], s[64:67], s6 offset:700
buffer_load_dwordx4 v22, s[68:71], s55 offen offset:2048 lds
s_add_u32 s6, s6, 0xa8000
buffer_load_dwordx4 v23, s[68:71], s55 offen offset:3072 lds
s_add_u32 s54, s54, 0x70000
s_add_u32 s55, s55, 0x20000
s_add_u32 s53, s53, 32768
s_cmp_ge_u32 s53, 131072
s_cselect_b32 s53, s0, s53
s_sub_u32 s7, s7, 1
s_cmp_lg_u32 s7, 0
s_cbranch_scc1 Lr_54
s_waitcnt vmcnt(16)
s_barrier
s_cmp_lg_u32 s22, 0
s_cbranch_scc1 Lm_36
v_lshrrev_b32 v57, 5, v1
v_lshlrev_b32 v57, 3, v57
s_sub_u32 s48, s41, 1
v_sub_u32 v57, s48, v57
v_lshl_add_u32 v57, v57, 8, v52
s_lshl_b32 s51, s42, 1
s_add_u32 s51, s51, s23
s_lshl_b32 s51, s51, 12
buffer_load_dwordx2 v[192:193], v57, s[96:99], s51 offen sc1
v_subrev_u32 v57, 256, v57
buffer_load_dwordx2 v[194:195], v57, s[96:99], s51 offen sc1
v_subrev_u32 v57, 256, v57
buffer_load_dwordx2 v[196:197], v57, s[96:99], s51 offen sc1
v_subrev_u32 v57, 256, v57
buffer_load_dwordx2 v[198:199], v57, s[96:99], s51 offen sc1
v_subrev_u32 v57, 256, v57
buffer_load_dwordx2 v[200:201], v57, s[96:99], s51 offen sc1
v_subrev_u32 v57, 256, v57
buffer_load_dwordx2 v[202:203], v57, s[96:99], s51 offen sc1
v_subrev_u32 v57, 256, v57
buffer_load_dwordx2 v[204:205], v57, s[96:99], s51 offen sc1
v_subrev_u32 v57, 256, v57
buffer_load_dwordx2 v[206:207], v57, s[96:99], s51 offen sc1
Lm_36:
s_mov_b32 m0, s53
s_add_u32 s1, s53, 16384
buffer_load_dwordx4 v16, s[64:67], s54 offen offset:0 lds
s_buffer_load_dwordx2 s[8:9], s[64:67], s6 offset:60
buffer_load_dwordx4 v17, s[64:67], s54 offen offset:1024 lds
s_buffer_load_dwordx2 s[8:9], s[64:67], s6 offset:188
buffer_load_dwordx4 v18, s[64:67], s54 offen offset:2048 lds
s_buffer_load_dwordx2 s[8:9], s[64:67], s6 offset:316
buffer_load_dwordx4 v19, s[64:67], s54 offen offset:3072 lds
s_buffer_load_dwordx2 s[8:9], s[64:67], s6 offset:444
s_mov_b32 m0, s1
s_nop 0
buffer_load_dwordx4 v20, s[68:71], s55 offen offset:0 lds
s_buffer_load_dwordx2 s[8:9], s[64:67], s6 offset:572
buffer_load_dwordx4 v21, s[68:71], s55 offen offset:1024 lds
s_buffer_load_dwordx2 s[8:9], s[64:67], s6 offset:700
buffer_load_dwordx4 v22, s[68:71], s55 offen offset:2048 lds
s_add_u32 s6, s6, 0xa8000
buffer_load_dwordx4 v23, s[68:71], s55 offen offset:3072 lds
s_add_u32 s54, s54, 0x70000
s_add_u32 s55, s55, 0x20000
s_add_u32 s53, s53, 32768
s_cmp_ge_u32 s53, 131072
s_cselect_b32 s53, s0, s53
s_waitcnt vmcnt(16)
s_barrier
s_mov_b32 m0, s53
s_add_u32 s1, s53, 16384
buffer_load_dwordx4 v16, s[64:67], s54 offen offset:0 lds
buffer_load_dwordx4 v17, s[64:67], s54 offen offset:1024 lds
buffer_load_dwordx4 v18, s[64:67], s54 offen offset:2048 lds
buffer_load_dwordx4 v19, s[64:67], s54 offen offset:3072 lds
s_mov_b32 m0, s1
s_nop 0
buffer_load_dwordx4 v20, s[68:71], s55 offen offset:0 lds
buffer_load_dwordx4 v21, s[68:71], s55 offen offset:1024 lds
buffer_load_dwordx4 v22, s[68:71], s55 offen offset:2048 lds
buffer_load_dwordx4 v23, s[68:71], s55 offen offset:3072 lds
s_add_u32 s54, s54, 0x70000
s_add_u32 s55, s55, 0x20000
s_add_u32 s53, s53, 32768
s_cmp_ge_u32 s53, 131072
s_cselect_b32 s53, s0, s53
s_waitcnt vmcnt(16)
s_barrier
s_mov_b32 m0, s53
s_add_u32 s1, s53, 16384
buffer_load_dwordx4 v16, s[64:67], s54 offen offset:0 lds
buffer_load_dwordx4 v17, s[64:67], s54 offen offset:1024 lds
buffer_load_dwordx4 v18, s[64:67], s54 offen offset:2048 lds
buffer_load_dwordx4 v19, s[64:67], s54 offen offset:3072 lds
s_mov_b32 m0, s1
s_nop 0
buffer_load_dwordx4 v20, s[68:71], s55 offen offset:0 lds
buffer_load_dwordx4 v21, s[68:71], s55 offen offset:1024 lds
buffer_load_dwordx4 v22, s[68:71], s55 offen offset:2048 lds
buffer_load_dwordx4 v23, s[68:71], s55 offen offset:3072 lds
s_add_u32 s54, s54, 0x70000
s_add_u32 s55, s55, 0x20000
s_add_u32 s53, s53, 32768
s_cmp_ge_u32 s53, 131072
s_cselect_b32 s53, s0, s53
s_waitcnt vmcnt(16)
s_barrier
s_cmp_lg_u32 s22, 0
s_cbranch_scc1 Lm_39
s_mov_b32 s50, 32768
Lgp_37:
v_max_u32 v57, v192, v193
v_max3_u32 v57, v57, v194, v195
v_max3_u32 v57, v57, v196, v197
v_max3_u32 v57, v57, v198, v199
v_max3_u32 v57, v57, v200, v201
v_max3_u32 v57, v57, v202, v203
v_max3_u32 v57, v57, v204, v205
v_max3_u32 v57, v57, v206, v207
v_cmp_eq_u32 vcc, -1, v57
s_nop 1
s_cbranch_vccz Lgo_38
s_sleep 16
v_lshrrev_b32 v57, 5, v1
v_lshlrev_b32 v57, 3, v57
s_sub_u32 s48, s41, 1
v_sub_u32 v57, s48, v57
v_lshl_add_u32 v57, v57, 8, v52
s_lshl_b32 s51, s42, 1
s_add_u32 s51, s51, s23
s_lshl_b32 s51, s51, 12
buffer_load_dwordx2 v[192:193], v57, s[96:99], s51 offen sc1
v_subrev_u32 v57, 256, v57
buffer_load_dwordx2 v[194:195], v57, s[96:99], s51 offen sc1
v_subrev_u32 v57, 256, v57
buffer_load_dwordx2 v[196:197], v57, s[96:99], s51 offen sc1
v_subrev_u32 v57, 256, v57
buffer_load_dwordx2 v[198:199], v57, s[96:99], s51 offen sc1
v_subrev_u32 v57, 256, v57
buffer_load_dwordx2 v[200:201], v57, s[96:99], s51 offen sc1
v_subrev_u32 v57, 256, v57
buffer_load_dwordx2 v[202:203], v57, s[96:99], s51 offen sc1
v_subrev_u32 v57, 256, v57
buffer_load_dwordx2 v[204:205], v57, s[96:99], s51 offen sc1
v_subrev_u32 v57, 256, v57
buffer_load_dwordx2 v[206:207], v57, s[96:99], s51 offen sc1
s_waitcnt vmcnt(0)
s_sub_u32 s50, s50, 1
s_cbranch_scc0 Lgp_37
Lgo_38:
Lm_39:
s_mov_b32 m0, s53
s_add_u32 s1, s53, 16384
buffer_load_dwordx4 v16, s[64:67], s54 offen offset:0 lds
v_fma_f32 v58, v46, v206, v204
v_fma_f32 v59, v46, v207, v205
v_fma_f32 v58, -v47, v207, v58
v_fma_f32 v59, v47, v206, v59
v_fma_f32 v60, v46, v58, v202
v_fma_f32 v61, v46, v59, v203
v_fma_f32 v60, -v47, v59, v60
buffer_load_dwordx4 v17, s[64:67], s54 offen offset:1024 lds
v_fma_f32 v61, v47, v58, v61
v_fma_f32 v58, v46, v60, v200
v_fma_f32 v59, v46, v61, v201
v_fma_f32 v58, -v47, v61, v58
v_fma_f32 v59, v47, v60, v59
v_fma_f32 v60, v46, v58, v198
v_fma_f32 v61, v46, v59, v199
buffer_load_dwordx4 v18, s[64:67], s54 offen offset:2048 lds
v_fma_f32 v60, -v47, v59, v60
v_fma_f32 v61, v47, v58, v61
v_fma_f32 v58, v46, v60, v196
v_fma_f32 v59, v46, v61, v197
v_fma_f32 v58, -v47, v61, v58
v_fma_f32 v59, v47, v60, v59
v_fma_f32 v60, v46, v58, v194
buffer_load_dwordx4 v19, s[64:67], s54 offen offset:3072 lds
v_fma_f32 v61, v46, v59, v195
v_fma_f32 v60, -v47, v59, v60
v_fma_f32 v61, v47, v58, v61
v_fma_f32 v58, v46, v60, v192
v_fma_f32 v59, v46, v61, v193
v_fma_f32 v58, -v47, v61, v58
v_fma_f32 v59, v47, v60, v59
s_mov_b32 m0, s1
s_nop 0
buffer_load_dwordx4 v20, s[68:71], s55 offen offset:0 lds
v_mov_b32 v60, v58
v_mov_b32 v61, v59
s_nop 1
v_permlane32_swap_b32 v60, v58
v_permlane32_swap_b32 v61, v59
s_nop 1
v_fma_f32 v62, v48, v58, v60
buffer_load_dwordx4 v21, s[68:71], s55 offen offset:1024 lds
v_fma_f32 v63, v48, v59, v61
v_fma_f32 v62, -v49, v59, v62
v_fma_f32 v63, v49, v58, v63
v_fma_f32 v58, v44, v62, v50
v_fma_f32 v59, v44, v63, v51
v_fma_f32 v58, -v45, v63, v58
v_fma_f32 v59, v45, v62, v59
buffer_load_dwordx4 v22, s[68:71], s55 offen offset:2048 lds
s_mul_i32 s48, s22, 20736
s_sub_u32 s48, 0x25100, s48
s_lshl_b32 s49, s23, 8
s_add_u32 s48, s48, s49
v_add_u32 v57, s48, v52
ds_write_b64 v57, v[62:63]
ds_write_b64 v57, v[58:59] offset:512
buffer_load_dwordx4 v23, s[68:71], s55 offen offset:3072 lds
s_add_u32 s54, s54, 0x70000
s_add_u32 s55, s55, 0x20000
s_add_u32 s53, s53, 32768
s_cmp_ge_u32 s53, 131072
s_cselect_b32 s53, s0, s53
s_waitcnt vmcnt(16) lgkmcnt(0)
s_barrier
s_mov_b32 m0, s53
s_add_u32 s1, s53, 16384
buffer_load_dwordx4 v16, s[64:67], s54 offen offset:0 lds
s_lshl_b32 s6, s2, 2
s_add_u32 s6, s6, s3
buffer_load_dwordx4 v17, s[64:67], s54 offen offset:1024 lds
s_lshr_b32 s48, s6, 7
s_and_b32 s6, s6, 127
buffer_load_dwordx4 v18, s[64:67], s54 offen offset:2048 lds
s_lshl_b32 s6, s6, 9
s_lshl_b32 s48, s48, 18
buffer_load_dwordx4 v19, s[64:67], s54 offen offset:3072 lds
s_add_u32 s6, s6, s48
s_add_u32 s6, s6, 0x0
s_mov_b32 m0, s1
s_nop 0
buffer_load_dwordx4 v20, s[68:71], s55 offen offset:0 lds
s_buffer_load_dwordx2 s[8:9], s[84:87], s6 offset:60
s_buffer_load_dwordx2 s[8:9], s[84:87], s6 offset:188
buffer_load_dwordx4 v21, s[68:71], s55 offen offset:1024 lds
s_buffer_load_dwordx2 s[8:9], s[84:87], s6 offset:316
s_buffer_load_dwordx2 s[8:9], s[84:87], s6 offset:444
buffer_load_dwordx4 v22, s[68:71], s55 offen offset:2048 lds
s_add_u32 s6, s6, 0x1c0000
buffer_load_dwordx4 v23, s[68:71], s55 offen offset:3072 lds
s_add_u32 s54, s54, 0x70000
s_add_u32 s55, s55, 0x20000
s_add_u32 s53, s53, 32768
s_cmp_ge_u32 s53, 131072
s_cselect_b32 s53, s0, s53
s_waitcnt vmcnt(16)
s_barrier
s_mov_b32 m0, s53
s_add_u32 s1, s53, 16384
buffer_load_dwordx4 v16, s[64:67], s54 offen offset:0 lds
buffer_load_dwordx4 v17, s[64:67], s54 offen offset:1024 lds
buffer_load_dwordx4 v18, s[64:67], s54 offen offset:2048 lds
buffer_load_dwordx4 v19, s[64:67], s54 offen offset:3072 lds
s_mov_b32 m0, s1
s_nop 0
buffer_load_dwordx4 v20, s[68:71], s55 offen offset:0 lds
buffer_load_dwordx4 v21, s[68:71], s55 offen offset:1024 lds
buffer_load_dwordx4 v22, s[68:71], s55 offen offset:2048 lds
buffer_load_dwordx4 v23, s[68:71], s55 offen offset:3072 lds
s_add_u32 s54, s54, 0x70000
s_add_u32 s55, s55, 0x20000
s_add_u32 s53, s53, 32768
s_cmp_ge_u32 s53, 131072
s_cselect_b32 s53, s0, s53
s_waitcnt vmcnt(16)
s_barrier
s_mov_b32 m0, s53
s_add_u32 s1, s53, 16384
buffer_load_dwordx4 v16, s[64:67], s54 offen offset:0 lds
s_buffer_load_dwordx2 s[8:9], s[84:87], s6 offset:60
buffer_load_dwordx4 v17, s[64:67], s54 offen offset:1024 lds
s_buffer_load_dwordx2 s[8:9], s[84:87], s6 offset:188
buffer_load_dwordx4 v18, s[64:67], s54 offen offset:2048 lds
s_buffer_load_dwordx2 s[8:9], s[84:87], s6 offset:316
buffer_load_dwordx4 v19, s[64:67], s54 offen offset:3072 lds
s_buffer_load_dwordx2 s[8:9], s[84:87], s6 offset:444
s_mov_b32 m0, s1
s_nop 0
buffer_load_dwordx4 v20, s[68:71], s55 offen offset:0 lds
s_add_u32 s6, s6, 0x1c0000
buffer_load_dwordx4 v21, s[68:71], s55 offen offset:1024 lds
buffer_load_dwordx4 v22, s[68:71], s55 offen offset:2048 lds
buffer_load_dwordx4 v23, s[68:71], s55 offen offset:3072 lds
s_add_u32 s54, s54, 0x70000
s_add_u32 s55, s55, 0x20000
s_add_u32 s53, s53, 32768
s_cmp_ge_u32 s53, 131072
s_cselect_b32 s53, s0, s53
s_waitcnt vmcnt(16)
s_barrier
s_mov_b32 m0, s53
s_add_u32 s1, s53, 16384
buffer_load_dwordx4 v16, s[64:67], s54 offen offset:0 lds
buffer_load_dwordx4 v17, s[64:67], s54 offen offset:1024 lds
buffer_load_dwordx4 v18, s[64:67], s54 offen offset:2048 lds
buffer_load_dwordx4 v19, s[64:67], s54 offen offset:3072 lds
s_mov_b32 m0, s1
s_nop 0
buffer_load_dwordx4 v20, s[68:71], s55 offen offset:0 lds
buffer_load_dwordx4 v21, s[68:71], s55 offen offset:1024 lds
buffer_load_dwordx4 v22, s[68:71], s55 offen offset:2048 lds
buffer_load_dwordx4 v23, s[68:71], s55 offen offset:3072 lds
s_add_u32 s54, s54, 0x70000
s_add_u32 s55, s55, 0x20000
s_add_u32 s53, s53, 32768
s_cmp_ge_u32 s53, 131072
s_cselect_b32 s53, s0, s53
s_waitcnt vmcnt(16)
s_barrier
s_mov_b32 m0, s53
s_add_u32 s1, s53, 16384
buffer_load_dwordx4 v16, s[64:67], s54 offen offset:0 lds
s_buffer_load_dwordx2 s[8:9], s[84:87], s6 offset:60
buffer_load_dwordx4 v17, s[64:67], s54 offen offset:1024 lds
s_buffer_load_dwordx2 s[8:9], s[84:87], s6 offset:188
buffer_load_dwordx4 v18, s[64:67], s54 offen offset:2048 lds
s_buffer_load_dwordx2 s[8:9], s[84:87], s6 offset:316
buffer_load_dwordx4 v19, s[64:67], s54 offen offset:3072 lds
s_buffer_load_dwordx2 s[8:9], s[84:87], s6 offset:444
s_mov_b32 m0, s1
s_nop 0
buffer_load_dwordx4 v20, s[68:71], s55 offen offset:0 lds
s_add_u32 s6, s6, 0x1c0000
buffer_load_dwordx4 v21, s[68:71], s55 offen offset:1024 lds
buffer_load_dwordx4 v22, s[68:71], s55 offen offset:2048 lds
buffer_load_dwordx4 v23, s[68:71], s55 offen offset:3072 lds
s_add_u32 s54, s54, 0x70000
s_add_u32 s55, s55, 0x20000
s_add_u32 s53, s53, 32768
s_cmp_ge_u32 s53, 131072
s_cselect_b32 s53, s0, s53
s_waitcnt vmcnt(16)
s_barrier
s_mov_b32 m0, s53
s_add_u32 s1, s53, 16384
buffer_load_dwordx4 v16, s[64:67], s54 offen offset:0 lds
buffer_load_dwordx4 v17, s[64:67], s54 offen offset:1024 lds
buffer_load_dwordx4 v18, s[64:67], s54 offen offset:2048 lds
buffer_load_dwordx4 v19, s[64:67], s54 offen offset:3072 lds
s_mov_b32 m0, s1
s_nop 0
buffer_load_dwordx4 v20, s[68:71], s55 offen offset:0 lds
buffer_load_dwordx4 v21, s[68:71], s55 offen offset:1024 lds
buffer_load_dwordx4 v22, s[68:71], s55 offen offset:2048 lds
buffer_load_dwordx4 v23, s[68:71], s55 offen offset:3072 lds
s_add_u32 s54, s54, 0x70000
s_add_u32 s55, s55, 0x20000
s_add_u32 s53, s53, 32768
s_cmp_ge_u32 s53, 131072
s_cselect_b32 s53, s0, s53
s_waitcnt vmcnt(16)
s_barrier
s_mov_b32 m0, s53
s_add_u32 s1, s53, 16384
buffer_load_dwordx4 v16, s[64:67], s54 offen offset:0 lds
s_buffer_load_dwordx2 s[8:9], s[84:87], s6 offset:60
buffer_load_dwordx4 v17, s[64:67], s54 offen offset:1024 lds
s_buffer_load_dwordx2 s[8:9], s[84:87], s6 offset:188
buffer_load_dwordx4 v18, s[64:67], s54 offen offset:2048 lds
s_buffer_load_dwordx2 s[8:9], s[84:87], s6 offset:316
buffer_load_dwordx4 v19, s[64:67], s54 offen offset:3072 lds
s_buffer_load_dwordx2 s[8:9], s[84:87], s6 offset:444
s_mov_b32 m0, s1
s_nop 0
buffer_load_dwordx4 v20, s[68:71], s55 offen offset:0 lds
s_add_u32 s6, s6, 0x1c0000
buffer_load_dwordx4 v21, s[68:71], s55 offen offset:1024 lds
buffer_load_dwordx4 v22, s[68:71], s55 offen offset:2048 lds
buffer_load_dwordx4 v23, s[68:71], s55 offen offset:3072 lds
s_add_u32 s54, s54, 0x70000
s_add_u32 s55, s55, 0x20000
s_add_u32 s53, s53, 32768
s_cmp_ge_u32 s53, 131072
s_cselect_b32 s53, s0, s53
s_waitcnt vmcnt(16)
s_barrier
s_mov_b32 m0, s53
s_add_u32 s1, s53, 16384
buffer_load_dwordx4 v16, s[64:67], s54 offen offset:0 lds
buffer_load_dwordx4 v17, s[64:67], s54 offen offset:1024 lds
buffer_load_dwordx4 v18, s[64:67], s54 offen offset:2048 lds
buffer_load_dwordx4 v19, s[64:67], s54 offen offset:3072 lds
s_mov_b32 m0, s1
s_nop 0
buffer_load_dwordx4 v20, s[68:71], s55 offen offset:0 lds
buffer_load_dwordx4 v21, s[68:71], s55 offen offset:1024 lds
buffer_load_dwordx4 v22, s[68:71], s55 offen offset:2048 lds
buffer_load_dwordx4 v23, s[68:71], s55 offen offset:3072 lds
s_add_u32 s54, s54, 0x70000
s_add_u32 s55, s55, 0x20000
s_add_u32 s53, s53, 32768
s_cmp_ge_u32 s53, 131072
s_cselect_b32 s53, s0, s53
s_waitcnt vmcnt(16)
s_barrier
s_mov_b32 m0, s53
s_add_u32 s1, s53, 16384
buffer_load_dwordx4 v16, s[64:67], s54 offen offset:0 lds
s_buffer_load_dwordx2 s[8:9], s[84:87], s6 offset:60
buffer_load_dwordx4 v17, s[64:67], s54 offen offset:1024 lds
s_buffer_load_dwordx2 s[8:9], s[84:87], s6 offset:188
buffer_load_dwordx4 v18, s[64:67], s54 offen offset:2048 lds
s_buffer_load_dwordx2 s[8:9], s[84:87], s6 offset:316
buffer_load_dwordx4 v19, s[64:67], s54 offen offset:3072 lds
s_buffer_load_dwordx2 s[8:9], s[84:87], s6 offset:444
s_mov_b32 m0, s1
s_nop 0
buffer_load_dwordx4 v20, s[68:71], s55 offen offset:0 lds
s_add_u32 s6, s6, 0x1c0000
buffer_load_dwordx4 v21, s[68:71], s55 offen offset:1024 lds
buffer_load_dwordx4 v22, s[68:71], s55 offen offset:2048 lds
buffer_load_dwordx4 v23, s[68:71], s55 offen offset:3072 lds
s_add_u32 s54, s54, 0x70000
s_add_u32 s55, s55, 0x20000
s_add_u32 s53, s53, 32768
s_cmp_ge_u32 s53, 131072
s_cselect_b32 s53, s0, s53
s_waitcnt vmcnt(16)
s_barrier
s_mov_b32 m0, s53
s_add_u32 s1, s53, 16384
buffer_load_dwordx4 v16, s[64:67], s54 offen offset:0 lds
buffer_load_dwordx4 v17, s[64:67], s54 offen offset:1024 lds
buffer_load_dwordx4 v18, s[64:67], s54 offen offset:2048 lds
buffer_load_dwordx4 v19, s[64:67], s54 offen offset:3072 lds
s_mov_b32 m0, s1
s_nop 0
buffer_load_dwordx4 v20, s[68:71], s55 offen offset:0 lds
buffer_load_dwordx4 v21, s[68:71], s55 offen offset:1024 lds
buffer_load_dwordx4 v22, s[68:71], s55 offen offset:2048 lds
buffer_load_dwordx4 v23, s[68:71], s55 offen offset:3072 lds
s_add_u32 s54, s54, 0x70000
s_add_u32 s55, s55, 0x20000
s_add_u32 s53, s53, 32768
s_cmp_ge_u32 s53, 131072
s_cselect_b32 s53, s0, s53
s_waitcnt vmcnt(16)
s_barrier
s_mov_b32 m0, s53
s_add_u32 s1, s53, 16384
buffer_load_dwordx4 v16, s[64:67], s54 offen offset:0 lds
s_buffer_load_dwordx2 s[8:9], s[84:87], s6 offset:60
buffer_load_dwordx4 v17, s[64:67], s54 offen offset:1024 lds
s_buffer_load_dwordx2 s[8:9], s[84:87], s6 offset:188
buffer_load_dwordx4 v18, s[64:67], s54 offen offset:2048 lds
s_buffer_load_dwordx2 s[8:9], s[84:87], s6 offset:316
buffer_load_dwordx4 v19, s[64:67], s54 offen offset:3072 lds
s_buffer_load_dwordx2 s[8:9], s[84:87], s6 offset:444
s_mov_b32 m0, s1
s_nop 0
buffer_load_dwordx4 v20, s[68:71], s55 offen offset:0 lds
s_add_u32 s6, s6, 0x1c0000
buffer_load_dwordx4 v21, s[68:71], s55 offen offset:1024 lds
buffer_load_dwordx4 v22, s[68:71], s55 offen offset:2048 lds
buffer_load_dwordx4 v23, s[68:71], s55 offen offset:3072 lds
s_add_u32 s54, s54, 0x70000
s_add_u32 s55, s55, 0x20000
s_add_u32 s53, s53, 32768
s_cmp_ge_u32 s53, 131072
s_cselect_b32 s53, s0, s53
s_mov_b32 s56, s26
s_mov_b32 s57, s27
s_mov_b32 s58, 0x1c00
s_mov_b32 s59, 0x20000
v_lshrrev_b32 v136, 5, v1
v_lshlrev_b32 v141, 4, v136
s_lshl_b32 s51, s44, 1
s_add_u32 s51, s51, s22
s_lshl_b32 s50, s51, 7
buffer_load_dwordx4 v[96:99], v141, s[56:59], s50 offen offset:32
buffer_load_dwordx4 v[100:103], v141, s[56:59], s50 offen offset:96
v_lshlrev_b32 v136, 10, v136
v_and_b32 v138, 31, v1
v_add_u32 v136, v136, v138
v_lshlrev_b32 v136, 4, v136
s_lshl_b32 s51, s51, 13
s_lshl_b32 s50, s43, 1
s_add_u32 s50, s50, s23
s_lshl_b32 s50, s50, 6
s_add_u32 s51, s51, s50
s_lshl_b32 s60, s51, 4
s_mov_b32 s62, 0xbdd2d3e8
v_mov_b32 v138, 0xc0135761
v_mov_b32 v140, 0xffff0000
s_waitcnt vmcnt(18)
s_barrier
s_mov_b32 m0, s53
s_add_u32 s1, s53, 16384
buffer_load_dwordx4 v16, s[64:67], s54 offen offset:0 lds
buffer_load_dwordx4 v17, s[64:67], s54 offen offset:1024 lds
buffer_load_dwordx4 v18, s[64:67], s54 offen offset:2048 lds
buffer_load_dwordx4 v19, s[64:67], s54 offen offset:3072 lds
s_mov_b32 m0, s1
s_nop 0
buffer_load_dwordx4 v20, s[68:71], s55 offen offset:0 lds
buffer_load_dwordx4 v21, s[68:71], s55 offen offset:1024 lds
buffer_load_dwordx4 v22, s[68:71], s55 offen offset:2048 lds
buffer_load_dwordx4 v23, s[68:71], s55 offen offset:3072 lds
s_add_u32 s54, s54, 0x70000
s_add_u32 s55, s55, 0x20000
s_add_u32 s53, s53, 32768
s_cmp_ge_u32 s53, 131072
s_cselect_b32 s53, s0, s53
s_waitcnt vmcnt(18)
s_barrier
s_mov_b32 m0, s53
s_add_u32 s1, s53, 16384
buffer_load_dwordx4 v16, s[64:67], s54 offen offset:0 lds
s_buffer_load_dwordx2 s[8:9], s[84:87], s6 offset:60
buffer_load_dwordx4 v17, s[64:67], s54 offen offset:1024 lds
s_buffer_load_dwordx2 s[8:9], s[84:87], s6 offset:188
buffer_load_dwordx4 v18, s[64:67], s54 offen offset:2048 lds
s_buffer_load_dwordx2 s[8:9], s[84:87], s6 offset:316
buffer_load_dwordx4 v19, s[64:67], s54 offen offset:3072 lds
s_buffer_load_dwordx2 s[8:9], s[84:87], s6 offset:444
s_mov_b32 m0, s1
s_nop 0
buffer_load_dwordx4 v20, s[68:71], s55 offen offset:0 lds
s_add_u32 s6, s6, 0x1c0000
buffer_load_dwordx4 v21, s[68:71], s55 offen offset:1024 lds
buffer_load_dwordx4 v22, s[68:71], s55 offen offset:2048 lds
buffer_load_dwordx4 v23, s[68:71], s55 offen offset:3072 lds
s_add_u32 s54, s54, 0x70000
s_add_u32 s55, s55, 0x20000
s_add_u32 s53, s53, 32768
s_cmp_ge_u32 s53, 131072
s_cselect_b32 s53, s0, s53
s_waitcnt vmcnt(18)
s_barrier
s_cmp_lg_u32 s3, 0
s_cbranch_scc1 Lw_40
s_mov_b32 exec_lo, -1
s_mov_b32 exec_hi, 0
buffer_load_dword v53, v54, s[88:91], s30 offen offset:0 sc1
s_mov_b64 exec, -1
Lw_40:
s_mov_b32 m0, s53
s_add_u32 s1, s53, 16384
buffer_load_dwordx4 v16, s[64:67], s54 offen offset:0 lds
buffer_load_dwordx4 v17, s[64:67], s54 offen offset:1024 lds
buffer_load_dwordx4 v18, s[64:67], s54 offen offset:2048 lds
buffer_load_dwordx4 v19, s[64:67], s54 offen offset:3072 lds
s_mov_b32 m0, s1
s_nop 0
buffer_load_dwordx4 v20, s[68:71], s55 offen offset:0 lds
buffer_load_dwordx4 v21, s[68:71], s55 offen offset:1024 lds
buffer_load_dwordx4 v22, s[68:71], s55 offen offset:2048 lds
buffer_load_dwordx4 v23, s[68:71], s55 offen offset:3072 lds
s_add_u32 s54, s54, 0x70000
s_add_u32 s55, s55, 0x20000
s_add_u32 s53, s53, 32768
s_cmp_ge_u32 s53, 131072
s_cselect_b32 s53, s0, s53
s_waitcnt vmcnt(16)
s_barrier
s_mov_b32 m0, s53
s_add_u32 s1, s53, 16384
buffer_load_dwordx4 v16, s[64:67], s54 offen offset:0 lds
s_buffer_load_dwordx2 s[8:9], s[84:87], s6 offset:60
buffer_load_dwordx4 v17, s[64:67], s54 offen offset:1024 lds
s_buffer_load_dwordx2 s[8:9], s[84:87], s6 offset:188
buffer_load_dwordx4 v18, s[64:67], s54 offen offset:2048 lds
s_buffer_load_dwordx2 s[8:9], s[84:87], s6 offset:316
buffer_load_dwordx4 v19, s[64:67], s54 offen offset:3072 lds
s_buffer_load_dwordx2 s[8:9], s[84:87], s6 offset:444
s_mov_b32 m0, s1
s_nop 0
buffer_load_dwordx4 v20, s[68:71], s55 offen offset:0 lds
s_add_u32 s6, s6, 0xff3d0000
buffer_load_dwordx4 v21, s[68:71], s55 offen offset:1024 lds
buffer_load_dwordx4 v22, s[68:71], s55 offen offset:2048 lds
buffer_load_dwordx4 v23, s[68:71], s55 offen offset:3072 lds
s_add_u32 s54, s54, 0x70000
s_add_u32 s55, s55, 0x20000
s_add_u32 s53, s53, 32768
s_cmp_ge_u32 s53, 131072
s_cselect_b32 s53, s0, s53
s_cmp_lg_u32 s3, 0
s_cbranch_scc1 Lw_43
s_mov_b32 exec_lo, -1
s_mov_b32 exec_hi, 0
s_mov_b32 s50, 32768
s_waitcnt vmcnt(16)
Lcp_41:
v_cmp_ne_u32 vcc, 1, v53
s_nop 1
s_cbranch_vccz Lco_42
s_sleep 8
buffer_load_dword v53, v54, s[88:91], s30 offen offset:0 sc1
s_waitcnt vmcnt(0)
s_sub_u32 s50, s50, 1
s_cbranch_scc0 Lcp_41
Lco_42:
s_mov_b64 exec, -1
Lw_43:
s_waitcnt vmcnt(16)
s_barrier
s_and_b32 s54, s45, 1
s_lshl_b32 s54, s54, 10
s_lshl_b32 s55, s45, 21
s_cmp_ge_u32 s45, 2
s_cselect_b32 s13, 0x40000, 0
s_add_u32 s54, s54, s13
s_cmp_ge_u32 s45, 2
s_cselect_b32 s13, 0xfff80000, 0
s_add_u32 s13, s13, 0x40000
s_mov_b32 m0, s53
s_add_u32 s1, s53, 16384
s_add_u32 s10, s54, s13
s_add_u32 s11, s53, 32768
buffer_load_dwordx4 v24, s[72:75], s54 offen offset:0 lds
buffer_load_dwordx4 v25, s[72:75], s54 offen offset:1024 lds
buffer_load_dwordx4 v26, s[72:75], s54 offen offset:2048 lds
buffer_load_dwordx4 v27, s[72:75], s54 offen offset:3072 lds
s_mov_b32 m0, s1
s_nop 0
buffer_load_dwordx4 v24, s[72:75], s10 offen offset:0 lds
buffer_load_dwordx4 v25, s[72:75], s10 offen offset:1024 lds
buffer_load_dwordx4 v26, s[72:75], s10 offen offset:2048 lds
buffer_load_dwordx4 v27, s[72:75], s10 offen offset:3072 lds
s_mov_b32 m0, s11
s_nop 0
buffer_load_dwordx4 v28, s[76:79], s55 offen offset:0 lds
buffer_load_dwordx4 v29, s[76:79], s55 offen offset:1024 lds
buffer_load_dwordx4 v30, s[76:79], s55 offen offset:2048 lds
buffer_load_dwordx4 v31, s[76:79], s55 offen offset:3072 lds
s_add_u32 s54, s54, 0x80
s_add_u32 s55, s55, 0x40000
s_add_u32 s53, s53, 49152
s_cmp_ge_u32 s53, 147456
s_cselect_b32 s53, s0, s53
s_mov_b32 m0, s53
s_add_u32 s1, s53, 16384
s_add_u32 s10, s54, s13
s_add_u32 s11, s0, 0x24000
s_mov_b32 m0, s11
s_nop 0
buffer_load_dwordx4 v28, s[76:79], s55 offen offset:0 lds
buffer_load_dwordx4 v29, s[76:79], s55 offen offset:1024 lds
buffer_load_dwordx4 v30, s[76:79], s55 offen offset:2048 lds
buffer_load_dwordx4 v31, s[76:79], s55 offen offset:3072 lds
s_waitcnt vmcnt(24)
s_barrier
s_mov_b32 m0, s53
s_add_u32 s1, s53, 16384
s_add_u32 s10, s54, s13
s_add_u32 s11, s53, 32768
buffer_load_dwordx4 v24, s[72:75], s54 offen offset:0 lds
buffer_load_dwordx4 v25, s[72:75], s54 offen offset:1024 lds
buffer_load_dwordx4 v26, s[72:75], s54 offen offset:2048 lds
buffer_load_dwordx4 v27, s[72:75], s54 offen offset:3072 lds
s_mov_b32 m0, s1
s_nop 0
buffer_load_dwordx4 v24, s[72:75], s10 offen offset:0 lds
buffer_load_dwordx4 v25, s[72:75], s10 offen offset:1024 lds
buffer_load_dwordx4 v26, s[72:75], s10 offen offset:2048 lds
buffer_load_dwordx4 v27, s[72:75], s10 offen offset:3072 lds
s_add_u32 s54, s54, 0x80
s_add_u32 s55, s55, 0x40000
s_add_u32 s53, s53, 49152
s_cmp_ge_u32 s53, 147456
s_cselect_b32 s53, s0, s53
s_waitcnt vmcnt(24)
s_barrier
s_mov_b32 m0, s53
s_add_u32 s1, s53, 16384
s_add_u32 s10, s54, s13
s_add_u32 s11, s53, 32768
buffer_load_dwordx4 v24, s[72:75], s54 offen offset:0 lds
buffer_load_dwordx4 v25, s[72:75], s54 offen offset:1024 lds
buffer_load_dwordx4 v26, s[72:75], s54 offen offset:2048 lds
buffer_load_dwordx4 v27, s[72:75], s54 offen offset:3072 lds
s_waitcnt vmcnt(16)
s_barrier
s_mov_b32 m0, s53
s_add_u32 s1, s53, 16384
s_add_u32 s10, s54, s13
s_add_u32 s11, s53, 32768
s_mov_b32 m0, s1
s_nop 0
buffer_load_dwordx4 v24, s[72:75], s10 offen offset:0 lds
buffer_load_dwordx4 v25, s[72:75], s10 offen offset:1024 lds
buffer_load_dwordx4 v26, s[72:75], s10 offen offset:2048 lds
buffer_load_dwordx4 v27, s[72:75], s10 offen offset:3072 lds
s_mov_b32 m0, s11
s_nop 0
buffer_load_dwordx4 v28, s[76:79], s55 offen offset:0 lds
buffer_load_dwordx4 v29, s[76:79], s55 offen offset:1024 lds
buffer_load_dwordx4 v30, s[76:79], s55 offen offset:2048 lds
buffer_load_dwordx4 v31, s[76:79], s55 offen offset:3072 lds
s_add_u32 s54, s54, 0x80
s_add_u32 s55, s55, 0x40000
s_add_u32 s53, s53, 49152
s_cmp_ge_u32 s53, 147456
s_cselect_b32 s53, s0, s53
s_waitcnt vmcnt(12)
s_barrier
s_lshl_b32 s51, s3, 12
s_add_u32 s51, s51, 0x8000
v_add_u32 v141, s51, v2
ds_read_b128 v[64:67], v141 offset:0
ds_read_b128 v[68:71], v141 offset:1024
ds_read_b128 v[72:75], v141 offset:2048
ds_read_b128 v[76:79], v141 offset:3072
s_mov_b32 m0, s53
s_add_u32 s1, s53, 16384
s_add_u32 s10, s54, s13
s_add_u32 s11, s53, 32768
buffer_load_dwordx4 v24, s[72:75], s54 offen offset:0 lds
buffer_load_dwordx4 v25, s[72:75], s54 offen offset:1024 lds
buffer_load_dwordx4 v26, s[72:75], s54 offen offset:2048 lds
buffer_load_dwordx4 v27, s[72:75], s54 offen offset:3072 lds
s_mov_b32 m0, s1
s_nop 0
buffer_load_dwordx4 v24, s[72:75], s10 offen offset:0 lds
buffer_load_dwordx4 v25, s[72:75], s10 offen offset:1024 lds
buffer_load_dwordx4 v26, s[72:75], s10 offen offset:2048 lds
buffer_load_dwordx4 v27, s[72:75], s10 offen offset:3072 lds
s_mov_b32 m0, s11
s_nop 0
buffer_load_dwordx4 v28, s[76:79], s55 offen offset:0 lds
buffer_load_dwordx4 v29, s[76:79], s55 offen offset:1024 lds
buffer_load_dwordx4 v30, s[76:79], s55 offen offset:2048 lds
buffer_load_dwordx4 v31, s[76:79], s55 offen offset:3072 lds
s_add_u32 s54, s54, 0x80
s_add_u32 s55, s55, 0x40000
s_add_u32 s53, s53, 49152
s_cmp_ge_u32 s53, 147456
s_cselect_b32 s53, s0, s53
v_lshlrev_b32 v112, 16, v96
v_and_b32 v113, v140, v96
v_lshlrev_b32 v114, 16, v97
v_and_b32 v115, v140, v97
v_lshlrev_b32 v116, 16, v98
v_and_b32 v117, v140, v98
v_lshlrev_b32 v118, 16, v99
v_and_b32 v119, v140, v99
s_waitcnt lgkmcnt(0)
v_lshlrev_b32 v120, 16, v64
v_and_b32 v121, v140, v64
v_lshlrev_b32 v122, 16, v65
v_and_b32 v123, v140, v65
v_lshlrev_b32 v124, 16, v66
v_and_b32 v125, v140, v66
v_lshlrev_b32 v126, 16, v67
v_and_b32 v127, v140, v67
v_add_f32 v120, v120, v112
v_add_f32 v121, v121, v113
v_add_f32 v122, v122, v114
v_add_f32 v123, v123, v115
v_add_f32 v124, v124, v116
v_add_f32 v125, v125, v117
v_add_f32 v126, v126, v118
v_add_f32 v127, v127, v119
v_cvt_pk_bf16_f32 v120, 0, v120
v_cvt_pk_bf16_f32 v121, 0, v121
v_cvt_pk_bf16_f32 v122, 0, v122
v_cvt_pk_bf16_f32 v123, 0, v123
v_cvt_pk_bf16_f32 v124, 0, v124
v_cvt_pk_bf16_f32 v125, 0, v125
v_cvt_pk_bf16_f32 v126, 0, v126
v_cvt_pk_bf16_f32 v127, 0, v127
v_mul_f32 v128, v120, v120
v_mul_f32 v129, v121, v121
v_mul_f32 v130, v122, v122
v_mul_f32 v131, v123, v123
v_mul_f32 v132, v124, v124
v_mul_f32 v133, v125, v125
v_mul_f32 v134, v126, v126
v_mul_f32 v135, v127, v127
v_fma_f32 v128, v128, s62, v138
v_fma_f32 v129, v129, s62, v138
v_fma_f32 v130, v130, s62, v138
v_fma_f32 v131, v131, s62, v138
v_fma_f32 v132, v132, s62, v138
v_fma_f32 v133, v133, s62, v138
s_waitcnt vmcnt(12)
s_barrier
s_mov_b32 m0, s53
s_add_u32 s1, s53, 16384
s_add_u32 s10, s54, s13
s_add_u32 s11, s53, 32768
buffer_load_dwordx4 v24, s[72:75], s54 offen offset:0 lds
s_lshl_b32 s6, s2, 2
s_add_u32 s6, s6, s3
buffer_load_dwordx4 v25, s[72:75], s54 offen offset:1024 lds
s_lshr_b32 s48, s6, 7
s_and_b32 s6, s6, 127
buffer_load_dwordx4 v26, s[72:75], s54 offen offset:2048 lds
s_lshl_b32 s6, s6, 9
s_lshl_b32 s48, s48, 18
buffer_load_dwordx4 v27, s[72:75], s54 offen offset:3072 lds
s_add_u32 s6, s6, s48
s_add_u32 s6, s6, 0x720000
s_mov_b32 m0, s1
s_nop 0
buffer_load_dwordx4 v24, s[72:75], s10 offen offset:0 lds
s_buffer_load_dwordx2 s[8:9], s[84:87], s6 offset:60
s_buffer_load_dwordx2 s[8:9], s[84:87], s6 offset:188
buffer_load_dwordx4 v25, s[72:75], s10 offen offset:1024 lds
s_buffer_load_dwordx2 s[8:9], s[84:87], s6 offset:316
s_buffer_load_dwordx2 s[8:9], s[84:87], s6 offset:444
buffer_load_dwordx4 v26, s[72:75], s10 offen offset:2048 lds
s_add_u32 s6, s6, 0x1c0000
buffer_load_dwordx4 v27, s[72:75], s10 offen offset:3072 lds
s_mov_b32 m0, s11
s_nop 0
buffer_load_dwordx4 v28, s[76:79], s55 offen offset:0 lds
buffer_load_dwordx4 v29, s[76:79], s55 offen offset:1024 lds
buffer_load_dwordx4 v30, s[76:79], s55 offen offset:2048 lds
buffer_load_dwordx4 v31, s[76:79], s55 offen offset:3072 lds
s_add_u32 s54, s54, 0x80
s_add_u32 s55, s55, 0x40000
s_add_u32 s53, s53, 49152
s_cmp_ge_u32 s53, 147456
s_cselect_b32 s53, s0, s53
v_fma_f32 v134, v134, s62, v138
v_fma_f32 v135, v135, s62, v138
v_mul_f32 v128, v128, v120
v_mul_f32 v129, v129, v121
v_mul_f32 v130, v130, v122
v_mul_f32 v131, v131, v123
v_mul_f32 v132, v132, v124
v_mul_f32 v133, v133, v125
v_mul_f32 v134, v134, v126
v_mul_f32 v135, v135, v127
v_exp_f32 v128, v128
v_exp_f32 v129, v129
v_exp_f32 v130, v130
v_exp_f32 v131, v131
v_exp_f32 v132, v132
v_exp_f32 v133, v133
v_exp_f32 v134, v134
v_exp_f32 v135, v135
v_add_f32 v128, 1.0, v128
v_add_f32 v129, 1.0, v129
v_add_f32 v130, 1.0, v130
v_add_f32 v131, 1.0, v131
v_add_f32 v132, 1.0, v132
v_add_f32 v133, 1.0, v133
v_add_f32 v134, 1.0, v134
v_add_f32 v135, 1.0, v135
v_rcp_f32 v128, v128
v_rcp_f32 v129, v129
v_rcp_f32 v130, v130
v_rcp_f32 v131, v131
v_rcp_f32 v132, v132
v_rcp_f32 v133, v133
v_rcp_f32 v134, v134
v_rcp_f32 v135, v135
v_mul_f32 v120, v120, v128
v_mul_f32 v121, v121, v129
v_mul_f32 v122, v122, v130
v_mul_f32 v123, v123, v131
v_mul_f32 v124, v124, v132
v_mul_f32 v125, v125, v133
v_mul_f32 v126, v126, v134
v_mul_f32 v127, v127, v135
v_cvt_pk_bf16_f32 v64, v120, v121
v_cvt_pk_bf16_f32 v65, v122, v123
v_cvt_pk_bf16_f32 v66, v124, v125
v_cvt_pk_bf16_f32 v67, v126, v127
s_add_u32 s51, s60, 0x9000
buffer_store_dwordx4 v[64:67], v136, s[80:83], s51 offen sc1
v_lshlrev_b32 v120, 16, v68
v_and_b32 v121, v140, v68
v_lshlrev_b32 v122, 16, v69
v_and_b32 v123, v140, v69
v_lshlrev_b32 v124, 16, v70
v_and_b32 v125, v140, v70
v_lshlrev_b32 v126, 16, v71
v_and_b32 v127, v140, v71
v_add_f32 v120, v120, v112
v_add_f32 v121, v121, v113
v_add_f32 v122, v122, v114
v_add_f32 v123, v123, v115
v_add_f32 v124, v124, v116
v_add_f32 v125, v125, v117
v_add_f32 v126, v126, v118
v_add_f32 v127, v127, v119
v_cvt_pk_bf16_f32 v120, 0, v120
v_cvt_pk_bf16_f32 v121, 0, v121
v_cvt_pk_bf16_f32 v122, 0, v122
v_cvt_pk_bf16_f32 v123, 0, v123
v_cvt_pk_bf16_f32 v124, 0, v124
v_cvt_pk_bf16_f32 v125, 0, v125
v_cvt_pk_bf16_f32 v126, 0, v126
v_cvt_pk_bf16_f32 v127, 0, v127
v_mul_f32 v128, v120, v120
v_mul_f32 v129, v121, v121
v_mul_f32 v130, v122, v122
v_mul_f32 v131, v123, v123
v_mul_f32 v132, v124, v124
v_mul_f32 v133, v125, v125
v_mul_f32 v134, v126, v126
v_mul_f32 v135, v127, v127
v_fma_f32 v128, v128, s62, v138
v_fma_f32 v129, v129, s62, v138
v_fma_f32 v130, v130, s62, v138
v_fma_f32 v131, v131, s62, v138
v_fma_f32 v132, v132, s62, v138
v_fma_f32 v133, v133, s62, v138
v_fma_f32 v134, v134, s62, v138
v_fma_f32 v135, v135, s62, v138
v_mul_f32 v128, v128, v120
v_mul_f32 v129, v129, v121
v_mul_f32 v130, v130, v122
s_waitcnt vmcnt(13)
s_barrier
s_mov_b32 m0, s53
s_add_u32 s1, s53, 16384
s_add_u32 s10, s54, s13
s_add_u32 s11, s53, 32768
buffer_load_dwordx4 v24, s[72:75], s54 offen offset:0 lds
s_buffer_load_dwordx2 s[8:9], s[84:87], s6 offset:60
buffer_load_dwordx4 v25, s[72:75], s54 offen offset:1024 lds
s_buffer_load_dwordx2 s[8:9], s[84:87], s6 offset:188
buffer_load_dwordx4 v26, s[72:75], s54 offen offset:2048 lds
s_buffer_load_dwordx2 s[8:9], s[84:87], s6 offset:316
buffer_load_dwordx4 v27, s[72:75], s54 offen offset:3072 lds
s_buffer_load_dwordx2 s[8:9], s[84:87], s6 offset:444
s_mov_b32 m0, s1
s_nop 0
buffer_load_dwordx4 v24, s[72:75], s10 offen offset:0 lds
s_add_u32 s6, s6, 0x1c0000
buffer_load_dwordx4 v25, s[72:75], s10 offen offset:1024 lds
buffer_load_dwordx4 v26, s[72:75], s10 offen offset:2048 lds
buffer_load_dwordx4 v27, s[72:75], s10 offen offset:3072 lds
s_mov_b32 m0, s11
s_nop 0
buffer_load_dwordx4 v28, s[76:79], s55 offen offset:0 lds
buffer_load_dwordx4 v29, s[76:79], s55 offen offset:1024 lds
buffer_load_dwordx4 v30, s[76:79], s55 offen offset:2048 lds
buffer_load_dwordx4 v31, s[76:79], s55 offen offset:3072 lds
s_add_u32 s54, s54, 0x80
s_add_u32 s55, s55, 0x40000
s_add_u32 s53, s53, 49152
s_cmp_ge_u32 s53, 147456
s_cselect_b32 s53, s0, s53
v_mul_f32 v131, v131, v123
v_mul_f32 v132, v132, v124
v_mul_f32 v133, v133, v125
v_mul_f32 v134, v134, v126
v_mul_f32 v135, v135, v127
v_exp_f32 v128, v128
v_exp_f32 v129, v129
v_exp_f32 v130, v130
v_exp_f32 v131, v131
v_exp_f32 v132, v132
v_exp_f32 v133, v133
v_exp_f32 v134, v134
v_exp_f32 v135, v135
v_add_f32 v128, 1.0, v128
v_add_f32 v129, 1.0, v129
v_add_f32 v130, 1.0, v130
v_add_f32 v131, 1.0, v131
v_add_f32 v132, 1.0, v132
v_add_f32 v133, 1.0, v133
v_add_f32 v134, 1.0, v134
v_add_f32 v135, 1.0, v135
v_rcp_f32 v128, v128
v_rcp_f32 v129, v129
v_rcp_f32 v130, v130
v_rcp_f32 v131, v131
v_rcp_f32 v132, v132
v_rcp_f32 v133, v133
v_rcp_f32 v134, v134
v_rcp_f32 v135, v135
v_mul_f32 v120, v120, v128
v_mul_f32 v121, v121, v129
v_mul_f32 v122, v122, v130
v_mul_f32 v123, v123, v131
v_mul_f32 v124, v124, v132
v_mul_f32 v125, v125, v133
v_mul_f32 v126, v126, v134
v_mul_f32 v127, v127, v135
v_cvt_pk_bf16_f32 v68, v120, v121
v_cvt_pk_bf16_f32 v69, v122, v123
v_cvt_pk_bf16_f32 v70, v124, v125
v_cvt_pk_bf16_f32 v71, v126, v127
s_add_u32 s51, s60, 0x9200
buffer_store_dwordx4 v[68:71], v136, s[80:83], s51 offen sc1
s_waitcnt vmcnt(14)
s_barrier
s_mov_b32 m0, s53
s_add_u32 s1, s53, 16384
s_add_u32 s10, s54, s13
s_add_u32 s11, s53, 32768
buffer_load_dwordx4 v24, s[72:75], s54 offen offset:0 lds
s_buffer_load_dwordx2 s[8:9], s[84:87], s6 offset:60
buffer_load_dwordx4 v25, s[72:75], s54 offen offset:1024 lds
s_buffer_load_dwordx2 s[8:9], s[84:87], s6 offset:188
buffer_load_dwordx4 v26, s[72:75], s54 offen offset:2048 lds
s_buffer_load_dwordx2 s[8:9], s[84:87], s6 offset:316
buffer_load_dwordx4 v27, s[72:75], s54 offen offset:3072 lds
s_buffer_load_dwordx2 s[8:9], s[84:87], s6 offset:444
s_mov_b32 m0, s1
s_nop 0
buffer_load_dwordx4 v24, s[72:75], s10 offen offset:0 lds
s_add_u32 s6, s6, 0x1c0000
buffer_load_dwordx4 v25, s[72:75], s10 offen offset:1024 lds
buffer_load_dwordx4 v26, s[72:75], s10 offen offset:2048 lds
buffer_load_dwordx4 v27, s[72:75], s10 offen offset:3072 lds
s_mov_b32 m0, s11
s_nop 0
buffer_load_dwordx4 v28, s[76:79], s55 offen offset:0 lds
buffer_load_dwordx4 v29, s[76:79], s55 offen offset:1024 lds
buffer_load_dwordx4 v30, s[76:79], s55 offen offset:2048 lds
buffer_load_dwordx4 v31, s[76:79], s55 offen offset:3072 lds
s_add_u32 s54, s54, 0x80
s_add_u32 s55, s55, 0x40000
s_add_u32 s53, s53, 49152
s_cmp_ge_u32 s53, 147456
s_cselect_b32 s53, s0, s53
v_lshlrev_b32 v112, 16, v100
v_and_b32 v113, v140, v100
v_lshlrev_b32 v114, 16, v101
v_and_b32 v115, v140, v101
v_lshlrev_b32 v116, 16, v102
v_and_b32 v117, v140, v102
v_lshlrev_b32 v118, 16, v103
v_and_b32 v119, v140, v103
v_lshlrev_b32 v120, 16, v72
v_and_b32 v121, v140, v72
v_lshlrev_b32 v122, 16, v73
v_and_b32 v123, v140, v73
v_lshlrev_b32 v124, 16, v74
v_and_b32 v125, v140, v74
v_lshlrev_b32 v126, 16, v75
v_and_b32 v127, v140, v75
v_add_f32 v120, v120, v112
v_add_f32 v121, v121, v113
v_add_f32 v122, v122, v114
v_add_f32 v123, v123, v115
v_add_f32 v124, v124, v116
v_add_f32 v125, v125, v117
v_add_f32 v126, v126, v118
v_add_f32 v127, v127, v119
v_cvt_pk_bf16_f32 v120, 0, v120
v_cvt_pk_bf16_f32 v121, 0, v121
v_cvt_pk_bf16_f32 v122, 0, v122
v_cvt_pk_bf16_f32 v123, 0, v123
v_cvt_pk_bf16_f32 v124, 0, v124
v_cvt_pk_bf16_f32 v125, 0, v125
v_cvt_pk_bf16_f32 v126, 0, v126
v_cvt_pk_bf16_f32 v127, 0, v127
v_mul_f32 v128, v120, v120
v_mul_f32 v129, v121, v121
v_mul_f32 v130, v122, v122
v_mul_f32 v131, v123, v123
v_mul_f32 v132, v124, v124
v_mul_f32 v133, v125, v125
v_mul_f32 v134, v126, v126
v_mul_f32 v135, v127, v127
v_fma_f32 v128, v128, s62, v138
v_fma_f32 v129, v129, s62, v138
v_fma_f32 v130, v130, s62, v138
v_fma_f32 v131, v131, s62, v138
v_fma_f32 v132, v132, s62, v138
v_fma_f32 v133, v133, s62, v138
v_fma_f32 v134, v134, s62, v138
s_waitcnt vmcnt(13)
s_barrier
s_cmp_lg_u32 s3, 0
s_cbranch_scc1 Lw_44
s_mov_b32 exec_lo, 0x7f
s_mov_b32 exec_hi, 0x7f
buffer_load_dword v53, v55, s[88:91], s31 offen offset:0 sc1
s_mov_b64 exec, -1
Lw_44:
s_mov_b32 m0, s53
s_add_u32 s1, s53, 16384
s_add_u32 s10, s54, s13
s_add_u32 s11, s53, 32768
buffer_load_dwordx4 v24, s[72:75], s54 offen offset:0 lds
buffer_load_dwordx4 v25, s[72:75], s54 offen offset:1024 lds
buffer_load_dwordx4 v26, s[72:75], s54 offen offset:2048 lds
buffer_load_dwordx4 v27, s[72:75], s54 offen offset:3072 lds
s_mov_b32 m0, s1
s_nop 0
buffer_load_dwordx4 v24, s[72:75], s10 offen offset:0 lds
buffer_load_dwordx4 v25, s[72:75], s10 offen offset:1024 lds
buffer_load_dwordx4 v26, s[72:75], s10 offen offset:2048 lds
buffer_load_dwordx4 v27, s[72:75], s10 offen offset:3072 lds
s_mov_b32 m0, s11
s_nop 0
buffer_load_dwordx4 v28, s[76:79], s55 offen offset:0 lds
buffer_load_dwordx4 v29, s[76:79], s55 offen offset:1024 lds
buffer_load_dwordx4 v30, s[76:79], s55 offen offset:2048 lds
buffer_load_dwordx4 v31, s[76:79], s55 offen offset:3072 lds
s_add_u32 s54, s54, 0x80
s_add_u32 s55, s55, 0x40000
s_add_u32 s53, s53, 49152
s_cmp_ge_u32 s53, 147456
s_cselect_b32 s53, s0, s53
v_fma_f32 v135, v135, s62, v138
v_mul_f32 v128, v128, v120
v_mul_f32 v129, v129, v121
v_mul_f32 v130, v130, v122
v_mul_f32 v131, v131, v123
v_mul_f32 v132, v132, v124
v_mul_f32 v133, v133, v125
v_mul_f32 v134, v134, v126
v_mul_f32 v135, v135, v127
v_exp_f32 v128, v128
v_exp_f32 v129, v129
v_exp_f32 v130, v130
v_exp_f32 v131, v131
v_exp_f32 v132, v132
v_exp_f32 v133, v133
v_exp_f32 v134, v134
v_exp_f32 v135, v135
v_add_f32 v128, 1.0, v128
v_add_f32 v129, 1.0, v129
v_add_f32 v130, 1.0, v130
v_add_f32 v131, 1.0, v131
v_add_f32 v132, 1.0, v132
v_add_f32 v133, 1.0, v133
v_add_f32 v134, 1.0, v134
v_add_f32 v135, 1.0, v135
v_rcp_f32 v128, v128
v_rcp_f32 v129, v129
v_rcp_f32 v130, v130
v_rcp_f32 v131, v131
v_rcp_f32 v132, v132
v_rcp_f32 v133, v133
v_rcp_f32 v134, v134
v_rcp_f32 v135, v135
v_mul_f32 v120, v120, v128
v_mul_f32 v121, v121, v129
v_mul_f32 v122, v122, v130
v_mul_f32 v123, v123, v131
v_mul_f32 v124, v124, v132
v_mul_f32 v125, v125, v133
v_mul_f32 v126, v126, v134
v_mul_f32 v127, v127, v135
v_cvt_pk_bf16_f32 v72, v120, v121
v_cvt_pk_bf16_f32 v73, v122, v123
v_cvt_pk_bf16_f32 v74, v124, v125
v_cvt_pk_bf16_f32 v75, v126, v127
s_add_u32 s51, s60, 0x19000
buffer_store_dwordx4 v[72:75], v136, s[80:83], s51 offen sc1
s_waitcnt vmcnt(25)
s_cmp_lg_u32 s3, 0
s_cbranch_scc1 Lw_47
s_mov_b32 exec_lo, 0x7f
s_mov_b32 exec_hi, 0x7f
s_mov_b32 s50, 32768
s_waitcnt vmcnt(13)
Lcp_45:
v_cmp_ne_u32 vcc, 1, v53
s_nop 1
s_cbranch_vccz Lco_46
s_sleep 8
buffer_load_dword v53, v55, s[88:91], s31 offen offset:0 sc1
s_waitcnt vmcnt(0)
s_sub_u32 s50, s50, 1
s_cbranch_scc0 Lcp_45
Lco_46:
s_mov_b64 exec, -1
Lw_47:
s_waitcnt vmcnt(13)
s_barrier
s_mul_i32 s54, s45, 7
s_add_u32 s54, s54, s23
s_lshl_b32 s54, s54, 18
s_mov_b32 s12, 0x80000
s_lshl_b32 s55, s54, 1
s_cmp_ge_u32 s45, 2
s_cselect_b32 s13, 0x800, 0
s_add_u32 s54, s54, s13
s_cmp_ge_u32 s45, 2
s_cselect_b32 s13, 0xfffff000, 0
s_add_u32 s13, s13, 0x800
s_mov_b32 m0, s53
s_add_u32 s1, s53, 16384
s_add_u32 s10, s54, s13
s_add_u32 s11, s53, 32768
buffer_load_dwordx4 v32, s[80:83], s54 offen offset:0 lds
s_buffer_load_dwordx2 s[8:9], s[84:87], s6 offset:60
buffer_load_dwordx4 v33, s[80:83], s54 offen offset:1024 lds
s_buffer_load_dwordx2 s[8:9], s[84:87], s6 offset:188
buffer_load_dwordx4 v34, s[80:83], s54 offen offset:2048 lds
s_buffer_load_dwordx2 s[8:9], s[84:87], s6 offset:316
buffer_load_dwordx4 v35, s[80:83], s54 offen offset:3072 lds
s_buffer_load_dwordx2 s[8:9], s[84:87], s6 offset:444
s_mov_b32 m0, s1
s_nop 0
buffer_load_dwordx4 v32, s[80:83], s10 offen offset:0 lds
s_add_u32 s6, s6, 0xff3d0000
buffer_load_dwordx4 v33, s[80:83], s10 offen offset:1024 lds
buffer_load_dwordx4 v34, s[80:83], s10 offen offset:2048 lds
buffer_load_dwordx4 v35, s[80:83], s10 offen offset:3072 lds
s_mov_b32 m0, s11
s_nop 0
buffer_load_dwordx4 v36, s[84:87], s55 offen offset:0 lds
buffer_load_dwordx4 v37, s[84:87], s55 offen offset:1024 lds
buffer_load_dwordx4 v38, s[84:87], s55 offen offset:2048 lds
buffer_load_dwordx4 v39, s[84:87], s55 offen offset:3072 lds
s_add_u32 s54, s54, 0x80000
s_add_u32 s55, s55, 0x100000
s_add_u32 s53, s53, 49152
s_cmp_ge_u32 s53, 147456
s_cselect_b32 s53, s0, s53
v_lshlrev_b32 v120, 16, v76
v_and_b32 v121, v140, v76
v_lshlrev_b32 v122, 16, v77
v_and_b32 v123, v140, v77
v_lshlrev_b32 v124, 16, v78
v_and_b32 v125, v140, v78
v_lshlrev_b32 v126, 16, v79
v_and_b32 v127, v140, v79
v_add_f32 v120, v120, v112
v_add_f32 v121, v121, v113
v_add_f32 v122, v122, v114
v_add_f32 v123, v123, v115
v_add_f32 v124, v124, v116
v_add_f32 v125, v125, v117
v_add_f32 v126, v126, v118
v_add_f32 v127, v127, v119
v_cvt_pk_bf16_f32 v120, 0, v120
v_cvt_pk_bf16_f32 v121, 0, v121
v_cvt_pk_bf16_f32 v122, 0, v122
v_cvt_pk_bf16_f32 v123, 0, v123
v_cvt_pk_bf16_f32 v124, 0, v124
v_cvt_pk_bf16_f32 v125, 0, v125
v_cvt_pk_bf16_f32 v126, 0, v126
v_cvt_pk_bf16_f32 v127, 0, v127
v_mul_f32 v128, v120, v120
v_mul_f32 v129, v121, v121
v_mul_f32 v130, v122, v122
v_mul_f32 v131, v123, v123
v_mul_f32 v132, v124, v124
v_mul_f32 v133, v125, v125
v_mul_f32 v134, v126, v126
v_mul_f32 v135, v127, v127
v_fma_f32 v128, v128, s62, v138
v_fma_f32 v129, v129, s62, v138
v_fma_f32 v130, v130, s62, v138
v_fma_f32 v131, v131, s62, v138
v_fma_f32 v132, v132, s62, v138
v_fma_f32 v133, v133, s62, v138
v_fma_f32 v134, v134, s62, v138
v_fma_f32 v135, v135, s62, v138
v_mul_f32 v128, v128, v120
v_mul_f32 v129, v129, v121
v_mul_f32 v130, v130, v122
s_cmp_lg_u32 s3, 0
s_cbranch_scc1 Lw_48
s_lshl_b32 s51, s43, 5
s_add_u32 s51, s51, s44
s_lshl_b32 s51, s51, 5
s_add_u32 s51, s51, 8196
s_mov_b64 exec, 1
buffer_store_dword v6, v2, s[88:91], s51 offen sc1
s_mov_b64 exec, -1
Lw_48:
s_waitcnt vmcnt(13)
s_barrier
s_mov_b32 m0, s53
s_add_u32 s1, s53, 16384
s_add_u32 s10, s54, s13
s_add_u32 s11, s53, 32768
buffer_load_dwordx4 v32, s[80:83], s54 offen offset:0 lds
s_buffer_load_dwordx2 s[8:9], s[84:87], s6 offset:60
buffer_load_dwordx4 v33, s[80:83], s54 offen offset:1024 lds
s_buffer_load_dwordx2 s[8:9], s[84:87], s6 offset:188
buffer_load_dwordx4 v34, s[80:83], s54 offen offset:2048 lds
s_buffer_load_dwordx2 s[8:9], s[84:87], s6 offset:316
buffer_load_dwordx4 v35, s[80:83], s54 offen offset:3072 lds
s_buffer_load_dwordx2 s[8:9], s[84:87], s6 offset:444
s_mov_b32 m0, s1
s_nop 0
buffer_load_dwordx4 v32, s[80:83], s10 offen offset:0 lds
s_add_u32 s6, s6, 0x1c0000
buffer_load_dwordx4 v33, s[80:83], s10 offen offset:1024 lds
buffer_load_dwordx4 v34, s[80:83], s10 offen offset:2048 lds
buffer_load_dwordx4 v35, s[80:83], s10 offen offset:3072 lds
s_mov_b32 m0, s11
s_nop 0
buffer_load_dwordx4 v36, s[84:87], s55 offen offset:0 lds
buffer_load_dwordx4 v37, s[84:87], s55 offen offset:1024 lds
buffer_load_dwordx4 v38, s[84:87], s55 offen offset:2048 lds
buffer_load_dwordx4 v39, s[84:87], s55 offen offset:3072 lds
s_add_u32 s54, s54, 0x80000
s_add_u32 s55, s55, 0x100000
s_add_u32 s53, s53, 49152
s_cmp_ge_u32 s53, 147456
s_cselect_b32 s53, s0, s53
v_mul_f32 v131, v131, v123
v_mul_f32 v132, v132, v124
v_mul_f32 v133, v133, v125
v_mul_f32 v134, v134, v126
v_mul_f32 v135, v135, v127
v_exp_f32 v128, v128
v_exp_f32 v129, v129
v_exp_f32 v130, v130
v_exp_f32 v131, v131
v_exp_f32 v132, v132
v_exp_f32 v133, v133
v_exp_f32 v134, v134
v_exp_f32 v135, v135
v_add_f32 v128, 1.0, v128
v_add_f32 v129, 1.0, v129
v_add_f32 v130, 1.0, v130
v_add_f32 v131, 1.0, v131
v_add_f32 v132, 1.0, v132
v_add_f32 v133, 1.0, v133
v_add_f32 v134, 1.0, v134
v_add_f32 v135, 1.0, v135
v_rcp_f32 v128, v128
v_rcp_f32 v129, v129
v_rcp_f32 v130, v130
v_rcp_f32 v131, v131
v_rcp_f32 v132, v132
v_rcp_f32 v133, v133
v_rcp_f32 v134, v134
v_rcp_f32 v135, v135
v_mul_f32 v120, v120, v128
v_mul_f32 v121, v121, v129
v_mul_f32 v122, v122, v130
v_mul_f32 v123, v123, v131
v_mul_f32 v124, v124, v132
v_mul_f32 v125, v125, v133
v_mul_f32 v126, v126, v134
v_mul_f32 v127, v127, v135
v_cvt_pk_bf16_f32 v76, v120, v121
v_cvt_pk_bf16_f32 v77, v122, v123
v_cvt_pk_bf16_f32 v78, v124, v125
v_cvt_pk_bf16_f32 v79, v126, v127
s_add_u32 s51, s60, 0x19200
buffer_store_dwordx4 v[76:79], v136, s[80:83], s51 offen sc1
s_waitcnt vmcnt(13)
s_barrier
s_cmp_lg_u32 s3, 0
s_cbranch_scc1 Lw_49
s_mov_b32 exec_lo, 0x7f
s_mov_b32 exec_hi, 0x7f
buffer_load_dword v53, v55, s[88:91], s31 offen offset:4 sc1
s_mov_b64 exec, -1
Lw_49:
s_mov_b32 m0, s53
s_add_u32 s1, s53, 16384
s_add_u32 s10, s54, s13
s_add_u32 s11, s53, 32768
buffer_load_dwordx4 v32, s[80:83], s54 offen offset:0 lds
s_buffer_load_dwordx2 s[8:9], s[84:87], s6 offset:60
buffer_load_dwordx4 v33, s[80:83], s54 offen offset:1024 lds
s_buffer_load_dwordx2 s[8:9], s[84:87], s6 offset:188
buffer_load_dwordx4 v34, s[80:83], s54 offen offset:2048 lds
s_buffer_load_dwordx2 s[8:9], s[84:87], s6 offset:316
buffer_load_dwordx4 v35, s[80:83], s54 offen offset:3072 lds
s_buffer_load_dwordx2 s[8:9], s[84:87], s6 offset:444
s_mov_b32 m0, s1
s_nop 0
buffer_load_dwordx4 v32, s[80:83], s10 offen offset:0 lds
s_add_u32 s6, s6, 0x1c0000
buffer_load_dwordx4 v33, s[80:83], s10 offen offset:1024 lds
buffer_load_dwordx4 v34, s[80:83], s10 offen offset:2048 lds
buffer_load_dwordx4 v35, s[80:83], s10 offen offset:3072 lds
s_mov_b32 m0, s11
s_nop 0
buffer_load_dwordx4 v36, s[84:87], s55 offen offset:0 lds
buffer_load_dwordx4 v37, s[84:87], s55 offen offset:1024 lds
buffer_load_dwordx4 v38, s[84:87], s55 offen offset:2048 lds
buffer_load_dwordx4 v39, s[84:87], s55 offen offset:3072 lds
s_cmp_eq_u32 s23, 1
s_cselect_b32 s10, 0xffec8000, s12
s_add_u32 s54, s54, s10
s_lshl_b32 s10, s10, 1
s_add_u32 s55, s55, s10
s_add_u32 s53, s53, 49152
s_cmp_ge_u32 s53, 147456
s_cselect_b32 s53, s0, s53
s_waitcnt vmcnt(12)
s_cmp_lg_u32 s3, 0
s_cbranch_scc1 Lw_52
s_mov_b32 exec_lo, 0x7f
s_mov_b32 exec_hi, 0x7f
s_mov_b32 s50, 32768
s_waitcnt vmcnt(12)
Lcp_50:
v_cmp_ne_u32 vcc, 1, v53
s_nop 1
s_cbranch_vccz Lco_51
s_sleep 8
buffer_load_dword v53, v55, s[88:91], s31 offen offset:4 sc1
s_waitcnt vmcnt(0)
s_sub_u32 s50, s50, 1
s_cbranch_scc0 Lcp_50
Lco_51:
s_mov_b64 exec, -1
Lw_52:
s_waitcnt vmcnt(13)
s_barrier
s_mov_b32 m0, s53
s_add_u32 s1, s53, 16384
s_add_u32 s10, s54, s13
s_add_u32 s11, s53, 32768
buffer_load_dwordx4 v32, s[80:83], s54 offen offset:0 lds
buffer_load_dwordx4 v33, s[80:83], s54 offen offset:1024 lds
buffer_load_dwordx4 v34, s[80:83], s54 offen offset:2048 lds
buffer_load_dwordx4 v35, s[80:83], s54 offen offset:3072 lds
s_mov_b32 m0, s1
s_nop 0
buffer_load_dwordx4 v32, s[80:83], s10 offen offset:0 lds
buffer_load_dwordx4 v33, s[80:83], s10 offen offset:1024 lds
buffer_load_dwordx4 v34, s[80:83], s10 offen offset:2048 lds
buffer_load_dwordx4 v35, s[80:83], s10 offen offset:3072 lds
s_mov_b32 m0, s11
s_nop 0
buffer_load_dwordx4 v36, s[84:87], s55 offen offset:0 lds
buffer_load_dwordx4 v37, s[84:87], s55 offen offset:1024 lds
buffer_load_dwordx4 v38, s[84:87], s55 offen offset:2048 lds
buffer_load_dwordx4 v39, s[84:87], s55 offen offset:3072 lds
s_cmp_eq_u32 s23, 0
s_cselect_b32 s10, 0xffec8000, s12
s_add_u32 s54, s54, s10
s_lshl_b32 s10, s10, 1
s_add_u32 s55, s55, s10
s_add_u32 s53, s53, 49152
s_cmp_ge_u32 s53, 147456
s_cselect_b32 s53, s0, s53
s_cmp_lg_u32 s3, 0
s_cbranch_scc1 Lw_53
s_lshl_b32 s51, s43, 5
s_add_u32 s51, s51, s44
s_lshl_b32 s51, s51, 5
s_add_u32 s51, s51, 8200
s_mov_b64 exec, 1
buffer_store_dword v6, v2, s[88:91], s51 offen sc1
s_mov_b64 exec, -1
Lw_53:
s_branch Lcm_30
Lsp_29:
s_waitcnt vmcnt(16)
s_barrier
s_buffer_load_dwordx2 s[8:9], s[64:67], s6 offset:60
s_buffer_load_dwordx2 s[8:9], s[64:67], s6 offset:188
s_buffer_load_dwordx2 s[8:9], s[64:67], s6 offset:316
s_add_u32 s6, s6, 0x60000
s_waitcnt vmcnt(8)
s_barrier
s_buffer_load_dwordx2 s[8:9], s[64:67], s6 offset:60
s_buffer_load_dwordx2 s[8:9], s[64:67], s6 offset:188
s_buffer_load_dwordx2 s[8:9], s[64:67], s6 offset:316
s_add_u32 s6, s6, 0x60000
s_waitcnt vmcnt(0)
s_barrier
s_buffer_load_dwordx2 s[8:9], s[64:67], s6 offset:60
s_buffer_load_dwordx2 s[8:9], s[64:67], s6 offset:188
s_buffer_load_dwordx2 s[8:9], s[64:67], s6 offset:316
s_add_u32 s6, s6, 0x60000
s_barrier
s_barrier
s_cmp_lg_u32 s22, 0
s_cbranch_scc1 Lm_55
s_lshl_b32 s48, s23, 8
s_add_u32 s48, s48, 0x24d00
v_add_u32 v57, s48, v52
ds_read_b64 v[50:51], v57
ds_read_b64 v[58:59], v57 offset:512
s_waitcnt lgkmcnt(0)
v_fma_f32 v60, v44, v50, v58
v_fma_f32 v61, v44, v51, v59
v_fma_f32 v60, -v45, v51, v60
v_fma_f32 v61, v45, v50, v61
s_lshl_b32 s51, s42, 1
s_add_u32 s51, s51, s23
s_lshl_b32 s51, s51, 12
s_lshl_b32 s48, s41, 8
s_add_u32 s51, s51, s48
buffer_store_dwordx2 v[60:61], v52, s[96:99], s51 offen sc1
Lm_55:
s_lshl_b32 s52, s2, 2
s_add_u32 s52, s52, s3
s_lshl_b32 s52, s52, 10
s_add_u32 s52, s52, 0xe00000
s_sub_u32 s27, s40, 28
s_lshl_b32 s27, s27, 3
s_add_u32 s27, s27, s39
s_lshl_b32 s27, s27, 2
s_add_u32 s27, s27, s3
s_lshl_b32 s27, s27, 10
v_lshlrev_b32 v3, 4, v1
s_sub_u32 s48, s40, 28
s_lshl_b32 s48, s48, 2
s_add_u32 s48, s48, s3
s_lshl_b32 s48, s48, 10
v_add_u32 v64, s48, v3
v_add_u32 v65, 0x4000, v64
v_add_u32 v66, 0x8000, v64
v_add_u32 v67, 0xc000, v64
s_lshl_b32 s27, s39, 16
s_lshl_b32 s6, s39, 18
s_mov_b32 s56, s24
s_mov_b32 s57, s25
s_mov_b32 s58, 0xe00000
s_mov_b32 s59, 0x20000
s_add_u32 s50, s27, 0x648000
s_mov_b32 s52, 8
Lpf_56:
buffer_load_dwordx4 v[40:43], v64, s[56:59], s50 offen
buffer_load_dwordx4 v[40:43], v65, s[56:59], s50 offen
buffer_load_dwordx4 v[40:43], v66, s[56:59], s50 offen
buffer_load_dwordx4 v[40:43], v67, s[56:59], s50 offen
s_add_u32 s50, s50, 0x80000
s_waitcnt vmcnt(24)
s_sub_u32 s52, s52, 1
s_cmp_lg_u32 s52, 0
s_cbranch_scc1 Lpf_56
s_mov_b32 s56, s14
s_mov_b32 s57, s15
s_mov_b32 s58, 0x200000
s_mov_b32 s59, 0x20000
s_add_u32 s50, s27, 0x0
s_mov_b32 s52, 2
Lpf_57:
buffer_load_dwordx4 v[40:43], v64, s[56:59], s50 offen
buffer_load_dwordx4 v[40:43], v65, s[56:59], s50 offen
buffer_load_dwordx4 v[40:43], v66, s[56:59], s50 offen
buffer_load_dwordx4 v[40:43], v67, s[56:59], s50 offen
s_add_u32 s50, s50, 0x80000
s_waitcnt vmcnt(24)
s_sub_u32 s52, s52, 1
s_cmp_lg_u32 s52, 0
s_cbranch_scc1 Lpf_57
s_cmp_lg_u32 s22, 0
s_cbranch_scc1 Lm_60
v_lshrrev_b32 v57, 5, v1
v_lshlrev_b32 v57, 3, v57
s_sub_u32 s48, s41, 1
v_sub_u32 v57, s48, v57
v_lshl_add_u32 v57, v57, 8, v52
s_lshl_b32 s51, s42, 1
s_add_u32 s51, s51, s23
s_lshl_b32 s51, s51, 12
buffer_load_dwordx2 v[192:193], v57, s[96:99], s51 offen sc1
v_subrev_u32 v57, 256, v57
buffer_load_dwordx2 v[194:195], v57, s[96:99], s51 offen sc1
v_subrev_u32 v57, 256, v57
buffer_load_dwordx2 v[196:197], v57, s[96:99], s51 offen sc1
v_subrev_u32 v57, 256, v57
buffer_load_dwordx2 v[198:199], v57, s[96:99], s51 offen sc1
v_subrev_u32 v57, 256, v57
buffer_load_dwordx2 v[200:201], v57, s[96:99], s51 offen sc1
v_subrev_u32 v57, 256, v57
buffer_load_dwordx2 v[202:203], v57, s[96:99], s51 offen sc1
v_subrev_u32 v57, 256, v57
buffer_load_dwordx2 v[204:205], v57, s[96:99], s51 offen sc1
v_subrev_u32 v57, 256, v57
buffer_load_dwordx2 v[206:207], v57, s[96:99], s51 offen sc1
s_waitcnt vmcnt(0)
s_mov_b32 s50, 32768
Lgp_58:
v_max_u32 v57, v192, v193
v_max3_u32 v57, v57, v194, v195
v_max3_u32 v57, v57, v196, v197
v_max3_u32 v57, v57, v198, v199
v_max3_u32 v57, v57, v200, v201
v_max3_u32 v57, v57, v202, v203
v_max3_u32 v57, v57, v204, v205
v_max3_u32 v57, v57, v206, v207
v_cmp_eq_u32 vcc, -1, v57
s_nop 1
s_cbranch_vccz Lgo_59
s_sleep 32
v_lshrrev_b32 v57, 5, v1
v_lshlrev_b32 v57, 3, v57
s_sub_u32 s48, s41, 1
v_sub_u32 v57, s48, v57
v_lshl_add_u32 v57, v57, 8, v52
s_lshl_b32 s51, s42, 1
s_add_u32 s51, s51, s23
s_lshl_b32 s51, s51, 12
buffer_load_dwordx2 v[192:193], v57, s[96:99], s51 offen sc1
v_subrev_u32 v57, 256, v57
buffer_load_dwordx2 v[194:195], v57, s[96:99], s51 offen sc1
v_subrev_u32 v57, 256, v57
buffer_load_dwordx2 v[196:197], v57, s[96:99], s51 offen sc1
v_subrev_u32 v57, 256, v57
buffer_load_dwordx2 v[198:199], v57, s[96:99], s51 offen sc1
v_subrev_u32 v57, 256, v57
buffer_load_dwordx2 v[200:201], v57, s[96:99], s51 offen sc1
v_subrev_u32 v57, 256, v57
buffer_load_dwordx2 v[202:203], v57, s[96:99], s51 offen sc1
v_subrev_u32 v57, 256, v57
buffer_load_dwordx2 v[204:205], v57, s[96:99], s51 offen sc1
v_subrev_u32 v57, 256, v57
buffer_load_dwordx2 v[206:207], v57, s[96:99], s51 offen sc1
s_waitcnt vmcnt(0)
s_sub_u32 s50, s50, 1
s_cbranch_scc0 Lgp_58
Lgo_59:
v_fma_f32 v58, v46, v206, v204
v_fma_f32 v59, v46, v207, v205
v_fma_f32 v58, -v47, v207, v58
v_fma_f32 v59, v47, v206, v59
v_fma_f32 v60, v46, v58, v202
v_fma_f32 v61, v46, v59, v203
v_fma_f32 v60, -v47, v59, v60
v_fma_f32 v61, v47, v58, v61
v_fma_f32 v58, v46, v60, v200
v_fma_f32 v59, v46, v61, v201
v_fma_f32 v58, -v47, v61, v58
v_fma_f32 v59, v47, v60, v59
v_fma_f32 v60, v46, v58, v198
v_fma_f32 v61, v46, v59, v199
v_fma_f32 v60, -v47, v59, v60
v_fma_f32 v61, v47, v58, v61
v_fma_f32 v58, v46, v60, v196
v_fma_f32 v59, v46, v61, v197
v_fma_f32 v58, -v47, v61, v58
v_fma_f32 v59, v47, v60, v59
v_fma_f32 v60, v46, v58, v194
v_fma_f32 v61, v46, v59, v195
v_fma_f32 v60, -v47, v59, v60
v_fma_f32 v61, v47, v58, v61
v_fma_f32 v58, v46, v60, v192
v_fma_f32 v59, v46, v61, v193
v_fma_f32 v58, -v47, v61, v58
v_fma_f32 v59, v47, v60, v59
v_mov_b32 v60, v58
v_mov_b32 v61, v59
s_nop 1
v_permlane32_swap_b32 v60, v58
v_permlane32_swap_b32 v61, v59
s_nop 1
v_fma_f32 v62, v48, v58, v60
v_fma_f32 v63, v48, v59, v61
v_fma_f32 v62, -v49, v59, v62
v_fma_f32 v63, v49, v58, v63
v_fma_f32 v58, v44, v62, v50
v_fma_f32 v59, v44, v63, v51
v_fma_f32 v58, -v45, v63, v58
v_fma_f32 v59, v45, v62, v59
s_mul_i32 s48, s22, 20736
s_sub_u32 s48, 0x25100, s48
s_lshl_b32 s49, s23, 8
s_add_u32 s48, s48, s49
v_add_u32 v57, s48, v52
ds_write_b64 v57, v[62:63]
ds_write_b64 v57, v[58:59] offset:512
Lm_60:
s_waitcnt lgkmcnt(0)
s_barrier
s_mov_b32 s56, s14
s_mov_b32 s57, s15
s_mov_b32 s58, 0x200000
s_mov_b32 s59, 0x20000
s_add_u32 s50, s27, 0xb8000
s_mov_b32 s52, 3
Lpf_61:
buffer_load_dwordx4 v[40:43], v64, s[56:59], s50 offen
buffer_load_dwordx4 v[40:43], v65, s[56:59], s50 offen
buffer_load_dwordx4 v[40:43], v66, s[56:59], s50 offen
buffer_load_dwordx4 v[40:43], v67, s[56:59], s50 offen
s_add_u32 s50, s50, 0x80000
s_waitcnt vmcnt(24)
s_sub_u32 s52, s52, 1
s_cmp_lg_u32 s52, 0
s_cbranch_scc1 Lpf_61
s_mov_b32 s56, s16
s_mov_b32 s57, s17
s_mov_b32 s58, 0x200000
s_mov_b32 s59, 0x20000
s_add_u32 s50, s27, 0x0
s_mov_b32 s52, 4
Lpf_62:
buffer_load_dwordx4 v[40:43], v64, s[56:59], s50 offen
buffer_load_dwordx4 v[40:43], v65, s[56:59], s50 offen
buffer_load_dwordx4 v[40:43], v66, s[56:59], s50 offen
buffer_load_dwordx4 v[40:43], v67, s[56:59], s50 offen
s_add_u32 s50, s50, 0x80000
s_waitcnt vmcnt(24)
s_sub_u32 s52, s52, 1
s_cmp_lg_u32 s52, 0
s_cbranch_scc1 Lpf_62
s_mov_b32 s56, s28
s_mov_b32 s57, s29
s_mov_b32 s58, 0xe00000
s_mov_b32 s59, 0x20000
s_add_u32 s6, s6, 0x10000
s_mov_b32 s52, 11
v_mov_b32 v57, 0x24400
Lpd_63:
buffer_load_dwordx4 v[40:43], v64, s[56:59], s6 offen
buffer_load_dwordx4 v[40:43], v65, s[56:59], s6 offen
buffer_load_dwordx4 v[40:43], v66, s[56:59], s6 offen
buffer_load_dwordx4 v[40:43], v67, s[56:59], s6 offen
s_add_u32 s6, s6, 0x200000
s_cmp_ge_u32 s6, 0xe00000
s_cselect_b32 s50, 0xff210000, 0
s_add_u32 s6, s6, s50
s_waitcnt vmcnt(24)
ds_read_b32 v58, v57
s_sub_u32 s52, s52, 1
s_waitcnt lgkmcnt(0)
v_readfirstlane_b32 s50, v58
s_nop 0
s_cmp_gt_i32 s52, s50
s_cbranch_scc1 Lpd_63
s_barrier
s_and_b32 s54, s45, 1
s_lshl_b32 s54, s54, 10
s_lshl_b32 s55, s45, 21
s_cmp_ge_u32 s45, 2
s_cselect_b32 s13, 0x40000, 0
s_add_u32 s54, s54, s13
s_cmp_ge_u32 s45, 2
s_cselect_b32 s13, 0xfff80000, 0
s_add_u32 s13, s13, 0x40000
s_mov_b32 m0, s53
s_add_u32 s1, s53, 16384
s_add_u32 s10, s54, s13
s_add_u32 s11, s53, 32768
buffer_load_dwordx4 v24, s[72:75], s54 offen offset:0 lds
buffer_load_dwordx4 v25, s[72:75], s54 offen offset:1024 lds
buffer_load_dwordx4 v26, s[72:75], s54 offen offset:2048 lds
buffer_load_dwordx4 v27, s[72:75], s54 offen offset:3072 lds
s_mov_b32 m0, s1
s_nop 0
buffer_load_dwordx4 v24, s[72:75], s10 offen offset:0 lds
buffer_load_dwordx4 v25, s[72:75], s10 offen offset:1024 lds
buffer_load_dwordx4 v26, s[72:75], s10 offen offset:2048 lds
buffer_load_dwordx4 v27, s[72:75], s10 offen offset:3072 lds
s_mov_b32 m0, s11
s_nop 0
buffer_load_dwordx4 v28, s[76:79], s55 offen offset:0 lds
buffer_load_dwordx4 v29, s[76:79], s55 offen offset:1024 lds
buffer_load_dwordx4 v30, s[76:79], s55 offen offset:2048 lds
buffer_load_dwordx4 v31, s[76:79], s55 offen offset:3072 lds
s_add_u32 s54, s54, 0x80
s_add_u32 s55, s55, 0x40000
s_add_u32 s53, s53, 49152
s_cmp_ge_u32 s53, 147456
s_cselect_b32 s53, s0, s53
s_mov_b32 m0, s53
s_add_u32 s1, s53, 16384
s_add_u32 s10, s54, s13
s_add_u32 s11, s53, 32768
buffer_load_dwordx4 v24, s[72:75], s54 offen offset:0 lds
buffer_load_dwordx4 v25, s[72:75], s54 offen offset:1024 lds
buffer_load_dwordx4 v26, s[72:75], s54 offen offset:2048 lds
buffer_load_dwordx4 v27, s[72:75], s54 offen offset:3072 lds
s_mov_b32 m0, s1
s_nop 0
buffer_load_dwordx4 v24, s[72:75], s10 offen offset:0 lds
buffer_load_dwordx4 v25, s[72:75], s10 offen offset:1024 lds
buffer_load_dwordx4 v26, s[72:75], s10 offen offset:2048 lds
buffer_load_dwordx4 v27, s[72:75], s10 offen offset:3072 lds
s_mov_b32 m0, s11
s_nop 0
buffer_load_dwordx4 v28, s[76:79], s55 offen offset:0 lds
buffer_load_dwordx4 v29, s[76:79], s55 offen offset:1024 lds
buffer_load_dwordx4 v30, s[76:79], s55 offen offset:2048 lds
buffer_load_dwordx4 v31, s[76:79], s55 offen offset:3072 lds
s_add_u32 s54, s54, 0x80
s_add_u32 s55, s55, 0x40000
s_add_u32 s53, s53, 49152
s_cmp_ge_u32 s53, 147456
s_cselect_b32 s53, s0, s53
s_waitcnt vmcnt(12) lgkmcnt(0)
s_barrier
s_mov_b32 m0, s53
s_add_u32 s1, s53, 16384
s_add_u32 s10, s54, s13
s_add_u32 s11, s53, 32768
buffer_load_dwordx4 v24, s[72:75], s54 offen offset:0 lds
buffer_load_dwordx4 v25, s[72:75], s54 offen offset:1024 lds
buffer_load_dwordx4 v26, s[72:75], s54 offen offset:2048 lds
buffer_load_dwordx4 v27, s[72:75], s54 offen offset:3072 lds
s_mov_b32 m0, s1
s_nop 0
buffer_load_dwordx4 v24, s[72:75], s10 offen offset:0 lds
buffer_load_dwordx4 v25, s[72:75], s10 offen offset:1024 lds
buffer_load_dwordx4 v26, s[72:75], s10 offen offset:2048 lds
buffer_load_dwordx4 v27, s[72:75], s10 offen offset:3072 lds
s_mov_b32 m0, s11
s_nop 0
buffer_load_dwordx4 v28, s[76:79], s55 offen offset:0 lds
buffer_load_dwordx4 v29, s[76:79], s55 offen offset:1024 lds
buffer_load_dwordx4 v30, s[76:79], s55 offen offset:2048 lds
buffer_load_dwordx4 v31, s[76:79], s55 offen offset:3072 lds
s_add_u32 s54, s54, 0x80
s_add_u32 s55, s55, 0x40000
s_add_u32 s53, s53, 49152
s_cmp_ge_u32 s53, 147456
s_cselect_b32 s53, s0, s53
s_mov_b32 s7, 4
Lr_74:
s_waitcnt vmcnt(12)
s_barrier
s_mov_b32 m0, s53
s_add_u32 s1, s53, 16384
s_add_u32 s10, s54, s13
s_add_u32 s11, s53, 32768
buffer_load_dwordx4 v24, s[72:75], s54 offen offset:0 lds
buffer_load_dwordx4 v25, s[72:75], s54 offen offset:1024 lds
buffer_load_dwordx4 v26, s[72:75], s54 offen offset:2048 lds
buffer_load_dwordx4 v27, s[72:75], s54 offen offset:3072 lds
s_mov_b32 m0, s1
s_nop 0
buffer_load_dwordx4 v24, s[72:75], s10 offen offset:0 lds
buffer_load_dwordx4 v25, s[72:75], s10 offen offset:1024 lds
buffer_load_dwordx4 v26, s[72:75], s10 offen offset:2048 lds
buffer_load_dwordx4 v27, s[72:75], s10 offen offset:3072 lds
s_mov_b32 m0, s11
s_nop 0
buffer_load_dwordx4 v28, s[76:79], s55 offen offset:0 lds
buffer_load_dwordx4 v29, s[76:79], s55 offen offset:1024 lds
buffer_load_dwordx4 v30, s[76:79], s55 offen offset:2048 lds
buffer_load_dwordx4 v31, s[76:79], s55 offen offset:3072 lds
s_add_u32 s54, s54, 0x80
s_add_u32 s55, s55, 0x40000
s_add_u32 s53, s53, 49152
s_cmp_ge_u32 s53, 147456
s_cselect_b32 s53, s0, s53
s_sub_u32 s7, s7, 1
s_cmp_lg_u32 s7, 0
s_cbranch_scc1 Lr_74
s_waitcnt vmcnt(12)
s_barrier
s_cmp_lg_u32 s3, 0
s_cbranch_scc1 Lw_66
s_mov_b32 exec_lo, 0x7f
s_mov_b32 exec_hi, 0x7f
buffer_load_dword v53, v55, s[88:91], s31 offen offset:0 sc1
s_mov_b64 exec, -1
Lw_66:
s_mov_b32 m0, s53
s_add_u32 s1, s53, 16384
s_add_u32 s10, s54, s13
s_add_u32 s11, s53, 32768
buffer_load_dwordx4 v24, s[72:75], s54 offen offset:0 lds
buffer_load_dwordx4 v25, s[72:75], s54 offen offset:1024 lds
buffer_load_dwordx4 v26, s[72:75], s54 offen offset:2048 lds
buffer_load_dwordx4 v27, s[72:75], s54 offen offset:3072 lds
s_mov_b32 m0, s1
s_nop 0
buffer_load_dwordx4 v24, s[72:75], s10 offen offset:0 lds
buffer_load_dwordx4 v25, s[72:75], s10 offen offset:1024 lds
buffer_load_dwordx4 v26, s[72:75], s10 offen offset:2048 lds
buffer_load_dwordx4 v27, s[72:75], s10 offen offset:3072 lds
s_mov_b32 m0, s11
s_nop 0
buffer_load_dwordx4 v28, s[76:79], s55 offen offset:0 lds
buffer_load_dwordx4 v29, s[76:79], s55 offen offset:1024 lds
buffer_load_dwordx4 v30, s[76:79], s55 offen offset:2048 lds
buffer_load_dwordx4 v31, s[76:79], s55 offen offset:3072 lds
s_add_u32 s54, s54, 0x80
s_add_u32 s55, s55, 0x40000
s_add_u32 s53, s53, 49152
s_cmp_ge_u32 s53, 147456
s_cselect_b32 s53, s0, s53
s_cmp_lg_u32 s3, 0
s_cbranch_scc1 Lw_69
s_mov_b32 exec_lo, 0x7f
s_mov_b32 exec_hi, 0x7f
s_mov_b32 s50, 32768
s_waitcnt vmcnt(12)
Lcp_67:
v_cmp_ne_u32 vcc, 1, v53
s_nop 1
s_cbranch_vccz Lco_68
s_sleep 8
buffer_load_dword v53, v55, s[88:91], s31 offen offset:0 sc1
s_waitcnt vmcnt(0)
s_sub_u32 s50, s50, 1
s_cbranch_scc0 Lcp_67
Lco_68:
s_mov_b64 exec, -1
Lw_69:
s_waitcnt vmcnt(12)
s_barrier
s_mul_i32 s54, s45, 7
s_add_u32 s54, s54, s23
s_lshl_b32 s54, s54, 18
s_mov_b32 s12, 0x80000
s_lshl_b32 s55, s54, 1
s_cmp_ge_u32 s45, 2
s_cselect_b32 s13, 0x800, 0
s_add_u32 s54, s54, s13
s_cmp_ge_u32 s45, 2
s_cselect_b32 s13, 0xfffff000, 0
s_add_u32 s13, s13, 0x800
s_mov_b32 m0, s53
s_add_u32 s1, s53, 16384
s_add_u32 s10, s54, s13
s_add_u32 s11, s53, 32768
buffer_load_dwordx4 v32, s[80:83], s54 offen offset:0 lds
buffer_load_dwordx4 v33, s[80:83], s54 offen offset:1024 lds
buffer_load_dwordx4 v34, s[80:83], s54 offen offset:2048 lds
buffer_load_dwordx4 v35, s[80:83], s54 offen offset:3072 lds
s_mov_b32 m0, s1
s_nop 0
buffer_load_dwordx4 v32, s[80:83], s10 offen offset:0 lds
buffer_load_dwordx4 v33, s[80:83], s10 offen offset:1024 lds
buffer_load_dwordx4 v34, s[80:83], s10 offen offset:2048 lds
buffer_load_dwordx4 v35, s[80:83], s10 offen offset:3072 lds
s_mov_b32 m0, s11
s_nop 0
buffer_load_dwordx4 v36, s[84:87], s55 offen offset:0 lds
buffer_load_dwordx4 v37, s[84:87], s55 offen offset:1024 lds
buffer_load_dwordx4 v38, s[84:87], s55 offen offset:2048 lds
buffer_load_dwordx4 v39, s[84:87], s55 offen offset:3072 lds
s_add_u32 s54, s54, 0x80000
s_add_u32 s55, s55, 0x100000
s_add_u32 s53, s53, 49152
s_cmp_ge_u32 s53, 147456
s_cselect_b32 s53, s0, s53
s_waitcnt vmcnt(12)
s_barrier
s_mov_b32 m0, s53
s_add_u32 s1, s53, 16384
s_add_u32 s10, s54, s13
s_add_u32 s11, s53, 32768
buffer_load_dwordx4 v32, s[80:83], s54 offen offset:0 lds
buffer_load_dwordx4 v33, s[80:83], s54 offen offset:1024 lds
buffer_load_dwordx4 v34, s[80:83], s54 offen offset:2048 lds
buffer_load_dwordx4 v35, s[80:83], s54 offen offset:3072 lds
s_mov_b32 m0, s1
s_nop 0
buffer_load_dwordx4 v32, s[80:83], s10 offen offset:0 lds
buffer_load_dwordx4 v33, s[80:83], s10 offen offset:1024 lds
buffer_load_dwordx4 v34, s[80:83], s10 offen offset:2048 lds
buffer_load_dwordx4 v35, s[80:83], s10 offen offset:3072 lds
s_mov_b32 m0, s11
s_nop 0
buffer_load_dwordx4 v36, s[84:87], s55 offen offset:0 lds
buffer_load_dwordx4 v37, s[84:87], s55 offen offset:1024 lds
buffer_load_dwordx4 v38, s[84:87], s55 offen offset:2048 lds
buffer_load_dwordx4 v39, s[84:87], s55 offen offset:3072 lds
s_add_u32 s54, s54, 0x80000
s_add_u32 s55, s55, 0x100000
s_add_u32 s53, s53, 49152
s_cmp_ge_u32 s53, 147456
s_cselect_b32 s53, s0, s53
s_waitcnt vmcnt(12)
s_barrier
s_cmp_lg_u32 s3, 0
s_cbranch_scc1 Lw_70
s_mov_b32 exec_lo, 0x7f
s_mov_b32 exec_hi, 0x7f
buffer_load_dword v53, v55, s[88:91], s31 offen offset:4 sc1
s_mov_b64 exec, -1
Lw_70:
s_mov_b32 m0, s53
s_add_u32 s1, s53, 16384
s_add_u32 s10, s54, s13
s_add_u32 s11, s53, 32768
buffer_load_dwordx4 v32, s[80:83], s54 offen offset:0 lds
buffer_load_dwordx4 v33, s[80:83], s54 offen offset:1024 lds
buffer_load_dwordx4 v34, s[80:83], s54 offen offset:2048 lds
buffer_load_dwordx4 v35, s[80:83], s54 offen offset:3072 lds
s_mov_b32 m0, s1
s_nop 0
buffer_load_dwordx4 v32, s[80:83], s10 offen offset:0 lds
buffer_load_dwordx4 v33, s[80:83], s10 offen offset:1024 lds
buffer_load_dwordx4 v34, s[80:83], s10 offen offset:2048 lds
buffer_load_dwordx4 v35, s[80:83], s10 offen offset:3072 lds
s_mov_b32 m0, s11
s_nop 0
buffer_load_dwordx4 v36, s[84:87], s55 offen offset:0 lds
buffer_load_dwordx4 v37, s[84:87], s55 offen offset:1024 lds
buffer_load_dwordx4 v38, s[84:87], s55 offen offset:2048 lds
buffer_load_dwordx4 v39, s[84:87], s55 offen offset:3072 lds
s_cmp_eq_u32 s23, 1
s_cselect_b32 s10, 0xffec8000, s12
s_add_u32 s54, s54, s10
s_lshl_b32 s10, s10, 1
s_add_u32 s55, s55, s10
s_add_u32 s53, s53, 49152
s_cmp_ge_u32 s53, 147456
s_cselect_b32 s53, s0, s53
s_cmp_lg_u32 s3, 0
s_cbranch_scc1 Lw_73
s_mov_b32 exec_lo, 0x7f
s_mov_b32 exec_hi, 0x7f
s_mov_b32 s50, 32768
s_waitcnt vmcnt(12)
Lcp_71:
v_cmp_ne_u32 vcc, 1, v53
s_nop 1
s_cbranch_vccz Lco_72
s_sleep 8
buffer_load_dword v53, v55, s[88:91], s31 offen offset:4 sc1
s_waitcnt vmcnt(0)
s_sub_u32 s50, s50, 1
s_cbranch_scc0 Lcp_71
Lco_72:
s_mov_b64 exec, -1
Lw_73:
s_waitcnt vmcnt(12)
s_barrier
s_mov_b32 m0, s53
s_add_u32 s1, s53, 16384
s_add_u32 s10, s54, s13
s_add_u32 s11, s53, 32768
buffer_load_dwordx4 v32, s[80:83], s54 offen offset:0 lds
buffer_load_dwordx4 v33, s[80:83], s54 offen offset:1024 lds
buffer_load_dwordx4 v34, s[80:83], s54 offen offset:2048 lds
buffer_load_dwordx4 v35, s[80:83], s54 offen offset:3072 lds
s_mov_b32 m0, s1
s_nop 0
buffer_load_dwordx4 v32, s[80:83], s10 offen offset:0 lds
buffer_load_dwordx4 v33, s[80:83], s10 offen offset:1024 lds
buffer_load_dwordx4 v34, s[80:83], s10 offen offset:2048 lds
buffer_load_dwordx4 v35, s[80:83], s10 offen offset:3072 lds
s_mov_b32 m0, s11
s_nop 0
buffer_load_dwordx4 v36, s[84:87], s55 offen offset:0 lds
buffer_load_dwordx4 v37, s[84:87], s55 offen offset:1024 lds
buffer_load_dwordx4 v38, s[84:87], s55 offen offset:2048 lds
buffer_load_dwordx4 v39, s[84:87], s55 offen offset:3072 lds
s_cmp_eq_u32 s23, 0
s_cselect_b32 s10, 0xffec8000, s12
s_add_u32 s54, s54, s10
s_lshl_b32 s10, s10, 1
s_add_u32 s55, s55, s10
s_add_u32 s53, s53, 49152
s_cmp_ge_u32 s53, 147456
s_cselect_b32 s53, s0, s53
Lcm_30:
s_waitcnt vmcnt(12)
s_barrier
s_mov_b32 m0, s53
s_add_u32 s1, s53, 16384
s_add_u32 s10, s54, s13
s_add_u32 s11, s53, 32768
buffer_load_dwordx4 v32, s[80:83], s54 offen offset:0 lds
s_lshl_b32 s6, s2, 2
s_add_u32 s6, s6, s3
buffer_load_dwordx4 v33, s[80:83], s54 offen offset:1024 lds
s_lshr_b32 s48, s6, 7
s_and_b32 s6, s6, 127
buffer_load_dwordx4 v34, s[80:83], s54 offen offset:2048 lds
s_lshl_b32 s6, s6, 9
s_lshl_b32 s48, s48, 18
buffer_load_dwordx4 v35, s[80:83], s54 offen offset:3072 lds
s_add_u32 s6, s6, s48
s_add_u32 s6, s6, 0x3b0000
s_mov_b32 m0, s1
s_nop 0
buffer_load_dwordx4 v32, s[80:83], s10 offen offset:0 lds
s_buffer_load_dwordx2 s[8:9], s[84:87], s6 offset:60
s_buffer_load_dwordx2 s[8:9], s[84:87], s6 offset:188
buffer_load_dwordx4 v33, s[80:83], s10 offen offset:1024 lds
s_buffer_load_dwordx2 s[8:9], s[84:87], s6 offset:316
s_buffer_load_dwordx2 s[8:9], s[84:87], s6 offset:444
buffer_load_dwordx4 v34, s[80:83], s10 offen offset:2048 lds
s_add_u32 s6, s6, 0x1c0000
buffer_load_dwordx4 v35, s[80:83], s10 offen offset:3072 lds
s_mov_b32 m0, s11
s_nop 0
buffer_load_dwordx4 v36, s[84:87], s55 offen offset:0 lds
buffer_load_dwordx4 v37, s[84:87], s55 offen offset:1024 lds
buffer_load_dwordx4 v38, s[84:87], s55 offen offset:2048 lds
buffer_load_dwordx4 v39, s[84:87], s55 offen offset:3072 lds
s_add_u32 s54, s54, 0x80000
s_add_u32 s55, s55, 0x100000
s_add_u32 s53, s53, 49152
s_cmp_ge_u32 s53, 147456
s_cselect_b32 s53, s0, s53
s_mov_b32 s56, s4
s_mov_b32 s57, s5
s_mov_b32 s58, 0x400000
s_mov_b32 s59, 0x20000
s_add_u32 s60, s36, 0x1800000
s_addc_u32 s61, s37, 0
s_mov_b32 s62, 0x10000
s_mov_b32 s63, 0x20000
s_mov_b32 s64, s20
s_mov_b32 s65, s21
s_mov_b32 s66, 0x800
s_mov_b32 s67, 0x20000
v_lshrrev_b32 v3, 4, v1
v_lshlrev_b32 v3, 10, v3
v_and_b32 v57, 15, v1
v_lshl_add_u32 v3, v57, 2, v3
v_lshlrev_b32 v3, 1, v3
s_lshl_b32 s27, s46, 1
s_add_u32 s27, s27, s23
s_lshl_b32 s27, s27, 1
s_and_b32 s50, s45, 1
s_add_u32 s27, s27, s50
s_lshl_b32 s27, s27, 9
s_lshl_b32 s51, s47, 2
s_and_b32 s50, s45, 2
s_add_u32 s51, s51, s50
s_add_u32 s51, s51, s22
s_add_u32 s27, s27, s51
s_lshl_b32 s27, s27, 7
v_lshlrev_b32 v57, 3, v57
v_lshrrev_b32 v4, 4, v1
v_lshlrev_b32 v4, 3, v4
s_mov_b32 s26, 0xffff0000
s_lshl_b32 s51, s51, 7
buffer_load_dwordx2 v[242:243], v57, s[64:67], s51 offen
s_lshl_b32 s68, s46, 1
s_add_u32 s68, s68, s23
s_lshl_b32 s68, s68, 1
s_and_b32 s50, s45, 1
s_add_u32 s68, s68, s50
s_lshl_b32 s68, s68, 10
s_waitcnt vmcnt(13)
s_barrier
s_mov_b32 m0, s53
s_add_u32 s1, s53, 16384
s_add_u32 s10, s54, s13
s_add_u32 s11, s53, 32768
buffer_load_dwordx4 v32, s[80:83], s54 offen offset:0 lds
s_buffer_load_dwordx2 s[8:9], s[84:87], s6 offset:60
buffer_load_dwordx4 v33, s[80:83], s54 offen offset:1024 lds
s_buffer_load_dwordx2 s[8:9], s[84:87], s6 offset:188
buffer_load_dwordx4 v34, s[80:83], s54 offen offset:2048 lds
s_buffer_load_dwordx2 s[8:9], s[84:87], s6 offset:316
buffer_load_dwordx4 v35, s[80:83], s54 offen offset:3072 lds
s_buffer_load_dwordx2 s[8:9], s[84:87], s6 offset:444
s_mov_b32 m0, s1
s_nop 0
buffer_load_dwordx4 v32, s[80:83], s10 offen offset:0 lds
s_add_u32 s6, s6, 0x1c0000
buffer_load_dwordx4 v33, s[80:83], s10 offen offset:1024 lds
buffer_load_dwordx2 v[64:65], v3, s[56:59], s27 offen
buffer_load_dwordx4 v34, s[80:83], s10 offen offset:2048 lds
s_add_u32 s27, s27, 8192
buffer_load_dwordx4 v35, s[80:83], s10 offen offset:3072 lds
buffer_load_dwordx2 v[66:67], v4, s[60:63], s68 offen offset:128
s_mov_b32 m0, s11
s_nop 0
buffer_load_dwordx4 v36, s[84:87], s55 offen offset:0 lds
buffer_load_dwordx4 v37, s[84:87], s55 offen offset:1024 lds
buffer_load_dwordx4 v38, s[84:87], s55 offen offset:2048 lds
buffer_load_dwordx4 v39, s[84:87], s55 offen offset:3072 lds
s_add_u32 s54, s54, 0x80000
s_add_u32 s55, s55, 0x100000
s_add_u32 s53, s53, 49152
s_cmp_ge_u32 s53, 147456
s_cselect_b32 s53, s0, s53
s_waitcnt vmcnt(15)
s_barrier
s_cmp_lg_u32 s3, 0
s_cbranch_scc1 Lw_76
s_mov_b32 exec_lo, 0x7f
s_mov_b32 exec_hi, 0x7f
buffer_load_dword v53, v55, s[88:91], s31 offen offset:8 sc1
s_mov_b64 exec, -1
Lw_76:
s_mov_b32 m0, s53
s_add_u32 s1, s53, 16384
s_add_u32 s10, s54, s13
s_add_u32 s11, s53, 32768
buffer_load_dwordx4 v32, s[80:83], s54 offen offset:0 lds
s_buffer_load_dwordx2 s[8:9], s[84:87], s6 offset:60
buffer_load_dwordx4 v33, s[80:83], s54 offen offset:1024 lds
s_buffer_load_dwordx2 s[8:9], s[84:87], s6 offset:188
buffer_load_dwordx4 v34, s[80:83], s54 offen offset:2048 lds
s_buffer_load_dwordx2 s[8:9], s[84:87], s6 offset:316
buffer_load_dwordx4 v35, s[80:83], s54 offen offset:3072 lds
s_buffer_load_dwordx2 s[8:9], s[84:87], s6 offset:444
s_mov_b32 m0, s1
s_nop 0
buffer_load_dwordx4 v32, s[80:83], s10 offen offset:0 lds
s_add_u32 s6, s6, 0x1c0000
buffer_load_dwordx4 v33, s[80:83], s10 offen offset:1024 lds
buffer_load_dwordx2 v[68:69], v3, s[56:59], s27 offen
buffer_load_dwordx4 v34, s[80:83], s10 offen offset:2048 lds
s_add_u32 s27, s27, 8192
buffer_load_dwordx4 v35, s[80:83], s10 offen offset:3072 lds
buffer_load_dwordx2 v[70:71], v4, s[60:63], s68 offen offset:160
s_mov_b32 m0, s11
s_nop 0
buffer_load_dwordx4 v36, s[84:87], s55 offen offset:0 lds
buffer_load_dwordx4 v37, s[84:87], s55 offen offset:1024 lds
buffer_load_dwordx4 v38, s[84:87], s55 offen offset:2048 lds
buffer_load_dwordx4 v39, s[84:87], s55 offen offset:3072 lds
s_add_u32 s54, s54, 0x80000
s_add_u32 s55, s55, 0x100000
s_add_u32 s53, s53, 49152
s_cmp_ge_u32 s53, 147456
s_cselect_b32 s53, s0, s53
s_cmp_lg_u32 s3, 0
s_cbranch_scc1 Lw_79
s_mov_b32 exec_lo, 0x7f
s_mov_b32 exec_hi, 0x7f
s_mov_b32 s50, 32768
s_waitcnt vmcnt(14)
Lcp_77:
v_cmp_ne_u32 vcc, 1, v53
s_nop 1
s_cbranch_vccz Lco_78
s_sleep 8
buffer_load_dword v53, v55, s[88:91], s31 offen offset:8 sc1
s_waitcnt vmcnt(0)
s_sub_u32 s50, s50, 1
s_cbranch_scc0 Lcp_77
Lco_78:
s_mov_b64 exec, -1
Lw_79:
s_waitcnt vmcnt(14)
s_barrier
s_mul_i32 s54, s45, 7
s_add_u32 s54, s54, s23
s_lshl_b32 s54, s54, 18
s_mov_b32 s12, 0x80000
s_add_u32 s54, s54, 0x10000
s_lshl_b32 s55, s54, 1
s_cmp_ge_u32 s45, 2
s_cselect_b32 s13, 0x800, 0
s_add_u32 s54, s54, s13
s_cmp_ge_u32 s45, 2
s_cselect_b32 s13, 0xfffff000, 0
s_add_u32 s13, s13, 0x800
s_mov_b32 m0, s53
s_add_u32 s1, s53, 16384
s_add_u32 s10, s54, s13
s_add_u32 s11, s53, 32768
buffer_load_dwordx4 v32, s[80:83], s54 offen offset:0 lds
buffer_load_dwordx2 v[72:73], v3, s[56:59], s27 offen
buffer_load_dwordx4 v33, s[80:83], s54 offen offset:1024 lds
s_add_u32 s27, s27, 8192
buffer_load_dwordx4 v34, s[80:83], s54 offen offset:2048 lds
buffer_load_dwordx2 v[74:75], v4, s[60:63], s68 offen offset:384
buffer_load_dwordx4 v35, s[80:83], s54 offen offset:3072 lds
s_mov_b32 m0, s1
s_nop 0
buffer_load_dwordx4 v32, s[80:83], s10 offen offset:0 lds
buffer_load_dwordx4 v33, s[80:83], s10 offen offset:1024 lds
buffer_load_dwordx4 v34, s[80:83], s10 offen offset:2048 lds
buffer_load_dwordx4 v35, s[80:83], s10 offen offset:3072 lds
s_mov_b32 m0, s11
s_nop 0
buffer_load_dwordx4 v36, s[84:87], s55 offen offset:0 lds
buffer_load_dwordx4 v37, s[84:87], s55 offen offset:1024 lds
buffer_load_dwordx4 v38, s[84:87], s55 offen offset:2048 lds
buffer_load_dwordx4 v39, s[84:87], s55 offen offset:3072 lds
s_add_u32 s54, s54, 0x80000
s_add_u32 s55, s55, 0x100000
s_add_u32 s53, s53, 49152
s_cmp_ge_u32 s53, 147456
s_cselect_b32 s53, s0, s53
s_waitcnt vmcnt(14)
s_barrier
s_mov_b32 m0, s53
s_add_u32 s1, s53, 16384
s_add_u32 s10, s54, s13
s_add_u32 s11, s53, 32768
buffer_load_dwordx4 v32, s[80:83], s54 offen offset:0 lds
s_buffer_load_dwordx2 s[8:9], s[84:87], s6 offset:60
s_buffer_load_dwordx2 s[8:9], s[84:87], s6 offset:188
s_buffer_load_dwordx2 s[8:9], s[84:87], s6 offset:316
s_buffer_load_dwordx2 s[8:9], s[84:87], s6 offset:444
s_add_u32 s6, s6, 0x1c0000
buffer_load_dwordx4 v33, s[80:83], s54 offen offset:1024 lds
v_lshlrev_b32 v240, 16, v242
v_and_b32 v241, s26, v242
v_lshlrev_b32 v242, 16, v243
v_and_b32 v243, s26, v243
v_lshlrev_b32 v244, 16, v64
buffer_load_dwordx4 v34, s[80:83], s54 offen offset:2048 lds
v_and_b32 v245, s26, v64
v_lshlrev_b32 v246, 16, v65
v_and_b32 v247, s26, v65
v_lshlrev_b32 v252, 16, v66
v_and_b32 v253, s26, v66
buffer_load_dwordx4 v35, s[80:83], s54 offen offset:3072 lds
v_sub_f32 v248, v244, v252
v_sub_f32 v249, v245, v252
v_sub_f32 v250, v246, v252
v_sub_f32 v251, v247, v252
v_cvt_pk_bf16_f32 v248, 0, v248
s_mov_b32 m0, s1
s_nop 0
buffer_load_dwordx4 v32, s[80:83], s10 offen offset:0 lds
v_cvt_pk_bf16_f32 v249, 0, v249
v_cvt_pk_bf16_f32 v250, 0, v250
v_cvt_pk_bf16_f32 v251, 0, v251
v_mul_f32 v248, v248, v67
v_mul_f32 v249, v249, v67
buffer_load_dwordx4 v33, s[80:83], s10 offen offset:1024 lds
v_mul_f32 v250, v250, v67
v_mul_f32 v251, v251, v67
v_cvt_pk_bf16_f32 v248, 0, v248
v_cvt_pk_bf16_f32 v249, 0, v249
v_cvt_pk_bf16_f32 v250, 0, v250
buffer_load_dwordx4 v34, s[80:83], s10 offen offset:2048 lds
v_cvt_pk_bf16_f32 v251, 0, v251
v_mul_f32 v248, v248, v240
v_mul_f32 v249, v249, v241
v_mul_f32 v250, v250, v242
v_mul_f32 v251, v251, v243
buffer_load_dwordx4 v35, s[80:83], s10 offen offset:3072 lds
v_cvt_pk_bf16_f32 v248, 0, v248
v_cvt_pk_bf16_f32 v249, 0, v249
v_cvt_pk_bf16_f32 v250, 0, v250
v_cvt_pk_bf16_f32 v251, 0, v251
v_add_f32 v244, v244, v253
s_mov_b32 m0, s11
s_nop 0
buffer_load_dwordx4 v36, s[84:87], s55 offen offset:0 lds
v_add_f32 v245, v245, v253
v_add_f32 v246, v246, v253
v_add_f32 v247, v247, v253
v_add_f32 v64, v244, v248
v_add_f32 v65, v245, v249
buffer_load_dwordx4 v37, s[84:87], s55 offen offset:1024 lds
v_add_f32 v66, v246, v250
v_add_f32 v67, v247, v251
buffer_load_dwordx2 v[76:77], v3, s[56:59], s27 offen
s_add_u32 s27, s27, 8192
buffer_load_dwordx2 v[78:79], v4, s[60:63], s68 offen offset:416
buffer_load_dwordx4 v38, s[84:87], s55 offen offset:2048 lds
buffer_load_dwordx4 v39, s[84:87], s55 offen offset:3072 lds
s_add_u32 s54, s54, 0x80000
s_add_u32 s55, s55, 0x100000
s_add_u32 s53, s53, 49152
s_cmp_ge_u32 s53, 147456
s_cselect_b32 s53, s0, s53
s_waitcnt vmcnt(14)
s_barrier
s_mov_b32 m0, s53
s_add_u32 s1, s53, 16384
s_add_u32 s10, s54, s13
s_add_u32 s11, s53, 32768
buffer_load_dwordx4 v32, s[80:83], s54 offen offset:0 lds
s_buffer_load_dwordx2 s[8:9], s[84:87], s6 offset:60
s_buffer_load_dwordx2 s[8:9], s[84:87], s6 offset:188
s_buffer_load_dwordx2 s[8:9], s[84:87], s6 offset:316
s_buffer_load_dwordx2 s[8:9], s[84:87], s6 offset:444
buffer_load_dwordx4 v33, s[80:83], s54 offen offset:1024 lds
s_add_u32 s6, s6, 0x1c0000
v_lshlrev_b32 v244, 16, v68
v_and_b32 v245, s26, v68
v_lshlrev_b32 v246, 16, v69
buffer_load_dwordx4 v34, s[80:83], s54 offen offset:2048 lds
v_and_b32 v247, s26, v69
v_lshlrev_b32 v252, 16, v70
v_and_b32 v253, s26, v70
v_sub_f32 v248, v244, v252
buffer_load_dwordx4 v35, s[80:83], s54 offen offset:3072 lds
v_sub_f32 v249, v245, v252
v_sub_f32 v250, v246, v252
v_sub_f32 v251, v247, v252
v_cvt_pk_bf16_f32 v248, 0, v248
s_mov_b32 m0, s1
s_nop 0
buffer_load_dwordx4 v32, s[80:83], s10 offen offset:0 lds
v_cvt_pk_bf16_f32 v249, 0, v249
v_cvt_pk_bf16_f32 v250, 0, v250
v_cvt_pk_bf16_f32 v251, 0, v251
v_mul_f32 v248, v248, v71
buffer_load_dwordx4 v33, s[80:83], s10 offen offset:1024 lds
v_mul_f32 v249, v249, v71
v_mul_f32 v250, v250, v71
v_mul_f32 v251, v251, v71
v_cvt_pk_bf16_f32 v248, 0, v248
buffer_load_dwordx4 v34, s[80:83], s10 offen offset:2048 lds
v_cvt_pk_bf16_f32 v249, 0, v249
v_cvt_pk_bf16_f32 v250, 0, v250
v_cvt_pk_bf16_f32 v251, 0, v251
v_mul_f32 v248, v248, v240
buffer_load_dwordx4 v35, s[80:83], s10 offen offset:3072 lds
v_mul_f32 v249, v249, v241
v_mul_f32 v250, v250, v242
v_mul_f32 v251, v251, v243
v_cvt_pk_bf16_f32 v248, 0, v248
s_mov_b32 m0, s11
s_nop 0
buffer_load_dwordx4 v36, s[84:87], s55 offen offset:0 lds
v_cvt_pk_bf16_f32 v249, 0, v249
v_cvt_pk_bf16_f32 v250, 0, v250
v_cvt_pk_bf16_f32 v251, 0, v251
v_add_f32 v244, v244, v253
buffer_load_dwordx4 v37, s[84:87], s55 offen offset:1024 lds
v_add_f32 v245, v245, v253
v_add_f32 v246, v246, v253
v_add_f32 v247, v247, v253
v_add_f32 v68, v244, v248
buffer_load_dwordx4 v38, s[84:87], s55 offen offset:2048 lds
v_add_f32 v69, v245, v249
v_add_f32 v70, v246, v250
v_add_f32 v71, v247, v251
buffer_load_dwordx2 v[80:81], v3, s[56:59], s27 offen
buffer_load_dwordx4 v39, s[84:87], s55 offen offset:3072 lds
s_add_u32 s27, s27, 8192
buffer_load_dwordx2 v[82:83], v4, s[60:63], s68 offen offset:640
s_cmp_eq_u32 s23, 1
s_cselect_b32 s10, 0xffec8000, s12
s_add_u32 s54, s54, s10
s_lshl_b32 s10, s10, 1
s_add_u32 s55, s55, s10
s_add_u32 s53, s53, 49152
s_cmp_ge_u32 s53, 147456
s_cselect_b32 s53, s0, s53
s_waitcnt vmcnt(14)
s_barrier
s_mov_b32 m0, s53
s_add_u32 s1, s53, 16384
s_add_u32 s10, s54, s13
s_add_u32 s11, s53, 32768
buffer_load_dwordx4 v32, s[80:83], s54 offen offset:0 lds
s_buffer_load_dwordx2 s[8:9], s[84:87], s6 offset:60
s_buffer_load_dwordx2 s[8:9], s[84:87], s6 offset:188
s_buffer_load_dwordx2 s[8:9], s[84:87], s6 offset:316
s_buffer_load_dwordx2 s[8:9], s[84:87], s6 offset:444
buffer_load_dwordx4 v33, s[80:83], s54 offen offset:1024 lds
s_add_u32 s6, s6, 0xff3d0000
v_lshlrev_b32 v244, 16, v72
v_and_b32 v245, s26, v72
v_lshlrev_b32 v246, 16, v73
buffer_load_dwordx4 v34, s[80:83], s54 offen offset:2048 lds
v_and_b32 v247, s26, v73
v_lshlrev_b32 v252, 16, v74
v_and_b32 v253, s26, v74
v_sub_f32 v248, v244, v252
buffer_load_dwordx4 v35, s[80:83], s54 offen offset:3072 lds
v_sub_f32 v249, v245, v252
v_sub_f32 v250, v246, v252
v_sub_f32 v251, v247, v252
v_cvt_pk_bf16_f32 v248, 0, v248
s_mov_b32 m0, s1
s_nop 0
buffer_load_dwordx4 v32, s[80:83], s10 offen offset:0 lds
v_cvt_pk_bf16_f32 v249, 0, v249
v_cvt_pk_bf16_f32 v250, 0, v250
v_cvt_pk_bf16_f32 v251, 0, v251
v_mul_f32 v248, v248, v75
buffer_load_dwordx4 v33, s[80:83], s10 offen offset:1024 lds
v_mul_f32 v249, v249, v75
v_mul_f32 v250, v250, v75
v_mul_f32 v251, v251, v75
v_cvt_pk_bf16_f32 v248, 0, v248
buffer_load_dwordx4 v34, s[80:83], s10 offen offset:2048 lds
v_cvt_pk_bf16_f32 v249, 0, v249
v_cvt_pk_bf16_f32 v250, 0, v250
v_cvt_pk_bf16_f32 v251, 0, v251
v_mul_f32 v248, v248, v240
buffer_load_dwordx4 v35, s[80:83], s10 offen offset:3072 lds
v_mul_f32 v249, v249, v241
v_mul_f32 v250, v250, v242
v_mul_f32 v251, v251, v243
v_cvt_pk_bf16_f32 v248, 0, v248
s_mov_b32 m0, s11
s_nop 0
buffer_load_dwordx4 v36, s[84:87], s55 offen offset:0 lds
v_cvt_pk_bf16_f32 v249, 0, v249
v_cvt_pk_bf16_f32 v250, 0, v250
v_cvt_pk_bf16_f32 v251, 0, v251
v_add_f32 v244, v244, v253
buffer_load_dwordx4 v37, s[84:87], s55 offen offset:1024 lds
v_add_f32 v245, v245, v253
v_add_f32 v246, v246, v253
v_add_f32 v247, v247, v253
v_add_f32 v72, v244, v248
buffer_load_dwordx4 v38, s[84:87], s55 offen offset:2048 lds
v_add_f32 v73, v245, v249
v_add_f32 v74, v246, v250
v_add_f32 v75, v247, v251
buffer_load_dwordx2 v[84:85], v3, s[56:59], s27 offen
buffer_load_dwordx4 v39, s[84:87], s55 offen offset:3072 lds
s_add_u32 s27, s27, 8192
buffer_load_dwordx2 v[86:87], v4, s[60:63], s68 offen offset:672
s_cmp_eq_u32 s23, 0
s_cselect_b32 s10, 0xffec8000, s12
s_add_u32 s54, s54, s10
s_lshl_b32 s10, s10, 1
s_add_u32 s55, s55, s10
s_add_u32 s53, s53, 49152
s_cmp_ge_u32 s53, 147456
s_cselect_b32 s53, s0, s53
s_waitcnt vmcnt(15)
s_barrier
s_mov_b32 m0, s53
s_add_u32 s1, s53, 16384
s_add_u32 s10, s54, s13
s_add_u32 s11, s53, 32768
buffer_load_dwordx4 v32, s[80:83], s54 offen offset:0 lds
v_lshlrev_b32 v244, 16, v76
v_and_b32 v245, s26, v76
v_lshlrev_b32 v246, 16, v77
v_and_b32 v247, s26, v77
buffer_load_dwordx4 v33, s[80:83], s54 offen offset:1024 lds
v_lshlrev_b32 v252, 16, v78
v_and_b32 v253, s26, v78
v_sub_f32 v248, v244, v252
v_sub_f32 v249, v245, v252
buffer_load_dwordx4 v34, s[80:83], s54 offen offset:2048 lds
v_sub_f32 v250, v246, v252
v_sub_f32 v251, v247, v252
v_cvt_pk_bf16_f32 v248, 0, v248
v_cvt_pk_bf16_f32 v249, 0, v249
buffer_load_dwordx4 v35, s[80:83], s54 offen offset:3072 lds
v_cvt_pk_bf16_f32 v250, 0, v250
v_cvt_pk_bf16_f32 v251, 0, v251
v_mul_f32 v248, v248, v79
v_mul_f32 v249, v249, v79
s_mov_b32 m0, s1
s_nop 0
buffer_load_dwordx4 v32, s[80:83], s10 offen offset:0 lds
v_mul_f32 v250, v250, v79
v_mul_f32 v251, v251, v79
v_cvt_pk_bf16_f32 v248, 0, v248
v_cvt_pk_bf16_f32 v249, 0, v249
buffer_load_dwordx4 v33, s[80:83], s10 offen offset:1024 lds
v_cvt_pk_bf16_f32 v250, 0, v250
v_cvt_pk_bf16_f32 v251, 0, v251
v_mul_f32 v248, v248, v240
v_mul_f32 v249, v249, v241
buffer_load_dwordx4 v34, s[80:83], s10 offen offset:2048 lds
v_mul_f32 v250, v250, v242
v_mul_f32 v251, v251, v243
v_cvt_pk_bf16_f32 v248, 0, v248
v_cvt_pk_bf16_f32 v249, 0, v249
buffer_load_dwordx4 v35, s[80:83], s10 offen offset:3072 lds
v_cvt_pk_bf16_f32 v250, 0, v250
v_cvt_pk_bf16_f32 v251, 0, v251
v_add_f32 v244, v244, v253
v_add_f32 v245, v245, v253
s_mov_b32 m0, s11
s_nop 0
buffer_load_dwordx4 v36, s[84:87], s55 offen offset:0 lds
v_add_f32 v246, v246, v253
v_add_f32 v247, v247, v253
v_add_f32 v76, v244, v248
v_add_f32 v77, v245, v249
buffer_load_dwordx4 v37, s[84:87], s55 offen offset:1024 lds
v_add_f32 v78, v246, v250
v_add_f32 v79, v247, v251
buffer_load_dwordx2 v[88:89], v3, s[56:59], s27 offen
s_add_u32 s27, s27, 8192
buffer_load_dwordx4 v38, s[84:87], s55 offen offset:2048 lds
buffer_load_dwordx2 v[90:91], v4, s[60:63], s68 offen offset:896
buffer_load_dwordx4 v39, s[84:87], s55 offen offset:3072 lds
s_add_u32 s54, s54, 0x80000
s_add_u32 s55, s55, 0x100000
s_add_u32 s53, s53, 49152
s_cmp_ge_u32 s53, 147456
s_cselect_b32 s53, s0, s53
s_waitcnt vmcnt(15)
s_barrier
s_mov_b32 m0, s53
s_add_u32 s1, s53, 16384
s_add_u32 s10, s54, s13
s_add_u32 s11, s53, 32768
buffer_load_dwordx4 v32, s[80:83], s54 offen offset:0 lds
v_lshlrev_b32 v244, 16, v80
v_and_b32 v245, s26, v80
v_lshlrev_b32 v246, 16, v81
v_and_b32 v247, s26, v81
buffer_load_dwordx4 v33, s[80:83], s54 offen offset:1024 lds
v_lshlrev_b32 v252, 16, v82
v_and_b32 v253, s26, v82
v_sub_f32 v248, v244, v252
v_sub_f32 v249, v245, v252
buffer_load_dwordx4 v34, s[80:83], s54 offen offset:2048 lds
v_sub_f32 v250, v246, v252
v_sub_f32 v251, v247, v252
v_cvt_pk_bf16_f32 v248, 0, v248
v_cvt_pk_bf16_f32 v249, 0, v249
buffer_load_dwordx4 v35, s[80:83], s54 offen offset:3072 lds
v_cvt_pk_bf16_f32 v250, 0, v250
v_cvt_pk_bf16_f32 v251, 0, v251
v_mul_f32 v248, v248, v83
v_mul_f32 v249, v249, v83
s_mov_b32 m0, s1
s_nop 0
buffer_load_dwordx4 v32, s[80:83], s10 offen offset:0 lds
v_mul_f32 v250, v250, v83
v_mul_f32 v251, v251, v83
v_cvt_pk_bf16_f32 v248, 0, v248
v_cvt_pk_bf16_f32 v249, 0, v249
buffer_load_dwordx4 v33, s[80:83], s10 offen offset:1024 lds
v_cvt_pk_bf16_f32 v250, 0, v250
v_cvt_pk_bf16_f32 v251, 0, v251
v_mul_f32 v248, v248, v240
v_mul_f32 v249, v249, v241
buffer_load_dwordx4 v34, s[80:83], s10 offen offset:2048 lds
v_mul_f32 v250, v250, v242
v_mul_f32 v251, v251, v243
v_cvt_pk_bf16_f32 v248, 0, v248
v_cvt_pk_bf16_f32 v249, 0, v249
buffer_load_dwordx4 v35, s[80:83], s10 offen offset:3072 lds
v_cvt_pk_bf16_f32 v250, 0, v250
v_cvt_pk_bf16_f32 v251, 0, v251
v_add_f32 v244, v244, v253
v_add_f32 v245, v245, v253
s_mov_b32 m0, s11
s_nop 0
buffer_load_dwordx4 v36, s[84:87], s55 offen offset:0 lds
v_add_f32 v246, v246, v253
v_add_f32 v247, v247, v253
v_add_f32 v80, v244, v248
v_add_f32 v81, v245, v249
buffer_load_dwordx4 v37, s[84:87], s55 offen offset:1024 lds
v_add_f32 v82, v246, v250
v_add_f32 v83, v247, v251
buffer_load_dwordx2 v[92:93], v3, s[56:59], s27 offen
s_add_u32 s27, s27, 8192
buffer_load_dwordx4 v38, s[84:87], s55 offen offset:2048 lds
buffer_load_dwordx2 v[94:95], v4, s[60:63], s68 offen offset:928
buffer_load_dwordx4 v39, s[84:87], s55 offen offset:3072 lds
s_add_u32 s54, s54, 0x80000
s_add_u32 s55, s55, 0x100000
s_add_u32 s53, s53, 49152
s_cmp_ge_u32 s53, 147456
s_cselect_b32 s53, s0, s53
s_waitcnt vmcnt(14)
s_barrier
s_mov_b32 m0, s53
s_add_u32 s1, s53, 16384
s_add_u32 s10, s54, s13
s_add_u32 s11, s53, 32768
buffer_load_dwordx4 v32, s[80:83], s54 offen offset:0 lds
v_lshlrev_b32 v244, 16, v84
v_and_b32 v245, s26, v84
v_lshlrev_b32 v246, 16, v85
v_and_b32 v247, s26, v85
buffer_load_dwordx4 v33, s[80:83], s54 offen offset:1024 lds
v_lshlrev_b32 v252, 16, v86
v_and_b32 v253, s26, v86
v_sub_f32 v248, v244, v252
v_sub_f32 v249, v245, v252
buffer_load_dwordx4 v34, s[80:83], s54 offen offset:2048 lds
v_sub_f32 v250, v246, v252
v_sub_f32 v251, v247, v252
v_cvt_pk_bf16_f32 v248, 0, v248
v_cvt_pk_bf16_f32 v249, 0, v249
buffer_load_dwordx4 v35, s[80:83], s54 offen offset:3072 lds
v_cvt_pk_bf16_f32 v250, 0, v250
v_cvt_pk_bf16_f32 v251, 0, v251
v_mul_f32 v248, v248, v87
v_mul_f32 v249, v249, v87
s_mov_b32 m0, s1
s_nop 0
buffer_load_dwordx4 v32, s[80:83], s10 offen offset:0 lds
v_mul_f32 v250, v250, v87
v_mul_f32 v251, v251, v87
v_cvt_pk_bf16_f32 v248, 0, v248
v_cvt_pk_bf16_f32 v249, 0, v249
buffer_load_dwordx4 v33, s[80:83], s10 offen offset:1024 lds
v_cvt_pk_bf16_f32 v250, 0, v250
v_cvt_pk_bf16_f32 v251, 0, v251
v_mul_f32 v248, v248, v240
v_mul_f32 v249, v249, v241
buffer_load_dwordx4 v34, s[80:83], s10 offen offset:2048 lds
v_mul_f32 v250, v250, v242
v_mul_f32 v251, v251, v243
v_cvt_pk_bf16_f32 v248, 0, v248
v_cvt_pk_bf16_f32 v249, 0, v249
buffer_load_dwordx4 v35, s[80:83], s10 offen offset:3072 lds
v_cvt_pk_bf16_f32 v250, 0, v250
v_cvt_pk_bf16_f32 v251, 0, v251
v_add_f32 v244, v244, v253
v_add_f32 v245, v245, v253
s_mov_b32 m0, s11
s_nop 0
buffer_load_dwordx4 v36, s[84:87], s55 offen offset:0 lds
v_add_f32 v246, v246, v253
v_add_f32 v247, v247, v253
v_add_f32 v84, v244, v248
v_add_f32 v85, v245, v249
buffer_load_dwordx4 v37, s[84:87], s55 offen offset:1024 lds
v_add_f32 v86, v246, v250
v_add_f32 v87, v247, v251
buffer_load_dwordx4 v38, s[84:87], s55 offen offset:2048 lds
buffer_load_dwordx4 v39, s[84:87], s55 offen offset:3072 lds
s_add_u32 s54, s54, 0x80000
s_add_u32 s55, s55, 0x100000
s_add_u32 s53, s53, 49152
s_cmp_ge_u32 s53, 147456
s_cselect_b32 s53, s0, s53
s_add_u32 s56, s36, 0x2000000
s_addc_u32 s57, s37, 0
s_mov_b32 s58, 0x1000000
s_mov_b32 s59, 0x20000
s_mov_b32 s64, s32
s_mov_b32 s65, s33
s_mov_b32 s66, 0x800000
s_mov_b32 s67, 0x20000
v_lshrrev_b32 v3, 4, v1
v_lshlrev_b32 v3, 10, v3
v_and_b32 v57, 15, v1
v_lshl_add_u32 v3, v57, 2, v3
v_lshlrev_b32 v3, 2, v3
s_lshl_b32 s27, s46, 1
s_add_u32 s27, s27, s23
s_lshl_b32 s27, s27, 1
s_and_b32 s50, s45, 1
s_add_u32 s27, s27, s50
s_lshl_b32 s27, s27, 9
s_lshl_b32 s51, s47, 2
s_and_b32 s50, s45, 2
s_add_u32 s51, s51, s50
s_add_u32 s51, s51, s22
s_add_u32 s27, s27, s51
s_lshl_b32 s27, s27, 8
s_lshl_b32 s51, s46, 2
s_add_u32 s51, s51, s47
s_lshl_b32 s51, s51, 2
s_add_u32 s51, s51, s45
s_lshl_b32 s51, s51, 2
s_add_u32 s51, s51, s3
s_lshl_b32 s52, s51, 14
s_mul_i32 s51, s51, 64
s_add_u32 s30, s51, 65536
v_mul_u32_u24 v54, 4, v1
v_bfe_u32 v4, v1, 1, 2
v_lshlrev_b32 v4, 10, v4
v_and_b32 v57, 1, v1
v_lshl_add_u32 v4, v57, 9, v4
v_bfe_u32 v57, v1, 3, 1
v_lshl_add_u32 v4, v57, 8, v4
v_lshrrev_b32 v57, 4, v1
v_lshl_add_u32 v4, v57, 4, v4
s_mul_i32 s48, s3, 8704
v_lshrrev_b32 v6, 4, v1
v_mul_u32_u24 v6, 272, v6
v_and_b32 v7, 15, v1
v_lshl_add_u32 v6, v7, 4, v6
v_add_u32 v6, s48, v6
s_waitcnt vmcnt(12)
s_barrier
v_lshlrev_b32 v244, 16, v88
v_and_b32 v245, s26, v88
v_lshlrev_b32 v246, 16, v89
v_and_b32 v247, s26, v89
v_lshlrev_b32 v252, 16, v90
v_and_b32 v253, s26, v90
v_sub_f32 v248, v244, v252
v_sub_f32 v249, v245, v252
v_sub_f32 v250, v246, v252
v_sub_f32 v251, v247, v252
v_cvt_pk_bf16_f32 v248, 0, v248
v_cvt_pk_bf16_f32 v249, 0, v249
v_cvt_pk_bf16_f32 v250, 0, v250
v_cvt_pk_bf16_f32 v251, 0, v251
v_mul_f32 v248, v248, v91
v_mul_f32 v249, v249, v91
v_mul_f32 v250, v250, v91
v_mul_f32 v251, v251, v91
v_cvt_pk_bf16_f32 v248, 0, v248
v_cvt_pk_bf16_f32 v249, 0, v249
v_cvt_pk_bf16_f32 v250, 0, v250
v_cvt_pk_bf16_f32 v251, 0, v251
v_mul_f32 v248, v248, v240
v_mul_f32 v249, v249, v241
v_mul_f32 v250, v250, v242
v_mul_f32 v251, v251, v243
v_cvt_pk_bf16_f32 v248, 0, v248
v_cvt_pk_bf16_f32 v249, 0, v249
v_cvt_pk_bf16_f32 v250, 0, v250
v_cvt_pk_bf16_f32 v251, 0, v251
v_add_f32 v244, v244, v253
v_add_f32 v245, v245, v253
v_add_f32 v246, v246, v253
v_add_f32 v247, v247, v253
v_add_f32 v88, v244, v248
v_add_f32 v89, v245, v249
v_add_f32 v90, v246, v250
v_add_f32 v91, v247, v251
s_waitcnt vmcnt(0)
s_barrier
v_lshlrev_b32 v244, 16, v92
v_and_b32 v245, s26, v92
v_lshlrev_b32 v246, 16, v93
v_and_b32 v247, s26, v93
v_lshlrev_b32 v252, 16, v94
v_and_b32 v253, s26, v94
v_sub_f32 v248, v244, v252
v_sub_f32 v249, v245, v252
v_sub_f32 v250, v246, v252
v_sub_f32 v251, v247, v252
v_cvt_pk_bf16_f32 v248, 0, v248
v_cvt_pk_bf16_f32 v249, 0, v249
v_cvt_pk_bf16_f32 v250, 0, v250
v_cvt_pk_bf16_f32 v251, 0, v251
v_mul_f32 v248, v248, v95
v_mul_f32 v249, v249, v95
v_mul_f32 v250, v250, v95
v_mul_f32 v251, v251, v95
v_cvt_pk_bf16_f32 v248, 0, v248
v_cvt_pk_bf16_f32 v249, 0, v249
v_cvt_pk_bf16_f32 v250, 0, v250
v_cvt_pk_bf16_f32 v251, 0, v251
v_mul_f32 v248, v248, v240
v_mul_f32 v249, v249, v241
v_mul_f32 v250, v250, v242
v_mul_f32 v251, v251, v243
v_cvt_pk_bf16_f32 v248, 0, v248
v_cvt_pk_bf16_f32 v249, 0, v249
v_cvt_pk_bf16_f32 v250, 0, v250
v_cvt_pk_bf16_f32 v251, 0, v251
v_add_f32 v244, v244, v253
v_add_f32 v245, v245, v253
v_add_f32 v246, v246, v253
v_add_f32 v247, v247, v253
v_add_f32 v92, v244, v248
v_add_f32 v93, v245, v249
v_add_f32 v94, v246, v250
v_add_f32 v95, v247, v251
s_barrier
s_barrier
ds_read_b128 v[128:131], v6 offset:0
ds_read_b128 v[132:135], v6 offset:1088
ds_read_b128 v[136:139], v6 offset:2176
ds_read_b128 v[140:143], v6 offset:3264
ds_read_b128 v[144:147], v6 offset:4352
ds_read_b128 v[148:151], v6 offset:5440
ds_read_b128 v[152:155], v6 offset:6528
ds_read_b128 v[156:159], v6 offset:7616
s_mov_b64 exec, 0x7
buffer_load_dword v53, v54, s[88:91], s30 offen offset:0 sc1
s_mov_b64 exec, -1
s_waitcnt lgkmcnt(7)
v_pk_add_f32 v[128:129], v[128:129], v[64:65]
v_pk_add_f32 v[130:131], v[130:131], v[66:67]
s_waitcnt lgkmcnt(6)
v_pk_add_f32 v[132:133], v[132:133], v[68:69]
v_pk_add_f32 v[134:135], v[134:135], v[70:71]
s_waitcnt lgkmcnt(5)
v_pk_add_f32 v[136:137], v[136:137], v[72:73]
v_pk_add_f32 v[138:139], v[138:139], v[74:75]
s_waitcnt lgkmcnt(4)
v_pk_add_f32 v[140:141], v[140:141], v[76:77]
v_pk_add_f32 v[142:143], v[142:143], v[78:79]
s_waitcnt lgkmcnt(3)
v_pk_add_f32 v[144:145], v[144:145], v[80:81]
v_pk_add_f32 v[146:147], v[146:147], v[82:83]
s_waitcnt lgkmcnt(2)
v_pk_add_f32 v[148:149], v[148:149], v[84:85]
v_pk_add_f32 v[150:151], v[150:151], v[86:87]
s_waitcnt lgkmcnt(1)
v_pk_add_f32 v[152:153], v[152:153], v[88:89]
v_pk_add_f32 v[154:155], v[154:155], v[90:91]
s_waitcnt lgkmcnt(0)
v_pk_add_f32 v[156:157], v[156:157], v[92:93]
v_pk_add_f32 v[158:159], v[158:159], v[94:95]
s_add_u32 s49, s52, 4096
s_add_u32 s50, s52, 8192
s_add_u32 s51, s27, 65536
s_mov_b32 s7, 7
s_mov_b32 s8, 32768
s_mov_b64 exec, 0x7
Lp_80:
buffer_load_dword v57, v54, s[88:91], s30 offen offset:0 sc1
s_waitcnt vmcnt(1)
Lq_87:
v_cmp_eq_u32 vcc, 1, v53
s_sub_u32 s8, s8, 1
s_cselect_b32 s6, 7, vcc_lo
s_and_b32 s6, s6, s7
s_cbranch_scc1 Lq_89
buffer_load_dword v53, v54, s[88:91], s30 offen offset:0 sc1
s_waitcnt vmcnt(1)
Lq_88:
v_cmp_eq_u32 vcc, 1, v57
s_sub_u32 s8, s8, 1
s_cselect_b32 s6, 7, vcc_lo
s_and_b32 s6, s6, s7
s_cbranch_scc1 Lq_90
s_branch Lp_80
Lq_89:
s_andn2_b32 s7, s7, s6
s_cbranch_scc0 Lq_91
buffer_load_dword v53, v54, s[88:91], s30 offen offset:0 sc1
s_mov_b64 exec, -1
s_bitcmp0_b32 s6, 0
s_cbranch_scc1 Lp_93
buffer_load_dwordx4 v[64:67], v4, s[56:59], s52 offen offset:0
buffer_load_dwordx4 v[76:79], v4, s[56:59], s52 offen offset:64
buffer_load_dwordx4 v[88:91], v4, s[56:59], s52 offen offset:128
buffer_load_dwordx4 v[100:103], v4, s[56:59], s52 offen offset:192
Lp_93:
s_bitcmp0_b32 s6, 1
s_cbranch_scc1 Lp_94
buffer_load_dwordx4 v[68:71], v4, s[56:59], s49 offen offset:0
buffer_load_dwordx4 v[80:83], v4, s[56:59], s49 offen offset:64
buffer_load_dwordx4 v[92:95], v4, s[56:59], s49 offen offset:128
buffer_load_dwordx4 v[104:107], v4, s[56:59], s49 offen offset:192
Lp_94:
s_bitcmp0_b32 s6, 2
s_cbranch_scc1 Lp_95
buffer_load_dwordx4 v[72:75], v4, s[56:59], s50 offen offset:0
buffer_load_dwordx4 v[84:87], v4, s[56:59], s50 offen offset:64
buffer_load_dwordx4 v[96:99], v4, s[56:59], s50 offen offset:128
buffer_load_dwordx4 v[108:111], v4, s[56:59], s50 offen offset:192
Lp_95:
s_mov_b64 exec, 0x7
s_bcnt1_i32_b32 s48, s6
s_cmp_eq_u32 s48, 1
s_cbranch_scc1 Lq_92
s_waitcnt vmcnt(9)
s_branch Lq_88
Lq_92:
s_waitcnt vmcnt(5)
s_branch Lq_88
Lq_90:
s_andn2_b32 s7, s7, s6
s_cbranch_scc0 Lq_91
buffer_load_dword v57, v54, s[88:91], s30 offen offset:0 sc1
s_mov_b64 exec, -1
s_bitcmp0_b32 s6, 0
s_cbranch_scc1 Lp_97
buffer_load_dwordx4 v[64:67], v4, s[56:59], s52 offen offset:0
buffer_load_dwordx4 v[76:79], v4, s[56:59], s52 offen offset:64
buffer_load_dwordx4 v[88:91], v4, s[56:59], s52 offen offset:128
buffer_load_dwordx4 v[100:103], v4, s[56:59], s52 offen offset:192
Lp_97:
s_bitcmp0_b32 s6, 1
s_cbranch_scc1 Lp_98
buffer_load_dwordx4 v[68:71], v4, s[56:59], s49 offen offset:0
buffer_load_dwordx4 v[80:83], v4, s[56:59], s49 offen offset:64
buffer_load_dwordx4 v[92:95], v4, s[56:59], s49 offen offset:128
buffer_load_dwordx4 v[104:107], v4, s[56:59], s49 offen offset:192
Lp_98:
s_bitcmp0_b32 s6, 2
s_cbranch_scc1 Lp_99
buffer_load_dwordx4 v[72:75], v4, s[56:59], s50 offen offset:0
buffer_load_dwordx4 v[84:87], v4, s[56:59], s50 offen offset:64
buffer_load_dwordx4 v[96:99], v4, s[56:59], s50 offen offset:128
buffer_load_dwordx4 v[108:111], v4, s[56:59], s50 offen offset:192
Lp_99:
s_mov_b64 exec, 0x7
s_bcnt1_i32_b32 s48, s6
s_cmp_eq_u32 s48, 1
s_cbranch_scc1 Lq_96
s_waitcnt vmcnt(9)
s_branch Lq_87
Lq_96:
s_waitcnt vmcnt(5)
s_branch Lq_87
Lq_91:
Lp_81:
s_mov_b64 exec, -1
s_bitcmp0_b32 s6, 0
s_cbranch_scc1 Lp_100
buffer_load_dwordx4 v[64:67], v4, s[56:59], s52 offen offset:0
buffer_load_dwordx4 v[76:79], v4, s[56:59], s52 offen offset:64
buffer_load_dwordx4 v[88:91], v4, s[56:59], s52 offen offset:128
buffer_load_dwordx4 v[100:103], v4, s[56:59], s52 offen offset:192
Lp_100:
s_bitcmp0_b32 s6, 1
s_cbranch_scc1 Lp_101
buffer_load_dwordx4 v[68:71], v4, s[56:59], s49 offen offset:0
buffer_load_dwordx4 v[80:83], v4, s[56:59], s49 offen offset:64
buffer_load_dwordx4 v[92:95], v4, s[56:59], s49 offen offset:128
buffer_load_dwordx4 v[104:107], v4, s[56:59], s49 offen offset:192
Lp_101:
s_bitcmp0_b32 s6, 2
s_cbranch_scc1 Lp_102
buffer_load_dwordx4 v[72:75], v4, s[56:59], s50 offen offset:0
buffer_load_dwordx4 v[84:87], v4, s[56:59], s50 offen offset:64
buffer_load_dwordx4 v[96:99], v4, s[56:59], s50 offen offset:128
buffer_load_dwordx4 v[108:111], v4, s[56:59], s50 offen offset:192
Lp_102:
s_bcnt1_i32_b32 s48, s6
s_cmp_eq_u32 s48, 1
s_cbranch_scc1 Lp_82
s_waitcnt vmcnt(8)
s_branch Lp_83
Lp_82:
s_waitcnt vmcnt(4)
Lp_83:
s_cmp_eq_u32 s7, 0
s_cbranch_scc1 Lp_86
s_mov_b64 exec, 0x7
s_branch Lp_81
Lp_86:
s_bitcmp0_b32 s6, 2
s_cbranch_scc1 Lp_103
s_waitcnt vmcnt(0)
Lp_103:
v_fma_mix_f32 v128, v72, 1.0, v128 op_sel:[0,0,0] op_sel_hi:[1,0,0]
v_fma_mix_f32 v129, v72, 1.0, v129 op_sel:[1,0,0] op_sel_hi:[1,0,0]
v_fma_mix_f32 v130, v73, 1.0, v130 op_sel:[0,0,0] op_sel_hi:[1,0,0]
v_fma_mix_f32 v131, v73, 1.0, v131 op_sel:[1,0,0] op_sel_hi:[1,0,0]
v_fma_mix_f32 v144, v74, 1.0, v144 op_sel:[0,0,0] op_sel_hi:[1,0,0]
v_fma_mix_f32 v145, v74, 1.0, v145 op_sel:[1,0,0] op_sel_hi:[1,0,0]
v_fma_mix_f32 v146, v75, 1.0, v146 op_sel:[0,0,0] op_sel_hi:[1,0,0]
v_fma_mix_f32 v147, v75, 1.0, v147 op_sel:[1,0,0] op_sel_hi:[1,0,0]
v_fma_mix_f32 v132, v84, 1.0, v132 op_sel:[0,0,0] op_sel_hi:[1,0,0]
v_fma_mix_f32 v133, v84, 1.0, v133 op_sel:[1,0,0] op_sel_hi:[1,0,0]
v_fma_mix_f32 v134, v85, 1.0, v134 op_sel:[0,0,0] op_sel_hi:[1,0,0]
v_fma_mix_f32 v135, v85, 1.0, v135 op_sel:[1,0,0] op_sel_hi:[1,0,0]
v_fma_mix_f32 v148, v86, 1.0, v148 op_sel:[0,0,0] op_sel_hi:[1,0,0]
v_fma_mix_f32 v149, v86, 1.0, v149 op_sel:[1,0,0] op_sel_hi:[1,0,0]
v_fma_mix_f32 v150, v87, 1.0, v150 op_sel:[0,0,0] op_sel_hi:[1,0,0]
v_fma_mix_f32 v151, v87, 1.0, v151 op_sel:[1,0,0] op_sel_hi:[1,0,0]
v_fma_mix_f32 v136, v96, 1.0, v136 op_sel:[0,0,0] op_sel_hi:[1,0,0]
v_fma_mix_f32 v137, v96, 1.0, v137 op_sel:[1,0,0] op_sel_hi:[1,0,0]
v_fma_mix_f32 v138, v97, 1.0, v138 op_sel:[0,0,0] op_sel_hi:[1,0,0]
v_fma_mix_f32 v139, v97, 1.0, v139 op_sel:[1,0,0] op_sel_hi:[1,0,0]
v_fma_mix_f32 v152, v98, 1.0, v152 op_sel:[0,0,0] op_sel_hi:[1,0,0]
v_fma_mix_f32 v153, v98, 1.0, v153 op_sel:[1,0,0] op_sel_hi:[1,0,0]
v_fma_mix_f32 v154, v99, 1.0, v154 op_sel:[0,0,0] op_sel_hi:[1,0,0]
v_fma_mix_f32 v155, v99, 1.0, v155 op_sel:[1,0,0] op_sel_hi:[1,0,0]
v_fma_mix_f32 v140, v108, 1.0, v140 op_sel:[0,0,0] op_sel_hi:[1,0,0]
v_fma_mix_f32 v141, v108, 1.0, v141 op_sel:[1,0,0] op_sel_hi:[1,0,0]
v_fma_mix_f32 v142, v109, 1.0, v142 op_sel:[0,0,0] op_sel_hi:[1,0,0]
v_fma_mix_f32 v143, v109, 1.0, v143 op_sel:[1,0,0] op_sel_hi:[1,0,0]
v_fma_mix_f32 v156, v110, 1.0, v156 op_sel:[0,0,0] op_sel_hi:[1,0,0]
v_fma_mix_f32 v157, v110, 1.0, v157 op_sel:[1,0,0] op_sel_hi:[1,0,0]
v_fma_mix_f32 v158, v111, 1.0, v158 op_sel:[0,0,0] op_sel_hi:[1,0,0]
v_fma_mix_f32 v159, v111, 1.0, v159 op_sel:[1,0,0] op_sel_hi:[1,0,0]
s_bitcmp0_b32 s6, 1
s_cbranch_scc1 Lp_104
s_waitcnt vmcnt(0)
Lp_104:
v_fma_mix_f32 v128, v68, 1.0, v128 op_sel:[0,0,0] op_sel_hi:[1,0,0]
v_fma_mix_f32 v129, v68, 1.0, v129 op_sel:[1,0,0] op_sel_hi:[1,0,0]
v_fma_mix_f32 v130, v69, 1.0, v130 op_sel:[0,0,0] op_sel_hi:[1,0,0]
v_fma_mix_f32 v131, v69, 1.0, v131 op_sel:[1,0,0] op_sel_hi:[1,0,0]
v_fma_mix_f32 v144, v70, 1.0, v144 op_sel:[0,0,0] op_sel_hi:[1,0,0]
v_fma_mix_f32 v145, v70, 1.0, v145 op_sel:[1,0,0] op_sel_hi:[1,0,0]
v_fma_mix_f32 v146, v71, 1.0, v146 op_sel:[0,0,0] op_sel_hi:[1,0,0]
v_fma_mix_f32 v147, v71, 1.0, v147 op_sel:[1,0,0] op_sel_hi:[1,0,0]
v_fma_mix_f32 v132, v80, 1.0, v132 op_sel:[0,0,0] op_sel_hi:[1,0,0]
v_fma_mix_f32 v133, v80, 1.0, v133 op_sel:[1,0,0] op_sel_hi:[1,0,0]
v_fma_mix_f32 v134, v81, 1.0, v134 op_sel:[0,0,0] op_sel_hi:[1,0,0]
v_fma_mix_f32 v135, v81, 1.0, v135 op_sel:[1,0,0] op_sel_hi:[1,0,0]
v_fma_mix_f32 v148, v82, 1.0, v148 op_sel:[0,0,0] op_sel_hi:[1,0,0]
v_fma_mix_f32 v149, v82, 1.0, v149 op_sel:[1,0,0] op_sel_hi:[1,0,0]
v_fma_mix_f32 v150, v83, 1.0, v150 op_sel:[0,0,0] op_sel_hi:[1,0,0]
v_fma_mix_f32 v151, v83, 1.0, v151 op_sel:[1,0,0] op_sel_hi:[1,0,0]
v_fma_mix_f32 v136, v92, 1.0, v136 op_sel:[0,0,0] op_sel_hi:[1,0,0]
v_fma_mix_f32 v137, v92, 1.0, v137 op_sel:[1,0,0] op_sel_hi:[1,0,0]
v_fma_mix_f32 v138, v93, 1.0, v138 op_sel:[0,0,0] op_sel_hi:[1,0,0]
v_fma_mix_f32 v139, v93, 1.0, v139 op_sel:[1,0,0] op_sel_hi:[1,0,0]
v_fma_mix_f32 v152, v94, 1.0, v152 op_sel:[0,0,0] op_sel_hi:[1,0,0]
v_fma_mix_f32 v153, v94, 1.0, v153 op_sel:[1,0,0] op_sel_hi:[1,0,0]
v_fma_mix_f32 v154, v95, 1.0, v154 op_sel:[0,0,0] op_sel_hi:[1,0,0]
v_fma_mix_f32 v155, v95, 1.0, v155 op_sel:[1,0,0] op_sel_hi:[1,0,0]
v_fma_mix_f32 v140, v104, 1.0, v140 op_sel:[0,0,0] op_sel_hi:[1,0,0]
v_fma_mix_f32 v141, v104, 1.0, v141 op_sel:[1,0,0] op_sel_hi:[1,0,0]
v_fma_mix_f32 v142, v105, 1.0, v142 op_sel:[0,0,0] op_sel_hi:[1,0,0]
v_fma_mix_f32 v143, v105, 1.0, v143 op_sel:[1,0,0] op_sel_hi:[1,0,0]
v_fma_mix_f32 v156, v106, 1.0, v156 op_sel:[0,0,0] op_sel_hi:[1,0,0]
v_fma_mix_f32 v157, v106, 1.0, v157 op_sel:[1,0,0] op_sel_hi:[1,0,0]
v_fma_mix_f32 v158, v107, 1.0, v158 op_sel:[0,0,0] op_sel_hi:[1,0,0]
v_fma_mix_f32 v159, v107, 1.0, v159 op_sel:[1,0,0] op_sel_hi:[1,0,0]
s_bitcmp0_b32 s6, 0
s_cbranch_scc1 Lp_105
s_waitcnt vmcnt(0)
Lp_105:
v_fma_mix_f32 v128, v64, 1.0, v128 op_sel:[0,0,0] op_sel_hi:[1,0,0]
v_fma_mix_f32 v129, v64, 1.0, v129 op_sel:[1,0,0] op_sel_hi:[1,0,0]
v_fma_mix_f32 v130, v65, 1.0, v130 op_sel:[0,0,0] op_sel_hi:[1,0,0]
v_fma_mix_f32 v131, v65, 1.0, v131 op_sel:[1,0,0] op_sel_hi:[1,0,0]
buffer_store_dwordx4 v[128:131], v3, s[64:67], s27 offen nt
s_add_u32 s27, s27, 16384
v_fma_mix_f32 v144, v66, 1.0, v144 op_sel:[0,0,0] op_sel_hi:[1,0,0]
v_fma_mix_f32 v145, v66, 1.0, v145 op_sel:[1,0,0] op_sel_hi:[1,0,0]
v_fma_mix_f32 v146, v67, 1.0, v146 op_sel:[0,0,0] op_sel_hi:[1,0,0]
v_fma_mix_f32 v147, v67, 1.0, v147 op_sel:[1,0,0] op_sel_hi:[1,0,0]
buffer_store_dwordx4 v[144:147], v3, s[64:67], s51 offen nt
s_add_u32 s51, s51, 16384
v_fma_mix_f32 v132, v76, 1.0, v132 op_sel:[0,0,0] op_sel_hi:[1,0,0]
v_fma_mix_f32 v133, v76, 1.0, v133 op_sel:[1,0,0] op_sel_hi:[1,0,0]
v_fma_mix_f32 v134, v77, 1.0, v134 op_sel:[0,0,0] op_sel_hi:[1,0,0]
v_fma_mix_f32 v135, v77, 1.0, v135 op_sel:[1,0,0] op_sel_hi:[1,0,0]
buffer_store_dwordx4 v[132:135], v3, s[64:67], s27 offen nt
s_add_u32 s27, s27, 16384
v_fma_mix_f32 v148, v78, 1.0, v148 op_sel:[0,0,0] op_sel_hi:[1,0,0]
v_fma_mix_f32 v149, v78, 1.0, v149 op_sel:[1,0,0] op_sel_hi:[1,0,0]
v_fma_mix_f32 v150, v79, 1.0, v150 op_sel:[0,0,0] op_sel_hi:[1,0,0]
v_fma_mix_f32 v151, v79, 1.0, v151 op_sel:[1,0,0] op_sel_hi:[1,0,0]
buffer_store_dwordx4 v[148:151], v3, s[64:67], s51 offen nt
s_add_u32 s51, s51, 16384
v_fma_mix_f32 v136, v88, 1.0, v136 op_sel:[0,0,0] op_sel_hi:[1,0,0]
v_fma_mix_f32 v137, v88, 1.0, v137 op_sel:[1,0,0] op_sel_hi:[1,0,0]
v_fma_mix_f32 v138, v89, 1.0, v138 op_sel:[0,0,0] op_sel_hi:[1,0,0]
v_fma_mix_f32 v139, v89, 1.0, v139 op_sel:[1,0,0] op_sel_hi:[1,0,0]
buffer_store_dwordx4 v[136:139], v3, s[64:67], s27 offen nt
s_add_u32 s27, s27, 16384
v_fma_mix_f32 v152, v90, 1.0, v152 op_sel:[0,0,0] op_sel_hi:[1,0,0]
v_fma_mix_f32 v153, v90, 1.0, v153 op_sel:[1,0,0] op_sel_hi:[1,0,0]
v_fma_mix_f32 v154, v91, 1.0, v154 op_sel:[0,0,0] op_sel_hi:[1,0,0]
v_fma_mix_f32 v155, v91, 1.0, v155 op_sel:[1,0,0] op_sel_hi:[1,0,0]
buffer_store_dwordx4 v[152:155], v3, s[64:67], s51 offen nt
s_add_u32 s51, s51, 16384
v_fma_mix_f32 v140, v100, 1.0, v140 op_sel:[0,0,0] op_sel_hi:[1,0,0]
v_fma_mix_f32 v141, v100, 1.0, v141 op_sel:[1,0,0] op_sel_hi:[1,0,0]
v_fma_mix_f32 v142, v101, 1.0, v142 op_sel:[0,0,0] op_sel_hi:[1,0,0]
v_fma_mix_f32 v143, v101, 1.0, v143 op_sel:[1,0,0] op_sel_hi:[1,0,0]
buffer_store_dwordx4 v[140:143], v3, s[64:67], s27 offen nt
s_add_u32 s27, s27, 16384
v_fma_mix_f32 v156, v102, 1.0, v156 op_sel:[0,0,0] op_sel_hi:[1,0,0]
v_fma_mix_f32 v157, v102, 1.0, v157 op_sel:[1,0,0] op_sel_hi:[1,0,0]
v_fma_mix_f32 v158, v103, 1.0, v158 op_sel:[0,0,0] op_sel_hi:[1,0,0]
v_fma_mix_f32 v159, v103, 1.0, v159 op_sel:[1,0,0] op_sel_hi:[1,0,0]
buffer_store_dwordx4 v[156:159], v3, s[64:67], s51 offen nt
s_add_u32 s51, s51, 16384
s_endpgm
.p2align 6
L_compute:
s_load_dwordx2 s[6:7], s[96:97], s98 offset:60
s_load_dwordx2 s[6:7], s[96:97], s98 offset:188
s_load_dwordx2 s[6:7], s[96:97], s98 offset:316
s_add_u32 s60, s36, 0x1900000
s_addc_u32 s61, s37, 0
s_mov_b32 s62, 0x20000
s_mov_b32 s63, 0x20000
s_cmp_lg_u32 s2, 0
s_cbranch_scc1 Lcl_2
v_mov_b32 v8, 0
v_mov_b32 v9, 0
v_mov_b32 v10, 0
v_mov_b32 v11, 0
s_lshl_b32 s48, s3, 13
s_add_u32 s49, s48, 4096
buffer_store_dwordx4 v[8:11], v2, s[60:63], s48 offen offset:0 sc1
buffer_store_dwordx4 v[8:11], v2, s[60:63], s48 offen offset:1024 sc1
buffer_store_dwordx4 v[8:11], v2, s[60:63], s48 offen offset:2048 sc1
buffer_store_dwordx4 v[8:11], v2, s[60:63], s48 offen offset:3072 sc1
buffer_store_dwordx4 v[8:11], v2, s[60:63], s49 offen offset:0 sc1
buffer_store_dwordx4 v[8:11], v2, s[60:63], s49 offen offset:1024 sc1
buffer_store_dwordx4 v[8:11], v2, s[60:63], s49 offen offset:2048 sc1
buffer_store_dwordx4 v[8:11], v2, s[60:63], s49 offen offset:3072 sc1
Lcl_2:
v_mov_b32 v6, v2
s_lshl_b32 s50, s42, 1
s_add_u32 s50, s50, s23
s_lshl_b32 s79, s50, 5
s_lshl_b32 s80, s41, 1
s_add_u32 s80, s80, s22
s_lshl_b32 s76, s41, 4
s_add_u32 s76, s76, s42
s_lshl_b32 s76, s76, 2
s_add_u32 s76, s76, s3
s_lshl_b32 s76, s76, 2
s_add_u32 s76, s76, 4096
s_lshl_b32 s77, s43, 5
s_add_u32 s77, s77, s44
s_lshl_b32 s77, s77, 3
s_add_u32 s77, s77, s3
s_lshl_b32 s77, s77, 2
s_add_u32 s77, s77, 8192
s_mov_b32 s53, 98304
s_add_u32 s56, s36, 0x400000
s_addc_u32 s57, s37, 0
s_mov_b32 s58, 0x400000
s_mov_b32 s59, 0x20000
s_add_u32 s64, s36, 0x1000000
s_addc_u32 s65, s37, 0
s_mov_b32 s66, 0x800000
s_mov_b32 s67, 0x20000
s_add_u32 s68, s36, 0x800000
s_addc_u32 s69, s37, 0
s_mov_b32 s70, 0x700000
s_mov_b32 s71, 0x20000
s_mov_b32 s72, s26
s_mov_b32 s73, s27
s_mov_b32 s74, 0x1c00
s_mov_b32 s75, 0x20000
s_add_u32 s88, s36, 0x1800000
s_addc_u32 s89, s37, 0
s_mov_b32 s90, 0x10000
s_mov_b32 s91, 0x20000
v_and_b32 v36, 31, v1
v_lshrrev_b32 v3, 5, v1
v_bfe_u32 v4, v36, 2, 1
v_lshlrev_b32 v4, 5, v4
v_lshrrev_b32 v37, 3, v36
v_lshl_add_u32 v4, v37, 2, v4
v_and_b32 v36, 3, v36
v_add_u32 v36, v36, v4
v_bfe_u32 v4, v36, 1, 2
v_bfe_u32 v37, v36, 5, 1
v_lshl_add_u32 v4, v37, 2, v4
s_lshl_b32 s48, s22, 6
v_add_u32 v36, s48, v36
v_xor_b32 v3, v3, v4
v_lshlrev_b32 v3, 4, v3
v_lshl_add_u32 v36, v36, 7, v3
v_add_u32 v24, 0, v36
v_and_b32 v36, 31, v1
v_lshrrev_b32 v3, 5, v1
v_bfe_u32 v4, v36, 1, 3
s_lshl_b32 s48, s23, 6
v_add_u32 v36, s48, v36
v_xor_b32 v3, v3, v4
v_lshlrev_b32 v3, 4, v3
v_lshl_add_u32 v36, v36, 7, v3
v_add_u32 v25, 16384, v36
v_bfe_u32 v38, v1, 2, 2
v_mul_u32_u24 v38, 2176, v38
v_bfe_u32 v3, v1, 1, 1
v_lshl_add_u32 v38, v3, 3, v38
v_lshrrev_b32 v3, 4, v1
v_lshl_add_u32 v38, v3, 4, v38
v_and_b32 v3, 1, v1
v_lshl_add_u32 v38, v3, 6, v38
s_lshl_b32 s48, s3, 7
s_add_u32 s48, s48, 0x20000
v_add_u32 v38, s48, v38
s_waitcnt vmcnt(8)
s_cmp_eq_u32 s2, 0
s_cbranch_scc1 Lcl_3
s_waitcnt vmcnt(0)
Lcl_3:
s_mov_b32 s49, 0x3f803f80
s_mov_b32 s50, 0x3f80
s_mov_b32 s51, 0x3f800000
v_dot2_f32_bf16 v80, v64, s49, 0
v_dot2_f32_bf16 v81, v64, v64, 0
v_dot2_f32_bf16 v82, v72, s49, 0
v_dot2_f32_bf16 v80, v65, s49, v80
v_dot2_f32_bf16 v81, v65, v65, v81
v_dot2_f32_bf16 v82, v73, s49, v82
v_dot2_f32_bf16 v80, v66, s49, v80
v_dot2_f32_bf16 v81, v66, v66, v81
v_dot2_f32_bf16 v82, v74, s49, v82
v_dot2_f32_bf16 v80, v67, s49, v80
v_dot2_f32_bf16 v81, v67, v67, v81
v_dot2_f32_bf16 v82, v75, s49, v82
v_dot2_f32_bf16 v80, v68, s49, v80
v_dot2_f32_bf16 v81, v68, v68, v81
v_dot2_f32_bf16 v82, v76, s49, v82
v_dot2_f32_bf16 v80, v69, s49, v80
v_dot2_f32_bf16 v81, v69, v69, v81
v_dot2_f32_bf16 v82, v77, s49, v82
v_dot2_f32_bf16 v80, v70, s49, v80
v_dot2_f32_bf16 v81, v70, v70, v81
v_dot2_f32_bf16 v82, v78, s49, v82
v_dot2_f32_bf16 v80, v71, s49, v80
v_dot2_f32_bf16 v81, v71, v71, v81
v_dot2_f32_bf16 v82, v79, s49, v82
s_nop 3
v_add_f32 v80, v80, v80 quad_perm:[1,0,3,2] row_mask:0xf bank_mask:0xf
v_add_f32 v81, v81, v81 quad_perm:[1,0,3,2] row_mask:0xf bank_mask:0xf
v_add_f32 v82, v82, v82 quad_perm:[1,0,3,2] row_mask:0xf bank_mask:0xf
v_add_f32 v80, v80, v80 quad_perm:[2,3,0,1] row_mask:0xf bank_mask:0xf
v_add_f32 v81, v81, v81 quad_perm:[2,3,0,1] row_mask:0xf bank_mask:0xf
v_add_f32 v82, v82, v82 quad_perm:[2,3,0,1] row_mask:0xf bank_mask:0xf
v_add_f32 v80, v80, v80 row_half_mirror row_mask:0xf bank_mask:0xf
v_add_f32 v81, v81, v81 row_half_mirror row_mask:0xf bank_mask:0xf
v_add_f32 v82, v82, v82 row_half_mirror row_mask:0xf bank_mask:0xf
v_add_f32 v80, v80, v80 row_mirror row_mask:0xf bank_mask:0xf
v_add_f32 v81, v81, v81 row_mirror row_mask:0xf bank_mask:0xf
v_add_f32 v82, v82, v82 row_mirror row_mask:0xf bank_mask:0xf
v_mov_b32 v84, v80
v_mov_b32 v85, v81
v_mov_b32 v86, v82
v_permlane16_swap_b32 v84, v80
v_permlane16_swap_b32 v85, v81
v_permlane16_swap_b32 v86, v82
v_add_f32 v80, v80, v84
v_add_f32 v81, v81, v85
v_add_f32 v82, v82, v86
v_mov_b32 v84, v80
v_mov_b32 v85, v81
v_mov_b32 v86, v82
v_permlane32_swap_b32 v84, v80
v_permlane32_swap_b32 v85, v81
v_permlane32_swap_b32 v86, v82
v_add_f32 v80, v80, v84
v_add_f32 v81, v81, v85
v_add_f32 v82, v82, v86
v_mul_f32 v80, 0x3a800000, v80
v_mul_f32 v81, 0x3a800000, v81
v_fma_f32 v81, -v80, v80, v81
v_max_f32 v81, 0, v81
v_cvt_pk_bf16_f32 v81, 0, v81
v_add_f32 v81, 0x3727c5ac, v81
v_cvt_pk_bf16_f32 v81, 0, v81
v_sqrt_f32 v81, v81
v_cvt_pk_bf16_f32 v80, 0, v80
v_xor_b32 v89, 0x80000000, v80
v_cvt_pk_bf16_f32 v81, 0, v81
v_rcp_f32 v81, v81
v_dot2_f32_bf16 v96, v64, s50, v89
v_dot2_f32_bf16 v97, v64, s51, v89
v_dot2_f32_bf16 v98, v65, s50, v89
v_dot2_f32_bf16 v99, v65, s51, v89
v_dot2_f32_bf16 v100, v66, s50, v89
v_dot2_f32_bf16 v101, v66, s51, v89
v_dot2_f32_bf16 v102, v67, s50, v89
v_dot2_f32_bf16 v103, v67, s51, v89
v_dot2_f32_bf16 v104, v68, s50, v89
v_dot2_f32_bf16 v105, v68, s51, v89
v_dot2_f32_bf16 v106, v69, s50, v89
v_dot2_f32_bf16 v107, v69, s51, v89
v_dot2_f32_bf16 v108, v70, s50, v89
v_dot2_f32_bf16 v109, v70, s51, v89
v_dot2_f32_bf16 v110, v71, s50, v89
v_dot2_f32_bf16 v111, v71, s51, v89
v_mov_b32 v87, v80
v_mov_b32 v88, v81
s_nop 1
v_cvt_pk_bf16_f32 v96, 0, v96
v_cvt_pk_bf16_f32 v97, 0, v97
v_cvt_pk_bf16_f32 v98, 0, v98
v_cvt_pk_bf16_f32 v99, 0, v99
v_cvt_pk_bf16_f32 v100, 0, v100
v_cvt_pk_bf16_f32 v101, 0, v101
v_cvt_pk_bf16_f32 v102, 0, v102
v_cvt_pk_bf16_f32 v103, 0, v103
v_cvt_pk_bf16_f32 v104, 0, v104
v_cvt_pk_bf16_f32 v105, 0, v105
v_cvt_pk_bf16_f32 v106, 0, v106
v_cvt_pk_bf16_f32 v107, 0, v107
v_cvt_pk_bf16_f32 v108, 0, v108
v_cvt_pk_bf16_f32 v109, 0, v109
v_cvt_pk_bf16_f32 v110, 0, v110
v_cvt_pk_bf16_f32 v111, 0, v111
v_pk_mul_f32 v[96:97], v[96:97], v[80:81] op_sel:[0,1] op_sel_hi:[1,1]
v_pk_mul_f32 v[98:99], v[98:99], v[80:81] op_sel:[0,1] op_sel_hi:[1,1]
v_pk_mul_f32 v[100:101], v[100:101], v[80:81] op_sel:[0,1] op_sel_hi:[1,1]
v_pk_mul_f32 v[102:103], v[102:103], v[80:81] op_sel:[0,1] op_sel_hi:[1,1]
v_pk_mul_f32 v[104:105], v[104:105], v[80:81] op_sel:[0,1] op_sel_hi:[1,1]
v_pk_mul_f32 v[106:107], v[106:107], v[80:81] op_sel:[0,1] op_sel_hi:[1,1]
v_pk_mul_f32 v[108:109], v[108:109], v[80:81] op_sel:[0,1] op_sel_hi:[1,1]
v_pk_mul_f32 v[110:111], v[110:111], v[80:81] op_sel:[0,1] op_sel_hi:[1,1]
v_cvt_pk_bf16_f32 v64, v96, v97
v_cvt_pk_bf16_f32 v65, v98, v99
v_cvt_pk_bf16_f32 v66, v100, v101
v_cvt_pk_bf16_f32 v67, v102, v103
v_cvt_pk_bf16_f32 v68, v104, v105
v_cvt_pk_bf16_f32 v69, v106, v107
v_cvt_pk_bf16_f32 v70, v108, v109
v_cvt_pk_bf16_f32 v71, v110, v111
v_dot2_f32_bf16 v80, v64, s49, 0
v_dot2_f32_bf16 v81, v64, v64, 0
v_dot2_f32_bf16 v80, v65, s49, v80
v_dot2_f32_bf16 v81, v65, v65, v81
v_dot2_f32_bf16 v80, v66, s49, v80
v_dot2_f32_bf16 v81, v66, v66, v81
v_dot2_f32_bf16 v80, v67, s49, v80
v_dot2_f32_bf16 v81, v67, v67, v81
v_dot2_f32_bf16 v80, v68, s49, v80
v_dot2_f32_bf16 v81, v68, v68, v81
v_dot2_f32_bf16 v80, v69, s49, v80
v_dot2_f32_bf16 v81, v69, v69, v81
v_dot2_f32_bf16 v80, v70, s49, v80
v_dot2_f32_bf16 v81, v70, v70, v81
v_dot2_f32_bf16 v80, v71, s49, v80
v_dot2_f32_bf16 v81, v71, v71, v81
s_nop 3
v_add_f32 v80, v80, v80 quad_perm:[1,0,3,2] row_mask:0xf bank_mask:0xf
v_add_f32 v81, v81, v81 quad_perm:[1,0,3,2] row_mask:0xf bank_mask:0xf
s_nop 0
v_add_f32 v80, v80, v80 quad_perm:[2,3,0,1] row_mask:0xf bank_mask:0xf
v_add_f32 v81, v81, v81 quad_perm:[2,3,0,1] row_mask:0xf bank_mask:0xf
s_nop 0
v_add_f32 v80, v80, v80 row_half_mirror row_mask:0xf bank_mask:0xf
v_add_f32 v81, v81, v81 row_half_mirror row_mask:0xf bank_mask:0xf
s_nop 0
v_add_f32 v80, v80, v80 row_mirror row_mask:0xf bank_mask:0xf
v_add_f32 v81, v81, v81 row_mirror row_mask:0xf bank_mask:0xf
s_nop 0
v_mov_b32 v84, v80
v_mov_b32 v85, v81
s_nop 0
v_permlane16_swap_b32 v84, v80
v_permlane16_swap_b32 v85, v81
s_nop 0
v_add_f32 v80, v80, v84
v_add_f32 v81, v81, v85
s_nop 0
v_mov_b32 v84, v80
v_mov_b32 v85, v81
s_nop 0
v_permlane32_swap_b32 v84, v80
v_permlane32_swap_b32 v85, v81
s_nop 0
v_add_f32 v80, v80, v84
v_add_f32 v81, v81, v85
s_nop 0
v_mul_f32 v80, 0x3a800000, v80
v_mul_f32 v81, 0x3a800000, v81
v_fma_f32 v81, -v80, v80, v81
v_max_f32 v81, 0, v81
v_cvt_pk_bf16_f32 v81, 0, v81
v_add_f32 v81, 0x3727c5ac, v81
v_cvt_pk_bf16_f32 v81, 0, v81
v_sqrt_f32 v81, v81
v_cvt_pk_bf16_f32 v80, 0, v80
v_xor_b32 v89, 0x80000000, v80
v_cvt_pk_bf16_f32 v81, 0, v81
v_rcp_f32 v81, v81
v_dot2_f32_bf16 v96, v64, s50, v89
v_dot2_f32_bf16 v97, v64, s51, v89
v_dot2_f32_bf16 v98, v65, s50, v89
v_dot2_f32_bf16 v99, v65, s51, v89
v_dot2_f32_bf16 v100, v66, s50, v89
v_dot2_f32_bf16 v101, v66, s51, v89
v_dot2_f32_bf16 v102, v67, s50, v89
v_dot2_f32_bf16 v103, v67, s51, v89
v_dot2_f32_bf16 v104, v68, s50, v89
v_dot2_f32_bf16 v105, v68, s51, v89
v_dot2_f32_bf16 v106, v69, s50, v89
v_dot2_f32_bf16 v107, v69, s51, v89
v_dot2_f32_bf16 v108, v70, s50, v89
v_dot2_f32_bf16 v109, v70, s51, v89
v_dot2_f32_bf16 v110, v71, s50, v89
v_dot2_f32_bf16 v111, v71, s51, v89
s_nop 1
v_cvt_pk_bf16_f32 v96, 0, v96
v_cvt_pk_bf16_f32 v97, 0, v97
v_cvt_pk_bf16_f32 v98, 0, v98
v_cvt_pk_bf16_f32 v99, 0, v99
v_cvt_pk_bf16_f32 v100, 0, v100
v_cvt_pk_bf16_f32 v101, 0, v101
v_cvt_pk_bf16_f32 v102, 0, v102
v_cvt_pk_bf16_f32 v103, 0, v103
v_cvt_pk_bf16_f32 v104, 0, v104
v_cvt_pk_bf16_f32 v105, 0, v105
v_cvt_pk_bf16_f32 v106, 0, v106
v_cvt_pk_bf16_f32 v107, 0, v107
v_cvt_pk_bf16_f32 v108, 0, v108
v_cvt_pk_bf16_f32 v109, 0, v109
v_cvt_pk_bf16_f32 v110, 0, v110
v_cvt_pk_bf16_f32 v111, 0, v111
v_pk_mul_f32 v[96:97], v[96:97], v[80:81] op_sel:[0,1] op_sel_hi:[1,1]
v_pk_mul_f32 v[98:99], v[98:99], v[80:81] op_sel:[0,1] op_sel_hi:[1,1]
v_pk_mul_f32 v[100:101], v[100:101], v[80:81] op_sel:[0,1] op_sel_hi:[1,1]
v_pk_mul_f32 v[102:103], v[102:103], v[80:81] op_sel:[0,1] op_sel_hi:[1,1]
v_pk_mul_f32 v[104:105], v[104:105], v[80:81] op_sel:[0,1] op_sel_hi:[1,1]
v_pk_mul_f32 v[106:107], v[106:107], v[80:81] op_sel:[0,1] op_sel_hi:[1,1]
v_pk_mul_f32 v[108:109], v[108:109], v[80:81] op_sel:[0,1] op_sel_hi:[1,1]
v_pk_mul_f32 v[110:111], v[110:111], v[80:81] op_sel:[0,1] op_sel_hi:[1,1]
v_cvt_pk_bf16_f32 v64, v96, v97
v_cvt_pk_bf16_f32 v65, v98, v99
v_cvt_pk_bf16_f32 v66, v100, v101
v_cvt_pk_bf16_f32 v67, v102, v103
v_cvt_pk_bf16_f32 v68, v104, v105
v_cvt_pk_bf16_f32 v69, v106, v107
v_cvt_pk_bf16_f32 v70, v108, v109
v_cvt_pk_bf16_f32 v71, v110, v111
s_mul_i32 s49, s38, 2176
s_add_u32 s49, s49, 0x20000
v_add_u32 v3, s49, v2
ds_write_b128 v3, v[64:67]
ds_write_b128 v3, v[68:71] offset:1024
v_lshrrev_b32 v84, 16, v87
v_lshl_or_b32 v84, v83, 16, v84
v_cmp_eq_u32 vcc, 1, v1
v_cndmask_b32 v87, v87, v88, vcc
v_cmp_eq_u32 vcc, 2, v1
v_cndmask_b32 v87, v87, v82, vcc
v_cmp_eq_u32 vcc, 3, v1
v_cndmask_b32 v87, v87, v84, vcc
v_cmp_eq_u32 vcc, 4, v1
v_cndmask_b32 v87, v87, v88, vcc
s_lshl_b32 s49, s38, 2
s_add_u32 s49, s49, 0x24400
v_lshl_add_u32 v3, v1, 5, s49
s_lshl_b32 s50, s38, 3
s_add_u32 s50, s50, 0x24474
v_lshl_add_u32 v4, v1, 2, s50
v_cmp_lt_u32 vcc, 2, v1
v_cndmask_b32 v3, v3, v4, vcc
s_mov_b64 exec, 31
ds_write_b32 v3, v87
s_mov_b64 exec, -1
s_cmp_lg_u32 s2, 0
s_cbranch_scc1 Lcm_4
s_mov_b32 s92, s34
s_mov_b32 s93, s35
s_mov_b32 s94, 0x100
s_mov_b32 s95, 0x20000
v_mov_b32 v3, 1
v_mov_b32 v4, 0
s_lshl_b32 s48, s3, 2
s_waitcnt vmcnt(0)
s_mov_b64 exec, 1
buffer_store_dword v3, v4, s[92:95], s48 offen sc1
s_mov_b64 exec, -1
Lcm_4:
v_add_u32 v16, s53, v24
v_xor_b32 v17, 32, v16
v_xor_b32 v18, 64, v16
v_xor_b32 v19, 96, v16
v_add_u32 v20, s53, v25
v_xor_b32 v21, 32, v20
v_xor_b32 v22, 64, v20
v_xor_b32 v23, 96, v20
s_waitcnt lgkmcnt(0)
s_barrier
ds_read_b128 v[40:43], v16 offset:0
ds_read_b128 v[48:51], v20 offset:0
ds_read_b128 v[52:55], v20 offset:4096
ds_read_b128 v[44:47], v16 offset:2048
ds_read_b128 v[56:59], v17 offset:0
ds_read_b128 v[64:67], v21 offset:0
ds_read_b128 v[68:71], v21 offset:4096
ds_read_b128 v[60:63], v17 offset:2048
s_waitcnt lgkmcnt(4)
v_mfma_f32_32x32x16_bf16 v[128:143], v[40:43], v[48:51], 0
ds_read_b128 v[72:75], v18 offset:0
ds_read_b64_tr_b16 v[192:193], v38 offset:0
ds_read_b64_tr_b16 v[194:195], v38 offset:8704
v_mfma_f32_32x32x16_bf16 v[144:159], v[40:43], v[52:55], 0
ds_read_b128 v[80:83], v22 offset:0
ds_read_b64_tr_b16 v[196:197], v38 offset:512
ds_read_b64_tr_b16 v[198:199], v38 offset:9216
ds_read_b64_tr_b16 v[200:201], v38 offset:1024
ds_read_b64_tr_b16 v[202:203], v38 offset:9728
v_mfma_f32_32x32x16_bf16 v[160:175], v[44:47], v[48:51], 0
ds_read_b128 v[84:87], v22 offset:4096
ds_read_b64_tr_b16 v[204:205], v38 offset:1536
ds_read_b64_tr_b16 v[206:207], v38 offset:10240
v_mfma_f32_32x32x16_bf16 v[176:191], v[44:47], v[52:55], 0
ds_read_b128 v[76:79], v18 offset:2048
v_lshlrev_b32 v4, 2, v1
v_add_u32 v3, 0x24400, v4
ds_read_b32 v208, v3
s_lshl_b32 s81, s2, 14
v_lshlrev_b32 v3, 4, v0
s_lshl_b32 s82, s2, 8
s_waitcnt lgkmcnt(4)
v_mfma_f32_32x32x16_bf16 v[128:143], v[56:59], v[64:67], v[128:143]
ds_read_b128 v[88:91], v19 offset:0
v_mfma_f32_32x32x16_bf16 v[144:159], v[56:59], v[68:71], v[144:159]
ds_read_b128 v[96:99], v23 offset:0
v_mfma_f32_32x32x16_bf16 v[160:175], v[60:63], v[64:67], v[160:175]
ds_read_b128 v[100:103], v23 offset:4096
v_mfma_f32_32x32x16_bf16 v[176:191], v[60:63], v[68:71], v[176:191]
ds_read_b128 v[92:95], v19 offset:2048
s_add_u32 s53, s53, 32768
s_cmp_ge_u32 s53, 131072
s_cselect_b32 s53, 0, s53
s_waitcnt lgkmcnt(4)
v_mfma_f32_32x32x16_bf16 v[128:143], v[72:75], v[80:83], v[128:143]
v_add_u32 v16, s53, v24
v_xor_b32 v17, 32, v16
v_mfma_f32_32x32x16_bf16 v[144:159], v[72:75], v[84:87], v[144:159]
v_xor_b32 v18, 64, v16
v_xor_b32 v19, 96, v16
v_mfma_f32_32x32x16_bf16 v[160:175], v[76:79], v[80:83], v[160:175]
v_add_u32 v20, s53, v25
v_xor_b32 v21, 32, v20
v_mfma_f32_32x32x16_bf16 v[176:191], v[76:79], v[84:87], v[176:191]
v_xor_b32 v22, 64, v20
v_xor_b32 v23, 96, v20
s_waitcnt lgkmcnt(0)
s_barrier
v_mfma_f32_32x32x16_bf16 v[128:143], v[88:91], v[96:99], v[128:143]
ds_read_b128 v[40:43], v16 offset:0
ds_read_b128 v[48:51], v20 offset:0
buffer_store_dwordx4 v[192:195], v3, s[56:59], s81 offen sc1
s_add_u32 s81, s81, 4096
v_mfma_f32_32x32x16_bf16 v[144:159], v[88:91], v[100:103], v[144:159]
ds_read_b128 v[52:55], v20 offset:4096
ds_read_b128 v[44:47], v16 offset:2048
buffer_store_dwordx4 v[196:199], v3, s[56:59], s81 offen sc1
s_add_u32 s81, s81, 4096
v_mfma_f32_32x32x16_bf16 v[160:175], v[92:95], v[96:99], v[160:175]
ds_read_b128 v[56:59], v17 offset:0
ds_read_b128 v[64:67], v21 offset:0
buffer_store_dwordx4 v[200:203], v3, s[56:59], s81 offen sc1
s_add_u32 s81, s81, 4096
buffer_store_dwordx4 v[204:207], v3, s[56:59], s81 offen sc1
s_add_u32 s81, s81, 4096
v_mfma_f32_32x32x16_bf16 v[176:191], v[92:95], v[100:103], v[176:191]
ds_read_b128 v[68:71], v21 offset:4096
ds_read_b128 v[60:63], v17 offset:2048
s_cmp_lg_u32 s3, 0
s_cbranch_scc1 Lw_5
buffer_store_dword v208, v4, s[88:91], s82 offen sc1
Lw_5:
s_waitcnt lgkmcnt(4)
v_mfma_f32_32x32x16_bf16 v[128:143], v[40:43], v[48:51], v[128:143]
ds_read_b128 v[72:75], v18 offset:0
s_lshl_b32 s81, s46, 2
s_add_u32 s81, s81, s47
s_lshl_b32 s81, s81, 2
s_add_u32 s81, s81, s45
s_lshl_b32 s81, s81, 2
s_add_u32 s81, s81, s3
s_mul_i32 s81, s81, 64
s_add_u32 s81, s81, 65536
v_mfma_f32_32x32x16_bf16 v[144:159], v[40:43], v[52:55], v[144:159]
ds_read_b128 v[80:83], v22 offset:0
v_mov_b32 v209, 0
v_mul_u32_u24 v210, 4, v1
s_mov_b64 exec, 7
buffer_store_dword v209, v210, s[60:63], s81 offen sc1
s_mov_b64 exec, -1
v_mfma_f32_32x32x16_bf16 v[160:175], v[44:47], v[48:51], v[160:175]
ds_read_b128 v[84:87], v22 offset:4096
s_mov_b32 s92, s24
s_mov_b32 s93, s25
s_mov_b32 s94, 0xe00000
s_mov_b32 s95, 0x20000
v_mfma_f32_32x32x16_bf16 v[176:191], v[44:47], v[52:55], v[176:191]
ds_read_b128 v[76:79], v18 offset:2048
s_lshl_b32 s85, s2, 2
s_add_u32 s85, s85, s3
s_lshl_b32 s85, s85, 10
v_bfe_u32 v36, v1, 2, 2
v_lshrrev_b32 v3, 5, v1
v_lshl_add_u32 v3, v3, 3, v36
v_lshlrev_b32 v3, 8, v3
s_waitcnt lgkmcnt(4)
v_mfma_f32_32x32x16_bf16 v[128:143], v[56:59], v[64:67], v[128:143]
ds_read_b128 v[88:91], v19 offset:0
v_bfe_u32 v4, v1, 4, 1
v_lshlrev_b32 v4, 5, v4
v_and_b32 v37, 1, v1
v_lshl_add_u32 v4, v37, 4, v4
v_bfe_u32 v37, v1, 1, 1
v_lshl_add_u32 v4, v37, 3, v4
v_mfma_f32_32x32x16_bf16 v[144:159], v[56:59], v[68:71], v[144:159]
ds_read_b128 v[96:99], v23 offset:0
v_add_u32 v3, v3, v4
v_add_u32 v3, 0, v3
s_lshl_b32 s48, s22, 1
v_xor_b32 v4, s48, v36
v_lshl_add_u32 v26, v4, 6, v3
v_mfma_f32_32x32x16_bf16 v[160:175], v[60:63], v[64:67], v[160:175]
ds_read_b128 v[100:103], v23 offset:4096
v_and_b32 v36, 31, v1
v_lshrrev_b32 v3, 5, v1
v_lshlrev_b32 v36, 4, v36
v_lshl_add_u32 v36, v3, 11, v36
s_lshl_b32 s48, s23, 10
s_add_u32 s48, s48, 16384
v_add_u32 v27, s48, v36
v_bfe_u32 v36, v1, 1, 1
v_mfma_f32_32x32x16_bf16 v[176:191], v[60:63], v[68:71], v[176:191]
ds_read_b128 v[92:95], v19 offset:2048
v_bfe_u32 v3, v1, 2, 2
v_lshrrev_b32 v4, 4, v1
v_lshl_add_u32 v3, v4, 3, v3
s_add_u32 s53, s53, 32768
s_cmp_ge_u32 s53, 131072
s_cselect_b32 s53, 0, s53
s_waitcnt lgkmcnt(4)
v_mfma_f32_32x32x16_bf16 v[128:143], v[72:75], v[80:83], v[128:143]
v_add_u32 v16, s53, v24
v_xor_b32 v17, 32, v16
v_lshlrev_b32 v4, 2, v36
v_xor_b32 v3, v3, v4
v_lshlrev_b32 v3, 4, v3
v_lshl_add_u32 v3, v36, 10, v3
v_and_b32 v4, 1, v1
v_lshl_add_u32 v3, v4, 3, v3
v_mfma_f32_32x32x16_bf16 v[144:159], v[72:75], v[84:87], v[144:159]
v_xor_b32 v18, 64, v16
v_xor_b32 v19, 96, v16
s_lshl_b32 s48, s23, 13
s_add_u32 s48, s48, 32768
v_add_u32 v28, s48, v3
v_and_b32 v36, 15, v1
v_lshrrev_b32 v3, 4, v1
v_lshlrev_b32 v36, 4, v36
v_lshl_add_u32 v36, v3, 11, v36
v_mfma_f32_32x32x16_bf16 v[160:175], v[76:79], v[80:83], v[160:175]
v_add_u32 v20, s53, v25
v_xor_b32 v21, 32, v20
s_lshl_b32 s48, s22, 10
s_add_u32 s48, s48, 0
v_add_u32 v29, s48, v36
v_bfe_u32 v36, v1, 2, 2
v_lshrrev_b32 v3, 4, v1
v_lshl_add_u32 v3, v3, 3, v36
v_lshlrev_b32 v3, 8, v3
v_mfma_f32_32x32x16_bf16 v[176:191], v[76:79], v[84:87], v[176:191]
v_xor_b32 v22, 64, v20
v_xor_b32 v23, 96, v20
v_bfe_u32 v4, v1, 4, 1
v_lshlrev_b32 v4, 5, v4
v_and_b32 v37, 3, v1
v_lshl_add_u32 v4, v37, 3, v4
v_add_u32 v3, v3, v4
v_add_u32 v3, 32768, v3
s_waitcnt lgkmcnt(0)
s_barrier
v_mfma_f32_32x32x16_bf16 v[128:143], v[88:91], v[96:99], v[128:143]
ds_read_b128 v[40:43], v16 offset:0
ds_read_b128 v[48:51], v20 offset:0
v_mfma_f32_32x32x16_bf16 v[144:159], v[88:91], v[100:103], v[144:159]
ds_read_b128 v[52:55], v20 offset:4096
ds_read_b128 v[44:47], v16 offset:2048
s_lshl_b32 s48, s23, 1
s_and_b32 s49, s45, 1
s_add_u32 s48, s48, s49
v_xor_b32 v4, s48, v36
v_lshl_add_u32 v39, v4, 6, v3
v_mfma_f32_32x32x16_bf16 v[160:175], v[92:95], v[96:99], v[160:175]
ds_read_b128 v[56:59], v17 offset:0
ds_read_b128 v[64:67], v21 offset:0
v_and_b32 v3, 31, v1
v_lshlrev_b32 v7, 3, v3
v_add_u32 v3, s79, v3
v_mfma_f32_32x32x16_bf16 v[176:191], v[92:95], v[100:103], v[176:191]
ds_read_b128 v[68:71], v21 offset:4096
ds_read_b128 v[60:63], v17 offset:2048
v_lshrrev_b32 v35, 3, v3
v_lshlrev_b32 v35, 8, v35
v_and_b32 v3, 7, v3
v_lshl_add_u32 v35, v3, 2, v35
s_waitcnt lgkmcnt(4)
v_mfma_f32_32x32x16_bf16 v[128:143], v[40:43], v[48:51], v[128:143]
ds_read_b128 v[72:75], v18 offset:0
v_lshrrev_b32 v34, 5, v1
v_lshlrev_b32 v34, 10, v34
v_bfe_u32 v3, v1, 3, 1
v_lshl_add_u32 v34, v3, 8, v34
v_and_b32 v3, 7, v1
v_lshl_add_u32 v34, v3, 2, v34
s_lshl_b32 s81, s80, 11
s_mov_b32 s82, 32768
v_mfma_f32_32x32x16_bf16 v[144:159], v[40:43], v[52:55], v[144:159]
ds_read_b128 v[80:83], v22 offset:0
s_lshl_b32 s48, s23, 10
s_add_u32 s48, s48, 0x24500
v_lshl_add_u32 v36, v7, 2, s48
v_mfma_f32_32x32x16_bf16 v[160:175], v[44:47], v[48:51], v[160:175]
ds_read_b128 v[84:87], v22 offset:4096
v_mfma_f32_32x32x16_bf16 v[176:191], v[44:47], v[52:55], v[176:191]
ds_read_b128 v[76:79], v18 offset:2048
s_waitcnt lgkmcnt(4)
v_mfma_f32_32x32x16_bf16 v[128:143], v[56:59], v[64:67], v[128:143]
ds_read_b128 v[88:91], v19 offset:0
v_mfma_f32_32x32x16_bf16 v[144:159], v[56:59], v[68:71], v[144:159]
ds_read_b128 v[96:99], v23 offset:0
v_mfma_f32_32x32x16_bf16 v[160:175], v[60:63], v[64:67], v[160:175]
ds_read_b128 v[100:103], v23 offset:4096
v_mfma_f32_32x32x16_bf16 v[176:191], v[60:63], v[68:71], v[176:191]
ds_read_b128 v[92:95], v19 offset:2048
s_add_u32 s53, s53, 32768
s_cmp_ge_u32 s53, 131072
s_cselect_b32 s53, 0, s53
s_waitcnt lgkmcnt(4)
v_mfma_f32_32x32x16_bf16 v[128:143], v[72:75], v[80:83], v[128:143]
v_add_u32 v16, s53, v24
v_xor_b32 v17, 32, v16
v_mfma_f32_32x32x16_bf16 v[144:159], v[72:75], v[84:87], v[144:159]
v_xor_b32 v18, 64, v16
v_xor_b32 v19, 96, v16
v_mfma_f32_32x32x16_bf16 v[160:175], v[76:79], v[80:83], v[160:175]
v_add_u32 v20, s53, v25
v_xor_b32 v21, 32, v20
v_mfma_f32_32x32x16_bf16 v[176:191], v[76:79], v[84:87], v[176:191]
v_xor_b32 v22, 64, v20
v_xor_b32 v23, 96, v20
s_waitcnt lgkmcnt(0)
s_barrier
v_mfma_f32_32x32x16_bf16 v[128:143], v[88:91], v[96:99], v[128:143]
ds_read_b128 v[40:43], v16 offset:0
ds_read_b128 v[48:51], v20 offset:0
v_mfma_f32_32x32x16_bf16 v[144:159], v[88:91], v[100:103], v[144:159]
ds_read_b128 v[52:55], v20 offset:4096
ds_read_b128 v[44:47], v16 offset:2048
v_mfma_f32_32x32x16_bf16 v[160:175], v[92:95], v[96:99], v[160:175]
ds_read_b128 v[56:59], v17 offset:0
ds_read_b128 v[64:67], v21 offset:0
v_mfma_f32_32x32x16_bf16 v[176:191], v[92:95], v[100:103], v[176:191]
ds_read_b128 v[68:71], v21 offset:4096
ds_read_b128 v[60:63], v17 offset:2048
s_waitcnt lgkmcnt(4)
v_mfma_f32_32x32x16_bf16 v[128:143], v[40:43], v[48:51], v[128:143]
ds_read_b128 v[72:75], v18 offset:0
v_mfma_f32_32x32x16_bf16 v[144:159], v[40:43], v[52:55], v[144:159]
ds_read_b128 v[80:83], v22 offset:0
v_mfma_f32_32x32x16_bf16 v[160:175], v[44:47], v[48:51], v[160:175]
ds_read_b128 v[84:87], v22 offset:4096
v_mfma_f32_32x32x16_bf16 v[176:191], v[44:47], v[52:55], v[176:191]
ds_read_b128 v[76:79], v18 offset:2048
s_waitcnt lgkmcnt(4)
v_mfma_f32_32x32x16_bf16 v[128:143], v[56:59], v[64:67], v[128:143]
ds_read_b128 v[88:91], v19 offset:0
v_mfma_f32_32x32x16_bf16 v[144:159], v[56:59], v[68:71], v[144:159]
ds_read_b128 v[96:99], v23 offset:0
v_mfma_f32_32x32x16_bf16 v[160:175], v[60:63], v[64:67], v[160:175]
ds_read_b128 v[100:103], v23 offset:4096
v_mfma_f32_32x32x16_bf16 v[176:191], v[60:63], v[68:71], v[176:191]
ds_read_b128 v[92:95], v19 offset:2048
s_add_u32 s53, s53, 32768
s_cmp_ge_u32 s53, 131072
s_cselect_b32 s53, 0, s53
s_waitcnt lgkmcnt(4)
v_mfma_f32_32x32x16_bf16 v[128:143], v[72:75], v[80:83], v[128:143]
v_add_u32 v16, s53, v24
v_xor_b32 v17, 32, v16
v_mfma_f32_32x32x16_bf16 v[144:159], v[72:75], v[84:87], v[144:159]
v_xor_b32 v18, 64, v16
v_xor_b32 v19, 96, v16
v_mfma_f32_32x32x16_bf16 v[160:175], v[76:79], v[80:83], v[160:175]
v_add_u32 v20, s53, v25
v_xor_b32 v21, 32, v20
v_mfma_f32_32x32x16_bf16 v[176:191], v[76:79], v[84:87], v[176:191]
v_xor_b32 v22, 64, v20
v_xor_b32 v23, 96, v20
s_waitcnt lgkmcnt(0)
s_barrier
v_mfma_f32_32x32x16_bf16 v[128:143], v[88:91], v[96:99], v[128:143]
ds_read_b128 v[40:43], v16 offset:0
ds_read_b128 v[48:51], v20 offset:0
v_mfma_f32_32x32x16_bf16 v[144:159], v[88:91], v[100:103], v[144:159]
ds_read_b128 v[52:55], v20 offset:4096
ds_read_b128 v[44:47], v16 offset:2048
v_mfma_f32_32x32x16_bf16 v[160:175], v[92:95], v[96:99], v[160:175]
ds_read_b128 v[56:59], v17 offset:0
ds_read_b128 v[64:67], v21 offset:0
v_mfma_f32_32x32x16_bf16 v[176:191], v[92:95], v[100:103], v[176:191]
ds_read_b128 v[68:71], v21 offset:4096
ds_read_b128 v[60:63], v17 offset:2048
s_waitcnt lgkmcnt(4)
v_mfma_f32_32x32x16_bf16 v[128:143], v[40:43], v[48:51], v[128:143]
ds_read_b128 v[72:75], v18 offset:0
v_mfma_f32_32x32x16_bf16 v[144:159], v[40:43], v[52:55], v[144:159]
ds_read_b128 v[80:83], v22 offset:0
v_mfma_f32_32x32x16_bf16 v[160:175], v[44:47], v[48:51], v[160:175]
ds_read_b128 v[84:87], v22 offset:4096
v_mfma_f32_32x32x16_bf16 v[176:191], v[44:47], v[52:55], v[176:191]
ds_read_b128 v[76:79], v18 offset:2048
s_waitcnt lgkmcnt(4)
v_mfma_f32_32x32x16_bf16 v[128:143], v[56:59], v[64:67], v[128:143]
ds_read_b128 v[88:91], v19 offset:0
v_mfma_f32_32x32x16_bf16 v[144:159], v[56:59], v[68:71], v[144:159]
ds_read_b128 v[96:99], v23 offset:0
v_mfma_f32_32x32x16_bf16 v[160:175], v[60:63], v[64:67], v[160:175]
ds_read_b128 v[100:103], v23 offset:4096
v_mfma_f32_32x32x16_bf16 v[176:191], v[60:63], v[68:71], v[176:191]
ds_read_b128 v[92:95], v19 offset:2048
s_add_u32 s53, s53, 32768
s_cmp_ge_u32 s53, 131072
s_cselect_b32 s53, 0, s53
s_waitcnt lgkmcnt(4)
v_mfma_f32_32x32x16_bf16 v[128:143], v[72:75], v[80:83], v[128:143]
v_add_u32 v16, s53, v24
v_xor_b32 v17, 32, v16
v_mfma_f32_32x32x16_bf16 v[144:159], v[72:75], v[84:87], v[144:159]
v_xor_b32 v18, 64, v16
v_xor_b32 v19, 96, v16
v_mfma_f32_32x32x16_bf16 v[160:175], v[76:79], v[80:83], v[160:175]
v_add_u32 v20, s53, v25
v_xor_b32 v21, 32, v20
v_mfma_f32_32x32x16_bf16 v[176:191], v[76:79], v[84:87], v[176:191]
v_xor_b32 v22, 64, v20
v_xor_b32 v23, 96, v20
s_waitcnt lgkmcnt(0)
s_barrier
v_mfma_f32_32x32x16_bf16 v[128:143], v[88:91], v[96:99], v[128:143]
ds_read_b128 v[40:43], v16 offset:0
ds_read_b128 v[48:51], v20 offset:0
ds_read_b128 v[8:11], v36
ds_read_b64 v[12:13], v36 offset:16
v_mfma_f32_32x32x16_bf16 v[144:159], v[88:91], v[100:103], v[144:159]
ds_read_b128 v[52:55], v20 offset:4096
ds_read_b128 v[44:47], v16 offset:2048
v_mfma_f32_32x32x16_bf16 v[160:175], v[92:95], v[96:99], v[160:175]
ds_read_b128 v[56:59], v17 offset:0
ds_read_b128 v[64:67], v21 offset:0
v_mfma_f32_32x32x16_bf16 v[176:191], v[92:95], v[100:103], v[176:191]
ds_read_b128 v[68:71], v21 offset:4096
ds_read_b128 v[60:63], v17 offset:2048
s_waitcnt lgkmcnt(4)
v_mfma_f32_32x32x16_bf16 v[128:143], v[40:43], v[48:51], v[128:143]
ds_read_b128 v[72:75], v18 offset:0
v_mfma_f32_32x32x16_bf16 v[144:159], v[40:43], v[52:55], v[144:159]
ds_read_b128 v[80:83], v22 offset:0
v_mfma_f32_32x32x16_bf16 v[160:175], v[44:47], v[48:51], v[160:175]
ds_read_b128 v[84:87], v22 offset:4096
v_mfma_f32_32x32x16_bf16 v[176:191], v[44:47], v[52:55], v[176:191]
ds_read_b128 v[76:79], v18 offset:2048
s_waitcnt lgkmcnt(4)
v_mfma_f32_32x32x16_bf16 v[128:143], v[56:59], v[64:67], v[128:143]
ds_read_b128 v[88:91], v19 offset:0
v_mfma_f32_32x32x16_bf16 v[144:159], v[56:59], v[68:71], v[144:159]
ds_read_b128 v[96:99], v23 offset:0
v_mfma_f32_32x32x16_bf16 v[160:175], v[60:63], v[64:67], v[160:175]
ds_read_b128 v[100:103], v23 offset:4096
v_mfma_f32_32x32x16_bf16 v[176:191], v[60:63], v[68:71], v[176:191]
ds_read_b128 v[92:95], v19 offset:2048
s_add_u32 s53, s53, 32768
s_cmp_ge_u32 s53, 131072
s_cselect_b32 s53, 0, s53
s_waitcnt lgkmcnt(4)
v_mfma_f32_32x32x16_bf16 v[128:143], v[72:75], v[80:83], v[128:143]
v_add_u32 v16, s53, v24
v_xor_b32 v17, 32, v16
v_mfma_f32_32x32x16_bf16 v[144:159], v[72:75], v[84:87], v[144:159]
v_xor_b32 v18, 64, v16
v_xor_b32 v19, 96, v16
v_mfma_f32_32x32x16_bf16 v[160:175], v[76:79], v[80:83], v[160:175]
v_add_u32 v20, s53, v25
v_xor_b32 v21, 32, v20
v_mfma_f32_32x32x16_bf16 v[176:191], v[76:79], v[84:87], v[176:191]
v_xor_b32 v22, 64, v20
v_xor_b32 v23, 96, v20
s_waitcnt lgkmcnt(0)
s_barrier
v_mfma_f32_32x32x16_bf16 v[128:143], v[88:91], v[96:99], v[128:143]
ds_read_b128 v[40:43], v16 offset:0
ds_read_b128 v[48:51], v20 offset:0
v_mfma_f32_32x32x16_bf16 v[144:159], v[88:91], v[100:103], v[144:159]
ds_read_b128 v[52:55], v20 offset:4096
ds_read_b128 v[44:47], v16 offset:2048
v_mfma_f32_32x32x16_bf16 v[160:175], v[92:95], v[96:99], v[160:175]
ds_read_b128 v[56:59], v17 offset:0
ds_read_b128 v[64:67], v21 offset:0
v_mfma_f32_32x32x16_bf16 v[176:191], v[92:95], v[100:103], v[176:191]
ds_read_b128 v[68:71], v21 offset:4096
ds_read_b128 v[60:63], v17 offset:2048
s_waitcnt lgkmcnt(4)
v_mfma_f32_32x32x16_bf16 v[128:143], v[40:43], v[48:51], v[128:143]
ds_read_b128 v[72:75], v18 offset:0
v_mfma_f32_32x32x16_bf16 v[144:159], v[40:43], v[52:55], v[144:159]
ds_read_b128 v[80:83], v22 offset:0
v_mfma_f32_32x32x16_bf16 v[160:175], v[44:47], v[48:51], v[160:175]
ds_read_b128 v[84:87], v22 offset:4096
v_mfma_f32_32x32x16_bf16 v[176:191], v[44:47], v[52:55], v[176:191]
ds_read_b128 v[76:79], v18 offset:2048
s_waitcnt lgkmcnt(4)
v_mfma_f32_32x32x16_bf16 v[128:143], v[56:59], v[64:67], v[128:143]
ds_read_b128 v[88:91], v19 offset:0
v_mfma_f32_32x32x16_bf16 v[144:159], v[56:59], v[68:71], v[144:159]
ds_read_b128 v[96:99], v23 offset:0
v_mfma_f32_32x32x16_bf16 v[160:175], v[60:63], v[64:67], v[160:175]
ds_read_b128 v[100:103], v23 offset:4096
v_mfma_f32_32x32x16_bf16 v[176:191], v[60:63], v[68:71], v[176:191]
ds_read_b128 v[92:95], v19 offset:2048
s_add_u32 s53, s53, 32768
s_cmp_ge_u32 s53, 131072
s_cselect_b32 s53, 0, s53
s_waitcnt lgkmcnt(4)
v_mfma_f32_32x32x16_bf16 v[128:143], v[72:75], v[80:83], v[128:143]
v_add_u32 v16, s53, v24
v_xor_b32 v17, 32, v16
v_mfma_f32_32x32x16_bf16 v[144:159], v[72:75], v[84:87], v[144:159]
v_xor_b32 v18, 64, v16
v_xor_b32 v19, 96, v16
v_mfma_f32_32x32x16_bf16 v[160:175], v[76:79], v[80:83], v[160:175]
v_add_u32 v20, s53, v25
v_xor_b32 v21, 32, v20
v_mfma_f32_32x32x16_bf16 v[176:191], v[76:79], v[84:87], v[176:191]
v_xor_b32 v22, 64, v20
v_xor_b32 v23, 96, v20
s_waitcnt vmcnt(0)
s_waitcnt lgkmcnt(0)
s_barrier
v_mfma_f32_32x32x16_bf16 v[128:143], v[88:91], v[96:99], v[128:143]
ds_read_b128 v[40:43], v16 offset:0
ds_read_b128 v[48:51], v20 offset:0
v_mfma_f32_32x32x16_bf16 v[144:159], v[88:91], v[100:103], v[144:159]
ds_read_b128 v[52:55], v20 offset:4096
ds_read_b128 v[44:47], v16 offset:2048
v_mfma_f32_32x32x16_bf16 v[160:175], v[92:95], v[96:99], v[160:175]
ds_read_b128 v[56:59], v17 offset:0
ds_read_b128 v[64:67], v21 offset:0
v_mfma_f32_32x32x16_bf16 v[176:191], v[92:95], v[100:103], v[176:191]
ds_read_b128 v[68:71], v21 offset:4096
ds_read_b128 v[60:63], v17 offset:2048
s_waitcnt lgkmcnt(4)
v_mfma_f32_32x32x16_bf16 v[128:143], v[40:43], v[48:51], v[128:143]
ds_read_b128 v[72:75], v18 offset:0
v_mfma_f32_32x32x16_bf16 v[144:159], v[40:43], v[52:55], v[144:159]
ds_read_b128 v[80:83], v22 offset:0
v_mfma_f32_32x32x16_bf16 v[160:175], v[44:47], v[48:51], v[160:175]
ds_read_b128 v[84:87], v22 offset:4096
v_mfma_f32_32x32x16_bf16 v[176:191], v[44:47], v[52:55], v[176:191]
ds_read_b128 v[76:79], v18 offset:2048
s_waitcnt lgkmcnt(4)
v_mfma_f32_32x32x16_bf16 v[128:143], v[56:59], v[64:67], v[128:143]
ds_read_b128 v[88:91], v19 offset:0
v_mfma_f32_32x32x16_bf16 v[144:159], v[56:59], v[68:71], v[144:159]
ds_read_b128 v[96:99], v23 offset:0
v_mfma_f32_32x32x16_bf16 v[160:175], v[60:63], v[64:67], v[160:175]
ds_read_b128 v[100:103], v23 offset:4096
v_mfma_f32_32x32x16_bf16 v[176:191], v[60:63], v[68:71], v[176:191]
ds_read_b128 v[92:95], v19 offset:2048
s_add_u32 s53, s53, 32768
s_cmp_ge_u32 s53, 131072
s_cselect_b32 s53, 0, s53
s_waitcnt lgkmcnt(4)
v_mfma_f32_32x32x16_bf16 v[128:143], v[72:75], v[80:83], v[128:143]
v_add_u32 v16, s53, v24
v_xor_b32 v17, 32, v16
v_mfma_f32_32x32x16_bf16 v[144:159], v[72:75], v[84:87], v[144:159]
v_xor_b32 v18, 64, v16
v_xor_b32 v19, 96, v16
v_mfma_f32_32x32x16_bf16 v[160:175], v[76:79], v[80:83], v[160:175]
v_add_u32 v20, s53, v25
v_xor_b32 v21, 32, v20
v_mfma_f32_32x32x16_bf16 v[176:191], v[76:79], v[84:87], v[176:191]
v_xor_b32 v22, 64, v20
v_xor_b32 v23, 96, v20
s_waitcnt lgkmcnt(0)
s_barrier
v_mfma_f32_32x32x16_bf16 v[128:143], v[88:91], v[96:99], v[128:143]
ds_read_b128 v[40:43], v16 offset:0
ds_read_b128 v[48:51], v20 offset:0
v_mfma_f32_32x32x16_bf16 v[144:159], v[88:91], v[100:103], v[144:159]
ds_read_b128 v[52:55], v20 offset:4096
ds_read_b128 v[44:47], v16 offset:2048
v_mfma_f32_32x32x16_bf16 v[160:175], v[92:95], v[96:99], v[160:175]
ds_read_b128 v[56:59], v17 offset:0
ds_read_b128 v[64:67], v21 offset:0
v_mfma_f32_32x32x16_bf16 v[176:191], v[92:95], v[100:103], v[176:191]
ds_read_b128 v[68:71], v21 offset:4096
ds_read_b128 v[60:63], v17 offset:2048
s_waitcnt lgkmcnt(4)
v_mfma_f32_32x32x16_bf16 v[128:143], v[40:43], v[48:51], v[128:143]
ds_read_b128 v[72:75], v18 offset:0
v_mfma_f32_32x32x16_bf16 v[144:159], v[40:43], v[52:55], v[144:159]
ds_read_b128 v[80:83], v22 offset:0
v_mfma_f32_32x32x16_bf16 v[160:175], v[44:47], v[48:51], v[160:175]
ds_read_b128 v[84:87], v22 offset:4096
v_mfma_f32_32x32x16_bf16 v[176:191], v[44:47], v[52:55], v[176:191]
ds_read_b128 v[76:79], v18 offset:2048
s_waitcnt lgkmcnt(4)
v_mfma_f32_32x32x16_bf16 v[128:143], v[56:59], v[64:67], v[128:143]
ds_read_b128 v[88:91], v19 offset:0
v_mfma_f32_32x32x16_bf16 v[144:159], v[56:59], v[68:71], v[144:159]
ds_read_b128 v[96:99], v23 offset:0
v_mfma_f32_32x32x16_bf16 v[160:175], v[60:63], v[64:67], v[160:175]
ds_read_b128 v[100:103], v23 offset:4096
v_mfma_f32_32x32x16_bf16 v[176:191], v[60:63], v[68:71], v[176:191]
ds_read_b128 v[92:95], v19 offset:2048
s_add_u32 s53, s53, 32768
s_cmp_ge_u32 s53, 131072
s_cselect_b32 s53, 0, s53
s_waitcnt lgkmcnt(4)
v_mfma_f32_32x32x16_bf16 v[128:143], v[72:75], v[80:83], v[128:143]
v_add_u32 v16, s53, v24
v_xor_b32 v17, 32, v16
v_mfma_f32_32x32x16_bf16 v[144:159], v[72:75], v[84:87], v[144:159]
v_xor_b32 v18, 64, v16
v_xor_b32 v19, 96, v16
v_mfma_f32_32x32x16_bf16 v[160:175], v[76:79], v[80:83], v[160:175]
v_add_u32 v20, s53, v25
v_xor_b32 v21, 32, v20
v_mfma_f32_32x32x16_bf16 v[176:191], v[76:79], v[84:87], v[176:191]
v_xor_b32 v22, 64, v20
v_xor_b32 v23, 96, v20
s_waitcnt lgkmcnt(0)
s_barrier
v_mfma_f32_32x32x16_bf16 v[128:143], v[88:91], v[96:99], v[128:143]
ds_read_b128 v[40:43], v16 offset:0
ds_read_b128 v[48:51], v20 offset:0
v_mfma_f32_32x32x16_bf16 v[144:159], v[88:91], v[100:103], v[144:159]
ds_read_b128 v[52:55], v20 offset:4096
ds_read_b128 v[44:47], v16 offset:2048
v_mfma_f32_32x32x16_bf16 v[160:175], v[92:95], v[96:99], v[160:175]
ds_read_b128 v[56:59], v17 offset:0
ds_read_b128 v[64:67], v21 offset:0
v_mfma_f32_32x32x16_bf16 v[176:191], v[92:95], v[100:103], v[176:191]
ds_read_b128 v[68:71], v21 offset:4096
ds_read_b128 v[60:63], v17 offset:2048
s_waitcnt lgkmcnt(4)
v_mfma_f32_32x32x16_bf16 v[128:143], v[40:43], v[48:51], v[128:143]
ds_read_b128 v[72:75], v18 offset:0
v_mfma_f32_32x32x16_bf16 v[144:159], v[40:43], v[52:55], v[144:159]
ds_read_b128 v[80:83], v22 offset:0
v_mfma_f32_32x32x16_bf16 v[160:175], v[44:47], v[48:51], v[160:175]
ds_read_b128 v[84:87], v22 offset:4096
v_mfma_f32_32x32x16_bf16 v[176:191], v[44:47], v[52:55], v[176:191]
ds_read_b128 v[76:79], v18 offset:2048
s_waitcnt lgkmcnt(4)
v_mfma_f32_32x32x16_bf16 v[128:143], v[56:59], v[64:67], v[128:143]
ds_read_b128 v[88:91], v19 offset:0
v_mfma_f32_32x32x16_bf16 v[144:159], v[56:59], v[68:71], v[144:159]
ds_read_b128 v[96:99], v23 offset:0
v_mfma_f32_32x32x16_bf16 v[160:175], v[60:63], v[64:67], v[160:175]
ds_read_b128 v[100:103], v23 offset:4096
v_mfma_f32_32x32x16_bf16 v[176:191], v[60:63], v[68:71], v[176:191]
ds_read_b128 v[92:95], v19 offset:2048
s_add_u32 s53, s53, 32768
s_cmp_ge_u32 s53, 131072
s_cselect_b32 s53, 0, s53
s_waitcnt lgkmcnt(4)
v_mfma_f32_32x32x16_bf16 v[128:143], v[72:75], v[80:83], v[128:143]
v_add_u32 v16, s53, v24
v_xor_b32 v17, 32, v16
v_mfma_f32_32x32x16_bf16 v[144:159], v[72:75], v[84:87], v[144:159]
v_xor_b32 v18, 64, v16
v_xor_b32 v19, 96, v16
v_mfma_f32_32x32x16_bf16 v[160:175], v[76:79], v[80:83], v[160:175]
v_add_u32 v20, s53, v25
v_xor_b32 v21, 32, v20
v_mfma_f32_32x32x16_bf16 v[176:191], v[76:79], v[84:87], v[176:191]
v_xor_b32 v22, 64, v20
v_xor_b32 v23, 96, v20
s_waitcnt lgkmcnt(0)
s_barrier
v_mfma_f32_32x32x16_bf16 v[128:143], v[88:91], v[96:99], v[128:143]
ds_read_b128 v[40:43], v16 offset:0
ds_read_b128 v[48:51], v20 offset:0
v_mfma_f32_32x32x16_bf16 v[144:159], v[88:91], v[100:103], v[144:159]
ds_read_b128 v[52:55], v20 offset:4096
ds_read_b128 v[44:47], v16 offset:2048
v_mfma_f32_32x32x16_bf16 v[160:175], v[92:95], v[96:99], v[160:175]
ds_read_b128 v[56:59], v17 offset:0
ds_read_b128 v[64:67], v21 offset:0
v_mfma_f32_32x32x16_bf16 v[176:191], v[92:95], v[100:103], v[176:191]
ds_read_b128 v[68:71], v21 offset:4096
ds_read_b128 v[60:63], v17 offset:2048
s_waitcnt lgkmcnt(4)
v_mfma_f32_32x32x16_bf16 v[128:143], v[40:43], v[48:51], v[128:143]
ds_read_b128 v[72:75], v18 offset:0
v_mfma_f32_32x32x16_bf16 v[144:159], v[40:43], v[52:55], v[144:159]
ds_read_b128 v[80:83], v22 offset:0
v_mfma_f32_32x32x16_bf16 v[160:175], v[44:47], v[48:51], v[160:175]
ds_read_b128 v[84:87], v22 offset:4096
v_mfma_f32_32x32x16_bf16 v[176:191], v[44:47], v[52:55], v[176:191]
ds_read_b128 v[76:79], v18 offset:2048
s_waitcnt lgkmcnt(4)
v_mfma_f32_32x32x16_bf16 v[128:143], v[56:59], v[64:67], v[128:143]
ds_read_b128 v[88:91], v19 offset:0
v_mfma_f32_32x32x16_bf16 v[144:159], v[56:59], v[68:71], v[144:159]
ds_read_b128 v[96:99], v23 offset:0
v_mfma_f32_32x32x16_bf16 v[160:175], v[60:63], v[64:67], v[160:175]
ds_read_b128 v[100:103], v23 offset:4096
v_mfma_f32_32x32x16_bf16 v[176:191], v[60:63], v[68:71], v[176:191]
ds_read_b128 v[92:95], v19 offset:2048
s_add_u32 s53, s53, 32768
s_cmp_ge_u32 s53, 131072
s_cselect_b32 s53, 0, s53
s_waitcnt lgkmcnt(4)
v_mfma_f32_32x32x16_bf16 v[128:143], v[72:75], v[80:83], v[128:143]
v_add_u32 v16, s53, v24
v_xor_b32 v17, 32, v16
v_mfma_f32_32x32x16_bf16 v[144:159], v[72:75], v[84:87], v[144:159]
v_xor_b32 v18, 64, v16
v_xor_b32 v19, 96, v16
v_mfma_f32_32x32x16_bf16 v[160:175], v[76:79], v[80:83], v[160:175]
v_add_u32 v20, s53, v25
v_xor_b32 v21, 32, v20
v_mfma_f32_32x32x16_bf16 v[176:191], v[76:79], v[84:87], v[176:191]
v_xor_b32 v22, 64, v20
v_xor_b32 v23, 96, v20
s_waitcnt lgkmcnt(0)
s_barrier
v_mfma_f32_32x32x16_bf16 v[128:143], v[88:91], v[96:99], v[128:143]
ds_read_b128 v[40:43], v16 offset:0
ds_read_b128 v[48:51], v20 offset:0
v_mfma_f32_32x32x16_bf16 v[144:159], v[88:91], v[100:103], v[144:159]
ds_read_b128 v[52:55], v20 offset:4096
ds_read_b128 v[44:47], v16 offset:2048
v_mfma_f32_32x32x16_bf16 v[160:175], v[92:95], v[96:99], v[160:175]
ds_read_b128 v[56:59], v17 offset:0
ds_read_b128 v[64:67], v21 offset:0
v_mfma_f32_32x32x16_bf16 v[176:191], v[92:95], v[100:103], v[176:191]
ds_read_b128 v[68:71], v21 offset:4096
ds_read_b128 v[60:63], v17 offset:2048
s_waitcnt lgkmcnt(4)
v_mfma_f32_32x32x16_bf16 v[128:143], v[40:43], v[48:51], v[128:143]
ds_read_b128 v[72:75], v18 offset:0
v_mfma_f32_32x32x16_bf16 v[144:159], v[40:43], v[52:55], v[144:159]
ds_read_b128 v[80:83], v22 offset:0
v_mfma_f32_32x32x16_bf16 v[160:175], v[44:47], v[48:51], v[160:175]
ds_read_b128 v[84:87], v22 offset:4096
v_mfma_f32_32x32x16_bf16 v[176:191], v[44:47], v[52:55], v[176:191]
ds_read_b128 v[76:79], v18 offset:2048
s_waitcnt lgkmcnt(4)
v_mfma_f32_32x32x16_bf16 v[128:143], v[56:59], v[64:67], v[128:143]
ds_read_b128 v[88:91], v19 offset:0
v_mfma_f32_32x32x16_bf16 v[144:159], v[56:59], v[68:71], v[144:159]
ds_read_b128 v[96:99], v23 offset:0
v_mfma_f32_32x32x16_bf16 v[160:175], v[60:63], v[64:67], v[160:175]
ds_read_b128 v[100:103], v23 offset:4096
v_mfma_f32_32x32x16_bf16 v[176:191], v[60:63], v[68:71], v[176:191]
ds_read_b128 v[92:95], v19 offset:2048
s_add_u32 s53, s53, 32768
s_cmp_ge_u32 s53, 131072
s_cselect_b32 s53, 0, s53
s_waitcnt lgkmcnt(4)
v_mfma_f32_32x32x16_bf16 v[128:143], v[72:75], v[80:83], v[128:143]
v_add_u32 v16, s53, v24
v_xor_b32 v17, 32, v16
v_mfma_f32_32x32x16_bf16 v[144:159], v[72:75], v[84:87], v[144:159]
v_xor_b32 v18, 64, v16
v_xor_b32 v19, 96, v16
v_mfma_f32_32x32x16_bf16 v[160:175], v[76:79], v[80:83], v[160:175]
v_add_u32 v20, s53, v25
v_xor_b32 v21, 32, v20
v_mfma_f32_32x32x16_bf16 v[176:191], v[76:79], v[84:87], v[176:191]
v_xor_b32 v22, 64, v20
v_xor_b32 v23, 96, v20
s_waitcnt lgkmcnt(0)
s_barrier
v_mfma_f32_32x32x16_bf16 v[128:143], v[88:91], v[96:99], v[128:143]
ds_read_b128 v[40:43], v16 offset:0
ds_read_b128 v[48:51], v20 offset:0
v_mfma_f32_32x32x16_bf16 v[144:159], v[88:91], v[100:103], v[144:159]
ds_read_b128 v[52:55], v20 offset:4096
ds_read_b128 v[44:47], v16 offset:2048
v_mfma_f32_32x32x16_bf16 v[160:175], v[92:95], v[96:99], v[160:175]
ds_read_b128 v[56:59], v17 offset:0
ds_read_b128 v[64:67], v21 offset:0
v_mfma_f32_32x32x16_bf16 v[176:191], v[92:95], v[100:103], v[176:191]
ds_read_b128 v[68:71], v21 offset:4096
ds_read_b128 v[60:63], v17 offset:2048
s_waitcnt lgkmcnt(4)
v_mfma_f32_32x32x16_bf16 v[128:143], v[40:43], v[48:51], v[128:143]
ds_read_b128 v[72:75], v18 offset:0
v_mfma_f32_32x32x16_bf16 v[144:159], v[40:43], v[52:55], v[144:159]
ds_read_b128 v[80:83], v22 offset:0
v_mfma_f32_32x32x16_bf16 v[160:175], v[44:47], v[48:51], v[160:175]
ds_read_b128 v[84:87], v22 offset:4096
v_mfma_f32_32x32x16_bf16 v[176:191], v[44:47], v[52:55], v[176:191]
ds_read_b128 v[76:79], v18 offset:2048
s_waitcnt lgkmcnt(4)
v_mfma_f32_32x32x16_bf16 v[128:143], v[56:59], v[64:67], v[128:143]
ds_read_b128 v[88:91], v19 offset:0
v_mfma_f32_32x32x16_bf16 v[144:159], v[56:59], v[68:71], v[144:159]
ds_read_b128 v[96:99], v23 offset:0
v_mfma_f32_32x32x16_bf16 v[160:175], v[60:63], v[64:67], v[160:175]
ds_read_b128 v[100:103], v23 offset:4096
v_mfma_f32_32x32x16_bf16 v[176:191], v[60:63], v[68:71], v[176:191]
ds_read_b128 v[92:95], v19 offset:2048
s_add_u32 s53, s53, 32768
s_cmp_ge_u32 s53, 131072
s_cselect_b32 s53, 0, s53
s_waitcnt lgkmcnt(4)
v_mfma_f32_32x32x16_bf16 v[128:143], v[72:75], v[80:83], v[128:143]
v_add_u32 v16, s53, v24
v_xor_b32 v17, 32, v16
v_mfma_f32_32x32x16_bf16 v[144:159], v[72:75], v[84:87], v[144:159]
v_xor_b32 v18, 64, v16
v_xor_b32 v19, 96, v16
v_mfma_f32_32x32x16_bf16 v[160:175], v[76:79], v[80:83], v[160:175]
v_add_u32 v20, s53, v25
v_xor_b32 v21, 32, v20
v_mfma_f32_32x32x16_bf16 v[176:191], v[76:79], v[84:87], v[176:191]
v_xor_b32 v22, 64, v20
v_xor_b32 v23, 96, v20
s_waitcnt lgkmcnt(0)
s_barrier
v_mfma_f32_32x32x16_bf16 v[128:143], v[88:91], v[96:99], v[128:143]
ds_read_b128 v[40:43], v16 offset:0
ds_read_b128 v[48:51], v20 offset:0
v_mfma_f32_32x32x16_bf16 v[144:159], v[88:91], v[100:103], v[144:159]
ds_read_b128 v[52:55], v20 offset:4096
ds_read_b128 v[44:47], v16 offset:2048
v_mfma_f32_32x32x16_bf16 v[160:175], v[92:95], v[96:99], v[160:175]
ds_read_b128 v[56:59], v17 offset:0
ds_read_b128 v[64:67], v21 offset:0
v_mfma_f32_32x32x16_bf16 v[176:191], v[92:95], v[100:103], v[176:191]
ds_read_b128 v[68:71], v21 offset:4096
ds_read_b128 v[60:63], v17 offset:2048
buffer_load_dword v14, v34, s[88:91], s81 offen offset:0
buffer_load_dword v15, v34, s[88:91], s81 offen offset:512
buffer_load_dword v30, v34, s[88:91], s81 offen offset:32
buffer_load_dword v31, v34, s[88:91], s81 offen offset:544
buffer_load_dword v32, v35, s[88:91], 0 offen offset:64
buffer_load_dword v33, v35, s[88:91], s82 offen offset:64
s_waitcnt lgkmcnt(4)
v_mfma_f32_32x32x16_bf16 v[128:143], v[40:43], v[48:51], v[128:143]
ds_read_b128 v[72:75], v18 offset:0
v_mfma_f32_32x32x16_bf16 v[144:159], v[40:43], v[52:55], v[144:159]
ds_read_b128 v[80:83], v22 offset:0
v_mfma_f32_32x32x16_bf16 v[160:175], v[44:47], v[48:51], v[160:175]
ds_read_b128 v[84:87], v22 offset:4096
v_mfma_f32_32x32x16_bf16 v[176:191], v[44:47], v[52:55], v[176:191]
ds_read_b128 v[76:79], v18 offset:2048
s_waitcnt lgkmcnt(4)
v_mfma_f32_32x32x16_bf16 v[128:143], v[56:59], v[64:67], v[128:143]
ds_read_b128 v[88:91], v19 offset:0
v_mfma_f32_32x32x16_bf16 v[144:159], v[56:59], v[68:71], v[144:159]
ds_read_b128 v[96:99], v23 offset:0
v_mfma_f32_32x32x16_bf16 v[160:175], v[60:63], v[64:67], v[160:175]
ds_read_b128 v[100:103], v23 offset:4096
v_mfma_f32_32x32x16_bf16 v[176:191], v[60:63], v[68:71], v[176:191]
ds_read_b128 v[92:95], v19 offset:2048
s_add_u32 s53, s53, 32768
s_cmp_ge_u32 s53, 131072
s_cselect_b32 s53, 0, s53
s_waitcnt lgkmcnt(4)
v_mfma_f32_32x32x16_bf16 v[128:143], v[72:75], v[80:83], v[128:143]
v_add_u32 v16, s53, v24
v_xor_b32 v17, 32, v16
v_mfma_f32_32x32x16_bf16 v[144:159], v[72:75], v[84:87], v[144:159]
v_xor_b32 v18, 64, v16
v_xor_b32 v19, 96, v16
v_mfma_f32_32x32x16_bf16 v[160:175], v[76:79], v[80:83], v[160:175]
v_add_u32 v20, s53, v25
v_xor_b32 v21, 32, v20
v_mfma_f32_32x32x16_bf16 v[176:191], v[76:79], v[84:87], v[176:191]
v_xor_b32 v22, 64, v20
v_xor_b32 v23, 96, v20
s_waitcnt lgkmcnt(0)
s_barrier
v_mfma_f32_32x32x16_bf16 v[128:143], v[88:91], v[96:99], v[128:143]
ds_read_b128 v[40:43], v16 offset:0
ds_read_b128 v[48:51], v20 offset:0
v_mfma_f32_32x32x16_bf16 v[144:159], v[88:91], v[100:103], v[144:159]
ds_read_b128 v[52:55], v20 offset:4096
ds_read_b128 v[44:47], v16 offset:2048
v_mfma_f32_32x32x16_bf16 v[160:175], v[92:95], v[96:99], v[160:175]
ds_read_b128 v[56:59], v17 offset:0
ds_read_b128 v[64:67], v21 offset:0
v_mfma_f32_32x32x16_bf16 v[176:191], v[92:95], v[100:103], v[176:191]
ds_read_b128 v[68:71], v21 offset:4096
ds_read_b128 v[60:63], v17 offset:2048
s_waitcnt lgkmcnt(4)
v_mfma_f32_32x32x16_bf16 v[128:143], v[40:43], v[48:51], v[128:143]
ds_read_b128 v[72:75], v18 offset:0
v_mfma_f32_32x32x16_bf16 v[144:159], v[40:43], v[52:55], v[144:159]
ds_read_b128 v[80:83], v22 offset:0
v_mfma_f32_32x32x16_bf16 v[160:175], v[44:47], v[48:51], v[160:175]
ds_read_b128 v[84:87], v22 offset:4096
v_mfma_f32_32x32x16_bf16 v[176:191], v[44:47], v[52:55], v[176:191]
ds_read_b128 v[76:79], v18 offset:2048
s_waitcnt lgkmcnt(4)
v_mfma_f32_32x32x16_bf16 v[128:143], v[56:59], v[64:67], v[128:143]
ds_read_b128 v[88:91], v19 offset:0
v_mfma_f32_32x32x16_bf16 v[144:159], v[56:59], v[68:71], v[144:159]
ds_read_b128 v[96:99], v23 offset:0
v_mfma_f32_32x32x16_bf16 v[160:175], v[60:63], v[64:67], v[160:175]
ds_read_b128 v[100:103], v23 offset:4096
v_mfma_f32_32x32x16_bf16 v[176:191], v[60:63], v[68:71], v[176:191]
ds_read_b128 v[92:95], v19 offset:2048
s_add_u32 s53, s53, 32768
s_cmp_ge_u32 s53, 131072
s_cselect_b32 s53, 0, s53
s_waitcnt lgkmcnt(4)
v_mfma_f32_32x32x16_bf16 v[128:143], v[72:75], v[80:83], v[128:143]
v_add_u32 v16, s53, v24
v_xor_b32 v17, 32, v16
v_mfma_f32_32x32x16_bf16 v[144:159], v[72:75], v[84:87], v[144:159]
v_xor_b32 v18, 64, v16
v_xor_b32 v19, 96, v16
v_mfma_f32_32x32x16_bf16 v[160:175], v[76:79], v[80:83], v[160:175]
v_add_u32 v20, s53, v25
v_xor_b32 v21, 32, v20
v_mfma_f32_32x32x16_bf16 v[176:191], v[76:79], v[84:87], v[176:191]
v_xor_b32 v22, 64, v20
v_xor_b32 v23, 96, v20
s_waitcnt lgkmcnt(0)
s_barrier
v_mfma_f32_32x32x16_bf16 v[128:143], v[88:91], v[96:99], v[128:143]
ds_read_b128 v[40:43], v16 offset:0
ds_read_b128 v[48:51], v20 offset:0
v_mfma_f32_32x32x16_bf16 v[144:159], v[88:91], v[100:103], v[144:159]
ds_read_b128 v[52:55], v20 offset:4096
ds_read_b128 v[44:47], v16 offset:2048
v_mfma_f32_32x32x16_bf16 v[160:175], v[92:95], v[96:99], v[160:175]
ds_read_b128 v[56:59], v17 offset:0
ds_read_b128 v[64:67], v21 offset:0
v_mfma_f32_32x32x16_bf16 v[176:191], v[92:95], v[100:103], v[176:191]
ds_read_b128 v[68:71], v21 offset:4096
ds_read_b128 v[60:63], v17 offset:2048
s_cmp_ge_u32 s40, 28
s_cbranch_scc1 Lcs_6
s_waitcnt lgkmcnt(4)
v_mfma_f32_32x32x16_bf16 v[128:143], v[40:43], v[48:51], v[128:143]
ds_read_b128 v[72:75], v18 offset:0
v_mfma_f32_32x32x16_bf16 v[144:159], v[40:43], v[52:55], v[144:159]
ds_read_b128 v[80:83], v22 offset:0
v_mfma_f32_32x32x16_bf16 v[160:175], v[44:47], v[48:51], v[160:175]
ds_read_b128 v[84:87], v22 offset:4096
v_mfma_f32_32x32x16_bf16 v[176:191], v[44:47], v[52:55], v[176:191]
ds_read_b128 v[76:79], v18 offset:2048
s_waitcnt lgkmcnt(4)
v_mfma_f32_32x32x16_bf16 v[128:143], v[56:59], v[64:67], v[128:143]
ds_read_b128 v[88:91], v19 offset:0
v_mfma_f32_32x32x16_bf16 v[144:159], v[56:59], v[68:71], v[144:159]
ds_read_b128 v[96:99], v23 offset:0
v_mfma_f32_32x32x16_bf16 v[160:175], v[60:63], v[64:67], v[160:175]
ds_read_b128 v[100:103], v23 offset:4096
v_mfma_f32_32x32x16_bf16 v[176:191], v[60:63], v[68:71], v[176:191]
ds_read_b128 v[92:95], v19 offset:2048
s_add_u32 s53, s53, 32768
s_cmp_ge_u32 s53, 131072
s_cselect_b32 s53, 0, s53
s_waitcnt lgkmcnt(4)
v_mfma_f32_32x32x16_bf16 v[128:143], v[72:75], v[80:83], v[128:143]
v_add_u32 v16, s53, v26
v_mfma_f32_32x32x16_bf16 v[144:159], v[72:75], v[84:87], v[144:159]
v_xor_b32 v17, 64, v16
v_mfma_f32_32x32x16_bf16 v[160:175], v[76:79], v[80:83], v[160:175]
v_add_u32 v20, s53, v27
v_mfma_f32_32x32x16_bf16 v[176:191], v[76:79], v[84:87], v[176:191]
s_waitcnt lgkmcnt(0)
s_barrier
v_mfma_f32_32x32x16_bf16 v[128:143], v[88:91], v[96:99], v[128:143]
ds_read_b64_tr_b16 v[40:41], v16 offset:0
ds_read_b64_tr_b16 v[42:43], v16 offset:1024
ds_read_b128 v[48:51], v20 offset:0
v_mfma_f32_32x32x16_bf16 v[144:159], v[88:91], v[100:103], v[144:159]
ds_read_b128 v[52:55], v20 offset:512
ds_read_b64_tr_b16 v[44:45], v17 offset:0
ds_read_b64_tr_b16 v[46:47], v17 offset:1024
v_mfma_f32_32x32x16_bf16 v[160:175], v[92:95], v[96:99], v[160:175]
ds_read_b64_tr_b16 v[56:57], v16 offset:4096
ds_read_b64_tr_b16 v[58:59], v16 offset:5120
ds_read_b128 v[64:67], v20 offset:4096
v_mfma_f32_32x32x16_bf16 v[176:191], v[92:95], v[100:103], v[176:191]
ds_read_b128 v[68:71], v20 offset:4608
ds_read_b64_tr_b16 v[60:61], v17 offset:4096
ds_read_b64_tr_b16 v[62:63], v17 offset:5120
s_waitcnt lgkmcnt(6)
v_mfma_f32_32x32x16_bf16 v[192:207], v[40:43], v[48:51], 0
ds_read_b64_tr_b16 v[72:73], v16 offset:8192
ds_read_b64_tr_b16 v[74:75], v16 offset:9216
s_waitcnt vmcnt(0)
v_xor_b32 v32, 0x80000000, v32
v_xor_b32 v33, 0x80000000, v33
s_nop 7
s_nop 7
v_mfma_f32_32x32x16_bf16 v[208:223], v[40:43], v[52:55], 0
ds_read_b128 v[80:83], v20 offset:8192
ds_read_b128 v[84:87], v20 offset:8704
v_fmac_f32_dpp v128, v14, v32 row_newbcast:0 row_mask:0xf bank_mask:0xf
v_fmac_f32_dpp v144, v14, v33 row_newbcast:0 row_mask:0xf bank_mask:0xf
v_mul_f32_dpp v128, v30, v128 row_newbcast:0 row_mask:0xf bank_mask:0xf
v_mul_f32_dpp v144, v30, v144 row_newbcast:0 row_mask:0xf bank_mask:0xf
v_mfma_f32_32x32x16_bf16 v[224:239], v[44:47], v[48:51], 0
ds_read_b64_tr_b16 v[76:77], v17 offset:8192
ds_read_b64_tr_b16 v[78:79], v17 offset:9216
v_mov_b32 v104, v128
v_mov_b32 v105, v144
v_fmac_f32_dpp v129, v14, v32 row_newbcast:1 row_mask:0xf bank_mask:0xf
v_fmac_f32_dpp v145, v14, v33 row_newbcast:1 row_mask:0xf bank_mask:0xf
v_mfma_f32_32x32x16_bf16 v[240:255], v[44:47], v[52:55], 0
v_mul_f32_dpp v129, v30, v129 row_newbcast:1 row_mask:0xf bank_mask:0xf
v_mul_f32_dpp v145, v30, v145 row_newbcast:1 row_mask:0xf bank_mask:0xf
v_fma_f32 v106, v8, v104, v129
v_fma_f32 v107, v8, v105, v145
v_fma_f32 v106, -v9, v105, v106
v_fma_f32 v107, v9, v104, v107
v_fmac_f32_dpp v130, v14, v32 row_newbcast:2 row_mask:0xf bank_mask:0xf
v_fmac_f32_dpp v146, v14, v33 row_newbcast:2 row_mask:0xf bank_mask:0xf
s_waitcnt lgkmcnt(6)
v_mfma_f32_32x32x16_bf16 v[192:207], v[56:59], v[64:67], v[192:207]
ds_read_b64_tr_b16 v[88:89], v16 offset:12288
ds_read_b64_tr_b16 v[90:91], v16 offset:13312
v_mul_f32_dpp v130, v30, v130 row_newbcast:2 row_mask:0xf bank_mask:0xf
v_mul_f32_dpp v146, v30, v146 row_newbcast:2 row_mask:0xf bank_mask:0xf
v_fma_f32 v104, v8, v106, v130
v_fma_f32 v105, v8, v107, v146
v_fma_f32 v104, -v9, v107, v104
v_fma_f32 v105, v9, v106, v105
v_mfma_f32_32x32x16_bf16 v[208:223], v[56:59], v[68:71], v[208:223]
ds_read_b128 v[96:99], v20 offset:12288
ds_read_b128 v[100:103], v20 offset:12800
v_fmac_f32_dpp v131, v14, v32 row_newbcast:3 row_mask:0xf bank_mask:0xf
v_fmac_f32_dpp v147, v14, v33 row_newbcast:3 row_mask:0xf bank_mask:0xf
v_mul_f32_dpp v131, v30, v131 row_newbcast:3 row_mask:0xf bank_mask:0xf
v_mul_f32_dpp v147, v30, v147 row_newbcast:3 row_mask:0xf bank_mask:0xf
v_mfma_f32_32x32x16_bf16 v[224:239], v[60:63], v[64:67], v[224:239]
ds_read_b64_tr_b16 v[92:93], v17 offset:12288
ds_read_b64_tr_b16 v[94:95], v17 offset:13312
v_fma_f32 v106, v8, v104, v131
v_fma_f32 v107, v8, v105, v147
v_fma_f32 v106, -v9, v105, v106
v_fma_f32 v107, v9, v104, v107
v_mfma_f32_32x32x16_bf16 v[240:255], v[60:63], v[68:71], v[240:255]
v_fmac_f32_dpp v132, v14, v32 row_newbcast:4 row_mask:0xf bank_mask:0xf
v_fmac_f32_dpp v148, v14, v33 row_newbcast:4 row_mask:0xf bank_mask:0xf
v_mul_f32_dpp v132, v30, v132 row_newbcast:4 row_mask:0xf bank_mask:0xf
v_mul_f32_dpp v148, v30, v148 row_newbcast:4 row_mask:0xf bank_mask:0xf
v_fma_f32 v104, v8, v106, v132
v_fma_f32 v105, v8, v107, v148
v_fma_f32 v104, -v9, v107, v104
v_fma_f32 v105, v9, v106, v105
s_add_u32 s53, s53, 32768
s_cmp_ge_u32 s53, 131072
s_cselect_b32 s53, 0, s53
s_waitcnt lgkmcnt(6)
v_mfma_f32_32x32x16_bf16 v[192:207], v[72:75], v[80:83], v[192:207]
v_add_u32 v16, s53, v26
v_fmac_f32_dpp v133, v14, v32 row_newbcast:5 row_mask:0xf bank_mask:0xf
v_fmac_f32_dpp v149, v14, v33 row_newbcast:5 row_mask:0xf bank_mask:0xf
v_mul_f32_dpp v133, v30, v133 row_newbcast:5 row_mask:0xf bank_mask:0xf
v_mul_f32_dpp v149, v30, v149 row_newbcast:5 row_mask:0xf bank_mask:0xf
v_fma_f32 v106, v8, v104, v133
v_fma_f32 v107, v8, v105, v149
v_fma_f32 v106, -v9, v105, v106
v_fma_f32 v107, v9, v104, v107
v_mfma_f32_32x32x16_bf16 v[208:223], v[72:75], v[84:87], v[208:223]
v_xor_b32 v17, 64, v16
v_fmac_f32_dpp v134, v14, v32 row_newbcast:6 row_mask:0xf bank_mask:0xf
v_fmac_f32_dpp v150, v14, v33 row_newbcast:6 row_mask:0xf bank_mask:0xf
v_mul_f32_dpp v134, v30, v134 row_newbcast:6 row_mask:0xf bank_mask:0xf
v_mul_f32_dpp v150, v30, v150 row_newbcast:6 row_mask:0xf bank_mask:0xf
v_fma_f32 v104, v8, v106, v134
v_fma_f32 v105, v8, v107, v150
v_mfma_f32_32x32x16_bf16 v[224:239], v[76:79], v[80:83], v[224:239]
v_add_u32 v20, s53, v27
v_fma_f32 v104, -v9, v107, v104
v_fma_f32 v105, v9, v106, v105
v_fmac_f32_dpp v135, v14, v32 row_newbcast:7 row_mask:0xf bank_mask:0xf
v_fmac_f32_dpp v151, v14, v33 row_newbcast:7 row_mask:0xf bank_mask:0xf
v_mul_f32_dpp v135, v30, v135 row_newbcast:7 row_mask:0xf bank_mask:0xf
v_mul_f32_dpp v151, v30, v151 row_newbcast:7 row_mask:0xf bank_mask:0xf
v_fma_f32 v106, v8, v104, v135
v_fma_f32 v107, v8, v105, v151
v_mfma_f32_32x32x16_bf16 v[240:255], v[76:79], v[84:87], v[240:255]
v_fma_f32 v106, -v9, v105, v106
v_fma_f32 v107, v9, v104, v107
v_fmac_f32_dpp v136, v14, v32 row_newbcast:8 row_mask:0xf bank_mask:0xf
v_fmac_f32_dpp v152, v14, v33 row_newbcast:8 row_mask:0xf bank_mask:0xf
v_mul_f32_dpp v136, v30, v136 row_newbcast:8 row_mask:0xf bank_mask:0xf
v_mul_f32_dpp v152, v30, v152 row_newbcast:8 row_mask:0xf bank_mask:0xf
v_fma_f32 v104, v8, v106, v136
v_fma_f32 v105, v8, v107, v152
s_waitcnt lgkmcnt(0)
s_barrier
v_mfma_f32_32x32x16_bf16 v[192:207], v[88:91], v[96:99], v[192:207]
ds_read_b64_tr_b16 v[40:41], v16 offset:0
ds_read_b64_tr_b16 v[42:43], v16 offset:1024
ds_read_b128 v[48:51], v20 offset:0
v_fma_f32 v104, -v9, v107, v104
v_fma_f32 v105, v9, v106, v105
v_mfma_f32_32x32x16_bf16 v[208:223], v[88:91], v[100:103], v[208:223]
ds_read_b128 v[52:55], v20 offset:512
ds_read_b64_tr_b16 v[44:45], v17 offset:0
ds_read_b64_tr_b16 v[46:47], v17 offset:1024
v_fmac_f32_dpp v137, v14, v32 row_newbcast:9 row_mask:0xf bank_mask:0xf
v_fmac_f32_dpp v153, v14, v33 row_newbcast:9 row_mask:0xf bank_mask:0xf
v_mul_f32_dpp v137, v30, v137 row_newbcast:9 row_mask:0xf bank_mask:0xf
v_mul_f32_dpp v153, v30, v153 row_newbcast:9 row_mask:0xf bank_mask:0xf
v_mfma_f32_32x32x16_bf16 v[224:239], v[92:95], v[96:99], v[224:239]
ds_read_b64_tr_b16 v[56:57], v16 offset:4096
ds_read_b64_tr_b16 v[58:59], v16 offset:5120
ds_read_b128 v[64:67], v20 offset:4096
v_fma_f32 v106, v8, v104, v137
v_fma_f32 v107, v8, v105, v153
v_mfma_f32_32x32x16_bf16 v[240:255], v[92:95], v[100:103], v[240:255]
ds_read_b128 v[68:71], v20 offset:4608
ds_read_b64_tr_b16 v[60:61], v17 offset:4096
ds_read_b64_tr_b16 v[62:63], v17 offset:5120
v_fma_f32 v106, -v9, v105, v106
v_fma_f32 v107, v9, v104, v107
v_fmac_f32_dpp v138, v14, v32 row_newbcast:10 row_mask:0xf bank_mask:0xf
v_fmac_f32_dpp v154, v14, v33 row_newbcast:10 row_mask:0xf bank_mask:0xf
s_waitcnt lgkmcnt(6)
v_mfma_f32_32x32x16_bf16 v[192:207], v[40:43], v[48:51], v[192:207]
ds_read_b64_tr_b16 v[72:73], v16 offset:8192
ds_read_b64_tr_b16 v[74:75], v16 offset:9216
v_mul_f32_dpp v138, v30, v138 row_newbcast:10 row_mask:0xf bank_mask:0xf
v_mul_f32_dpp v154, v30, v154 row_newbcast:10 row_mask:0xf bank_mask:0xf
v_fma_f32 v104, v8, v106, v138
v_fma_f32 v105, v8, v107, v154
v_mfma_f32_32x32x16_bf16 v[208:223], v[40:43], v[52:55], v[208:223]
ds_read_b128 v[80:83], v20 offset:8192
ds_read_b128 v[84:87], v20 offset:8704
v_fma_f32 v104, -v9, v107, v104
v_fma_f32 v105, v9, v106, v105
v_fmac_f32_dpp v139, v14, v32 row_newbcast:11 row_mask:0xf bank_mask:0xf
v_fmac_f32_dpp v155, v14, v33 row_newbcast:11 row_mask:0xf bank_mask:0xf
v_mfma_f32_32x32x16_bf16 v[224:239], v[44:47], v[48:51], v[224:239]
ds_read_b64_tr_b16 v[76:77], v17 offset:8192
ds_read_b64_tr_b16 v[78:79], v17 offset:9216
v_mul_f32_dpp v139, v30, v139 row_newbcast:11 row_mask:0xf bank_mask:0xf
v_mul_f32_dpp v155, v30, v155 row_newbcast:11 row_mask:0xf bank_mask:0xf
v_fma_f32 v106, v8, v104, v139
v_fma_f32 v107, v8, v105, v155
v_fma_f32 v106, -v9, v105, v106
v_fma_f32 v107, v9, v104, v107
v_mfma_f32_32x32x16_bf16 v[240:255], v[44:47], v[52:55], v[240:255]
v_fmac_f32_dpp v140, v14, v32 row_newbcast:12 row_mask:0xf bank_mask:0xf
v_fmac_f32_dpp v156, v14, v33 row_newbcast:12 row_mask:0xf bank_mask:0xf
v_mul_f32_dpp v140, v30, v140 row_newbcast:12 row_mask:0xf bank_mask:0xf
v_mul_f32_dpp v156, v30, v156 row_newbcast:12 row_mask:0xf bank_mask:0xf
v_fma_f32 v104, v8, v106, v140
v_fma_f32 v105, v8, v107, v156
v_fma_f32 v104, -v9, v107, v104
v_fma_f32 v105, v9, v106, v105
s_waitcnt lgkmcnt(6)
v_mfma_f32_32x32x16_bf16 v[192:207], v[56:59], v[64:67], v[192:207]
ds_read_b64_tr_b16 v[88:89], v16 offset:12288
ds_read_b64_tr_b16 v[90:91], v16 offset:13312
v_fmac_f32_dpp v141, v14, v32 row_newbcast:13 row_mask:0xf bank_mask:0xf
v_fmac_f32_dpp v157, v14, v33 row_newbcast:13 row_mask:0xf bank_mask:0xf
v_mul_f32_dpp v141, v30, v141 row_newbcast:13 row_mask:0xf bank_mask:0xf
v_mul_f32_dpp v157, v30, v157 row_newbcast:13 row_mask:0xf bank_mask:0xf
v_mfma_f32_32x32x16_bf16 v[208:223], v[56:59], v[68:71], v[208:223]
ds_read_b128 v[96:99], v20 offset:12288
ds_read_b128 v[100:103], v20 offset:12800
v_fma_f32 v106, v8, v104, v141
v_fma_f32 v107, v8, v105, v157
v_fma_f32 v106, -v9, v105, v106
v_fma_f32 v107, v9, v104, v107
v_mfma_f32_32x32x16_bf16 v[224:239], v[60:63], v[64:67], v[224:239]
ds_read_b64_tr_b16 v[92:93], v17 offset:12288
ds_read_b64_tr_b16 v[94:95], v17 offset:13312
v_fmac_f32_dpp v142, v14, v32 row_newbcast:14 row_mask:0xf bank_mask:0xf
v_fmac_f32_dpp v158, v14, v33 row_newbcast:14 row_mask:0xf bank_mask:0xf
v_mul_f32_dpp v142, v30, v142 row_newbcast:14 row_mask:0xf bank_mask:0xf
v_mul_f32_dpp v158, v30, v158 row_newbcast:14 row_mask:0xf bank_mask:0xf
v_fma_f32 v104, v8, v106, v142
v_fma_f32 v105, v8, v107, v158
v_mfma_f32_32x32x16_bf16 v[240:255], v[60:63], v[68:71], v[240:255]
v_fma_f32 v104, -v9, v107, v104
v_fma_f32 v105, v9, v106, v105
v_fmac_f32_dpp v143, v14, v32 row_newbcast:15 row_mask:0xf bank_mask:0xf
v_fmac_f32_dpp v159, v14, v33 row_newbcast:15 row_mask:0xf bank_mask:0xf
v_mul_f32_dpp v143, v30, v143 row_newbcast:15 row_mask:0xf bank_mask:0xf
v_mul_f32_dpp v159, v30, v159 row_newbcast:15 row_mask:0xf bank_mask:0xf
v_fma_f32 v106, v8, v104, v143
v_fma_f32 v107, v8, v105, v159
s_add_u32 s53, s53, 32768
s_cmp_ge_u32 s53, 131072
s_cselect_b32 s53, 0, s53
s_waitcnt lgkmcnt(6)
v_mfma_f32_32x32x16_bf16 v[192:207], v[72:75], v[80:83], v[192:207]
v_add_u32 v16, s53, v26
v_fma_f32 v106, -v9, v105, v106
v_fma_f32 v107, v9, v104, v107
v_fmac_f32_dpp v160, v15, v32 row_newbcast:0 row_mask:0xf bank_mask:0xf
v_fmac_f32_dpp v176, v15, v33 row_newbcast:0 row_mask:0xf bank_mask:0xf
v_mul_f32_dpp v160, v31, v160 row_newbcast:0 row_mask:0xf bank_mask:0xf
v_mul_f32_dpp v176, v31, v176 row_newbcast:0 row_mask:0xf bank_mask:0xf
v_mfma_f32_32x32x16_bf16 v[208:223], v[72:75], v[84:87], v[208:223]
v_xor_b32 v17, 64, v16
v_fma_f32 v104, v8, v106, v160
v_fma_f32 v105, v8, v107, v176
v_fma_f32 v104, -v9, v107, v104
v_fma_f32 v105, v9, v106, v105
v_fmac_f32_dpp v161, v15, v32 row_newbcast:1 row_mask:0xf bank_mask:0xf
v_fmac_f32_dpp v177, v15, v33 row_newbcast:1 row_mask:0xf bank_mask:0xf
v_mul_f32_dpp v161, v31, v161 row_newbcast:1 row_mask:0xf bank_mask:0xf
v_mul_f32_dpp v177, v31, v177 row_newbcast:1 row_mask:0xf bank_mask:0xf
v_mfma_f32_32x32x16_bf16 v[224:239], v[76:79], v[80:83], v[224:239]
v_add_u32 v20, s53, v27
v_fma_f32 v106, v8, v104, v161
v_fma_f32 v107, v8, v105, v177
v_fma_f32 v106, -v9, v105, v106
v_fma_f32 v107, v9, v104, v107
v_fmac_f32_dpp v162, v15, v32 row_newbcast:2 row_mask:0xf bank_mask:0xf
v_fmac_f32_dpp v178, v15, v33 row_newbcast:2 row_mask:0xf bank_mask:0xf
v_mfma_f32_32x32x16_bf16 v[240:255], v[76:79], v[84:87], v[240:255]
v_mul_f32_dpp v162, v31, v162 row_newbcast:2 row_mask:0xf bank_mask:0xf
v_mul_f32_dpp v178, v31, v178 row_newbcast:2 row_mask:0xf bank_mask:0xf
v_fma_f32 v104, v8, v106, v162
v_fma_f32 v105, v8, v107, v178
v_fma_f32 v104, -v9, v107, v104
v_fma_f32 v105, v9, v106, v105
v_fmac_f32_dpp v163, v15, v32 row_newbcast:3 row_mask:0xf bank_mask:0xf
v_fmac_f32_dpp v179, v15, v33 row_newbcast:3 row_mask:0xf bank_mask:0xf
s_waitcnt lgkmcnt(0)
s_barrier
v_mfma_f32_32x32x16_bf16 v[192:207], v[88:91], v[96:99], v[192:207]
ds_read_b64_tr_b16 v[40:41], v16 offset:0
ds_read_b64_tr_b16 v[42:43], v16 offset:1024
ds_read_b128 v[48:51], v20 offset:0
v_mul_f32_dpp v163, v31, v163 row_newbcast:3 row_mask:0xf bank_mask:0xf
v_mul_f32_dpp v179, v31, v179 row_newbcast:3 row_mask:0xf bank_mask:0xf
v_fma_f32 v106, v8, v104, v163
v_fma_f32 v107, v8, v105, v179
v_mfma_f32_32x32x16_bf16 v[208:223], v[88:91], v[100:103], v[208:223]
ds_read_b128 v[52:55], v20 offset:512
ds_read_b64_tr_b16 v[44:45], v17 offset:0
ds_read_b64_tr_b16 v[46:47], v17 offset:1024
v_fma_f32 v106, -v9, v105, v106
v_fma_f32 v107, v9, v104, v107
v_mfma_f32_32x32x16_bf16 v[224:239], v[92:95], v[96:99], v[224:239]
ds_read_b64_tr_b16 v[56:57], v16 offset:4096
ds_read_b64_tr_b16 v[58:59], v16 offset:5120
ds_read_b128 v[64:67], v20 offset:4096
v_fmac_f32_dpp v164, v15, v32 row_newbcast:4 row_mask:0xf bank_mask:0xf
v_fmac_f32_dpp v180, v15, v33 row_newbcast:4 row_mask:0xf bank_mask:0xf
v_mul_f32_dpp v164, v31, v164 row_newbcast:4 row_mask:0xf bank_mask:0xf
v_mul_f32_dpp v180, v31, v180 row_newbcast:4 row_mask:0xf bank_mask:0xf
v_mfma_f32_32x32x16_bf16 v[240:255], v[92:95], v[100:103], v[240:255]
ds_read_b128 v[68:71], v20 offset:4608
ds_read_b64_tr_b16 v[60:61], v17 offset:4096
ds_read_b64_tr_b16 v[62:63], v17 offset:5120
v_fma_f32 v104, v8, v106, v164
v_fma_f32 v105, v8, v107, v180
s_waitcnt lgkmcnt(6)
v_mfma_f32_32x32x16_bf16 v[192:207], v[40:43], v[48:51], v[192:207]
ds_read_b64_tr_b16 v[72:73], v16 offset:8192
ds_read_b64_tr_b16 v[74:75], v16 offset:9216
v_fma_f32 v104, -v9, v107, v104
v_fma_f32 v105, v9, v106, v105
v_fmac_f32_dpp v165, v15, v32 row_newbcast:5 row_mask:0xf bank_mask:0xf
v_fmac_f32_dpp v181, v15, v33 row_newbcast:5 row_mask:0xf bank_mask:0xf
v_mul_f32_dpp v165, v31, v165 row_newbcast:5 row_mask:0xf bank_mask:0xf
v_mul_f32_dpp v181, v31, v181 row_newbcast:5 row_mask:0xf bank_mask:0xf
v_mfma_f32_32x32x16_bf16 v[208:223], v[40:43], v[52:55], v[208:223]
ds_read_b128 v[80:83], v20 offset:8192
ds_read_b128 v[84:87], v20 offset:8704
v_fma_f32 v106, v8, v104, v165
v_fma_f32 v107, v8, v105, v181
v_fma_f32 v106, -v9, v105, v106
v_fma_f32 v107, v9, v104, v107
v_mfma_f32_32x32x16_bf16 v[224:239], v[44:47], v[48:51], v[224:239]
ds_read_b64_tr_b16 v[76:77], v17 offset:8192
ds_read_b64_tr_b16 v[78:79], v17 offset:9216
v_fmac_f32_dpp v166, v15, v32 row_newbcast:6 row_mask:0xf bank_mask:0xf
v_fmac_f32_dpp v182, v15, v33 row_newbcast:6 row_mask:0xf bank_mask:0xf
v_mul_f32_dpp v166, v31, v166 row_newbcast:6 row_mask:0xf bank_mask:0xf
v_mul_f32_dpp v182, v31, v182 row_newbcast:6 row_mask:0xf bank_mask:0xf
v_mfma_f32_32x32x16_bf16 v[240:255], v[44:47], v[52:55], v[240:255]
v_fma_f32 v104, v8, v106, v166
v_fma_f32 v105, v8, v107, v182
v_fma_f32 v104, -v9, v107, v104
v_fma_f32 v105, v9, v106, v105
v_fmac_f32_dpp v167, v15, v32 row_newbcast:7 row_mask:0xf bank_mask:0xf
v_fmac_f32_dpp v183, v15, v33 row_newbcast:7 row_mask:0xf bank_mask:0xf
v_mul_f32_dpp v167, v31, v167 row_newbcast:7 row_mask:0xf bank_mask:0xf
v_mul_f32_dpp v183, v31, v183 row_newbcast:7 row_mask:0xf bank_mask:0xf
s_waitcnt lgkmcnt(6)
v_mfma_f32_32x32x16_bf16 v[192:207], v[56:59], v[64:67], v[192:207]
ds_read_b64_tr_b16 v[88:89], v16 offset:12288
ds_read_b64_tr_b16 v[90:91], v16 offset:13312
v_fma_f32 v106, v8, v104, v167
v_fma_f32 v107, v8, v105, v183
v_fma_f32 v106, -v9, v105, v106
v_fma_f32 v107, v9, v104, v107
v_fmac_f32_dpp v168, v15, v32 row_newbcast:8 row_mask:0xf bank_mask:0xf
v_fmac_f32_dpp v184, v15, v33 row_newbcast:8 row_mask:0xf bank_mask:0xf
v_mfma_f32_32x32x16_bf16 v[208:223], v[56:59], v[68:71], v[208:223]
ds_read_b128 v[96:99], v20 offset:12288
ds_read_b128 v[100:103], v20 offset:12800
v_mul_f32_dpp v168, v31, v168 row_newbcast:8 row_mask:0xf bank_mask:0xf
v_mul_f32_dpp v184, v31, v184 row_newbcast:8 row_mask:0xf bank_mask:0xf
v_fma_f32 v104, v8, v106, v168
v_fma_f32 v105, v8, v107, v184
v_mfma_f32_32x32x16_bf16 v[224:239], v[60:63], v[64:67], v[224:239]
ds_read_b64_tr_b16 v[92:93], v17 offset:12288
ds_read_b64_tr_b16 v[94:95], v17 offset:13312
v_fma_f32 v104, -v9, v107, v104
v_fma_f32 v105, v9, v106, v105
v_fmac_f32_dpp v169, v15, v32 row_newbcast:9 row_mask:0xf bank_mask:0xf
v_fmac_f32_dpp v185, v15, v33 row_newbcast:9 row_mask:0xf bank_mask:0xf
v_mfma_f32_32x32x16_bf16 v[240:255], v[60:63], v[68:71], v[240:255]
v_mul_f32_dpp v169, v31, v169 row_newbcast:9 row_mask:0xf bank_mask:0xf
v_mul_f32_dpp v185, v31, v185 row_newbcast:9 row_mask:0xf bank_mask:0xf
v_fma_f32 v106, v8, v104, v169
v_fma_f32 v107, v8, v105, v185
v_fma_f32 v106, -v9, v105, v106
v_fma_f32 v107, v9, v104, v107
v_fmac_f32_dpp v170, v15, v32 row_newbcast:10 row_mask:0xf bank_mask:0xf
v_fmac_f32_dpp v186, v15, v33 row_newbcast:10 row_mask:0xf bank_mask:0xf
s_add_u32 s53, s53, 32768
s_cmp_ge_u32 s53, 131072
s_cselect_b32 s53, 0, s53
s_waitcnt lgkmcnt(6)
v_mfma_f32_32x32x16_bf16 v[192:207], v[72:75], v[80:83], v[192:207]
v_add_u32 v16, s53, v26
v_mul_f32_dpp v170, v31, v170 row_newbcast:10 row_mask:0xf bank_mask:0xf
v_mul_f32_dpp v186, v31, v186 row_newbcast:10 row_mask:0xf bank_mask:0xf
v_fma_f32 v104, v8, v106, v170
v_fma_f32 v105, v8, v107, v186
v_fma_f32 v104, -v9, v107, v104
v_fma_f32 v105, v9, v106, v105
v_fmac_f32_dpp v171, v15, v32 row_newbcast:11 row_mask:0xf bank_mask:0xf
v_fmac_f32_dpp v187, v15, v33 row_newbcast:11 row_mask:0xf bank_mask:0xf
v_mfma_f32_32x32x16_bf16 v[208:223], v[72:75], v[84:87], v[208:223]
v_xor_b32 v17, 64, v16
v_mul_f32_dpp v171, v31, v171 row_newbcast:11 row_mask:0xf bank_mask:0xf
v_mul_f32_dpp v187, v31, v187 row_newbcast:11 row_mask:0xf bank_mask:0xf
v_fma_f32 v106, v8, v104, v171
v_fma_f32 v107, v8, v105, v187
v_fma_f32 v106, -v9, v105, v106
v_fma_f32 v107, v9, v104, v107
v_mfma_f32_32x32x16_bf16 v[224:239], v[76:79], v[80:83], v[224:239]
v_add_u32 v20, s53, v27
v_fmac_f32_dpp v172, v15, v32 row_newbcast:12 row_mask:0xf bank_mask:0xf
v_fmac_f32_dpp v188, v15, v33 row_newbcast:12 row_mask:0xf bank_mask:0xf
v_mul_f32_dpp v172, v31, v172 row_newbcast:12 row_mask:0xf bank_mask:0xf
v_mul_f32_dpp v188, v31, v188 row_newbcast:12 row_mask:0xf bank_mask:0xf
v_fma_f32 v104, v8, v106, v172
v_fma_f32 v105, v8, v107, v188
v_fma_f32 v104, -v9, v107, v104
v_fma_f32 v105, v9, v106, v105
v_mfma_f32_32x32x16_bf16 v[240:255], v[76:79], v[84:87], v[240:255]
v_fmac_f32_dpp v173, v15, v32 row_newbcast:13 row_mask:0xf bank_mask:0xf
v_fmac_f32_dpp v189, v15, v33 row_newbcast:13 row_mask:0xf bank_mask:0xf
v_mul_f32_dpp v173, v31, v173 row_newbcast:13 row_mask:0xf bank_mask:0xf
v_mul_f32_dpp v189, v31, v189 row_newbcast:13 row_mask:0xf bank_mask:0xf
v_fma_f32 v106, v8, v104, v173
v_fma_f32 v107, v8, v105, v189
v_fma_f32 v106, -v9, v105, v106
v_fma_f32 v107, v9, v104, v107
s_waitcnt lgkmcnt(0)
s_barrier
v_mfma_f32_32x32x16_bf16 v[192:207], v[88:91], v[96:99], v[192:207]
ds_read_b64_tr_b16 v[40:41], v16 offset:0
ds_read_b64_tr_b16 v[42:43], v16 offset:1024
ds_read_b128 v[48:51], v20 offset:0
v_fmac_f32_dpp v174, v15, v32 row_newbcast:14 row_mask:0xf bank_mask:0xf
v_fmac_f32_dpp v190, v15, v33 row_newbcast:14 row_mask:0xf bank_mask:0xf
v_mfma_f32_32x32x16_bf16 v[208:223], v[88:91], v[100:103], v[208:223]
ds_read_b128 v[52:55], v20 offset:512
ds_read_b64_tr_b16 v[44:45], v17 offset:0
ds_read_b64_tr_b16 v[46:47], v17 offset:1024
v_mul_f32_dpp v174, v31, v174 row_newbcast:14 row_mask:0xf bank_mask:0xf
v_mul_f32_dpp v190, v31, v190 row_newbcast:14 row_mask:0xf bank_mask:0xf
v_fma_f32 v104, v8, v106, v174
v_fma_f32 v105, v8, v107, v190
v_mfma_f32_32x32x16_bf16 v[224:239], v[92:95], v[96:99], v[224:239]
ds_read_b64_tr_b16 v[56:57], v16 offset:4096
ds_read_b64_tr_b16 v[58:59], v16 offset:5120
ds_read_b128 v[64:67], v20 offset:4096
v_fma_f32 v104, -v9, v107, v104
v_fma_f32 v105, v9, v106, v105
v_mfma_f32_32x32x16_bf16 v[240:255], v[92:95], v[100:103], v[240:255]
ds_read_b128 v[68:71], v20 offset:4608
ds_read_b64_tr_b16 v[60:61], v17 offset:4096
ds_read_b64_tr_b16 v[62:63], v17 offset:5120
v_fmac_f32_dpp v175, v15, v32 row_newbcast:15 row_mask:0xf bank_mask:0xf
v_fmac_f32_dpp v191, v15, v33 row_newbcast:15 row_mask:0xf bank_mask:0xf
v_mul_f32_dpp v175, v31, v175 row_newbcast:15 row_mask:0xf bank_mask:0xf
v_mul_f32_dpp v191, v31, v191 row_newbcast:15 row_mask:0xf bank_mask:0xf
s_waitcnt lgkmcnt(6)
v_mfma_f32_32x32x16_bf16 v[192:207], v[40:43], v[48:51], v[192:207]
ds_read_b64_tr_b16 v[72:73], v16 offset:8192
ds_read_b64_tr_b16 v[74:75], v16 offset:9216
v_fma_f32 v106, v8, v104, v175
v_fma_f32 v107, v8, v105, v191
v_fma_f32 v106, -v9, v105, v106
v_fma_f32 v107, v9, v104, v107
v_mfma_f32_32x32x16_bf16 v[208:223], v[40:43], v[52:55], v[208:223]
ds_read_b128 v[80:83], v20 offset:8192
ds_read_b128 v[84:87], v20 offset:8704
v_mfma_f32_32x32x16_bf16 v[224:239], v[44:47], v[48:51], v[224:239]
ds_read_b64_tr_b16 v[76:77], v17 offset:8192
ds_read_b64_tr_b16 v[78:79], v17 offset:9216
v_mov_b32 v34, v106
v_mov_b32 v35, v107
s_nop 1
v_permlane32_swap_b32 v34, v106
v_permlane32_swap_b32 v35, v107
s_nop 1
v_mfma_f32_32x32x16_bf16 v[240:255], v[44:47], v[52:55], v[240:255]
v_fma_f32 v110, v12, v34, v106
v_fma_f32 v111, v12, v35, v107
v_fma_f32 v110, -v13, v35, v110
v_fma_f32 v111, v13, v34, v111
s_lshl_b32 s51, s3, 8
s_add_u32 s51, s51, 0x24d00
v_add_u32 v38, s51, v7
ds_write_b64 v38, v[110:111]
s_waitcnt lgkmcnt(6)
v_mfma_f32_32x32x16_bf16 v[192:207], v[56:59], v[64:67], v[192:207]
ds_read_b64_tr_b16 v[88:89], v16 offset:12288
ds_read_b64_tr_b16 v[90:91], v16 offset:13312
v_lshrrev_b32 v2, 5, v1
v_lshlrev_b32 v2, 12, v2
v_lshl_add_u32 v2, v7, 1, v2
v_mfma_f32_32x32x16_bf16 v[208:223], v[56:59], v[68:71], v[208:223]
ds_read_b128 v[96:99], v20 offset:12288
ds_read_b128 v[100:103], v20 offset:12800
s_lshl_b32 s81, s42, 5
s_add_u32 s81, s81, s80
s_lshl_b32 s81, s81, 4
s_add_u32 s81, s81, s23
s_lshl_b32 s81, s81, 9
s_add_u32 s82, s81, 0x400000
v_mfma_f32_32x32x16_bf16 v[224:239], v[60:63], v[64:67], v[224:239]
ds_read_b64_tr_b16 v[92:93], v17 offset:12288
ds_read_b64_tr_b16 v[94:95], v17 offset:13312
v_and_b32 v36, 15, v1
v_lshrrev_b32 v3, 4, v1
v_bfe_u32 v4, v36, 2, 1
v_lshlrev_b32 v4, 5, v4
v_lshrrev_b32 v37, 3, v36
v_mfma_f32_32x32x16_bf16 v[240:255], v[60:63], v[68:71], v[240:255]
v_lshl_add_u32 v4, v37, 2, v4
v_and_b32 v36, 3, v36
v_add_u32 v36, v36, v4
v_bfe_u32 v4, v36, 1, 2
v_bfe_u32 v37, v36, 5, 1
v_lshl_add_u32 v4, v37, 2, v4
s_lshl_b32 s48, s22, 6
v_add_u32 v36, s48, v36
s_add_u32 s53, s53, 32768
s_cmp_ge_u32 s53, 131072
s_cselect_b32 s53, 0, s53
s_waitcnt lgkmcnt(6)
v_mfma_f32_32x32x16_bf16 v[192:207], v[72:75], v[80:83], v[192:207]
v_add_u32 v16, s53, v26
v_xor_b32 v3, v3, v4
v_lshlrev_b32 v3, 4, v3
v_lshl_add_u32 v36, v36, 7, v3
v_add_u32 v24, 0, v36
v_mfma_f32_32x32x16_bf16 v[208:223], v[72:75], v[84:87], v[208:223]
v_xor_b32 v17, 64, v16
v_mfma_f32_32x32x16_bf16 v[224:239], v[76:79], v[80:83], v[224:239]
v_add_u32 v20, s53, v27
v_mfma_f32_32x32x16_bf16 v[240:255], v[76:79], v[84:87], v[240:255]
s_waitcnt lgkmcnt(0)
s_barrier
v_mfma_f32_32x32x16_bf16 v[192:207], v[88:91], v[96:99], v[192:207]
ds_read_b64_tr_b16 v[40:41], v16 offset:0
ds_read_b64_tr_b16 v[42:43], v16 offset:1024
ds_read_b128 v[48:51], v20 offset:0
v_mfma_f32_32x32x16_bf16 v[208:223], v[88:91], v[100:103], v[208:223]
ds_read_b128 v[52:55], v20 offset:512
ds_read_b64_tr_b16 v[44:45], v17 offset:0
ds_read_b64_tr_b16 v[46:47], v17 offset:1024
v_mfma_f32_32x32x16_bf16 v[224:239], v[92:95], v[96:99], v[224:239]
ds_read_b64_tr_b16 v[56:57], v16 offset:4096
ds_read_b64_tr_b16 v[58:59], v16 offset:5120
ds_read_b128 v[64:67], v20 offset:4096
v_mfma_f32_32x32x16_bf16 v[240:255], v[92:95], v[100:103], v[240:255]
ds_read_b128 v[68:71], v20 offset:4608
ds_read_b64_tr_b16 v[60:61], v17 offset:4096
ds_read_b64_tr_b16 v[62:63], v17 offset:5120
s_waitcnt lgkmcnt(6)
v_mfma_f32_32x32x16_bf16 v[192:207], v[40:43], v[48:51], v[192:207]
ds_read_b64_tr_b16 v[72:73], v16 offset:8192
ds_read_b64_tr_b16 v[74:75], v16 offset:9216
v_mfma_f32_32x32x16_bf16 v[208:223], v[40:43], v[52:55], v[208:223]
ds_read_b128 v[80:83], v20 offset:8192
ds_read_b128 v[84:87], v20 offset:8704
v_mfma_f32_32x32x16_bf16 v[224:239], v[44:47], v[48:51], v[224:239]
ds_read_b64_tr_b16 v[76:77], v17 offset:8192
ds_read_b64_tr_b16 v[78:79], v17 offset:9216
v_mfma_f32_32x32x16_bf16 v[240:255], v[44:47], v[52:55], v[240:255]
s_waitcnt lgkmcnt(6)
v_mfma_f32_32x32x16_bf16 v[192:207], v[56:59], v[64:67], v[192:207]
ds_read_b64_tr_b16 v[88:89], v16 offset:12288
ds_read_b64_tr_b16 v[90:91], v16 offset:13312
v_mfma_f32_32x32x16_bf16 v[208:223], v[56:59], v[68:71], v[208:223]
ds_read_b128 v[96:99], v20 offset:12288
ds_read_b128 v[100:103], v20 offset:12800
v_mfma_f32_32x32x16_bf16 v[224:239], v[60:63], v[64:67], v[224:239]
ds_read_b64_tr_b16 v[92:93], v17 offset:12288
ds_read_b64_tr_b16 v[94:95], v17 offset:13312
v_mfma_f32_32x32x16_bf16 v[240:255], v[60:63], v[68:71], v[240:255]
s_add_u32 s53, s53, 32768
s_cmp_ge_u32 s53, 131072
s_cselect_b32 s53, 0, s53
s_waitcnt lgkmcnt(6)
v_mfma_f32_32x32x16_bf16 v[192:207], v[72:75], v[80:83], v[192:207]
v_add_u32 v16, s53, v26
v_mfma_f32_32x32x16_bf16 v[208:223], v[72:75], v[84:87], v[208:223]
v_xor_b32 v17, 64, v16
v_mfma_f32_32x32x16_bf16 v[224:239], v[76:79], v[80:83], v[224:239]
v_add_u32 v20, s53, v27
v_mfma_f32_32x32x16_bf16 v[240:255], v[76:79], v[84:87], v[240:255]
s_waitcnt lgkmcnt(0)
s_barrier
v_mfma_f32_32x32x16_bf16 v[192:207], v[88:91], v[96:99], v[192:207]
ds_read_b64_tr_b16 v[40:41], v16 offset:0
ds_read_b64_tr_b16 v[42:43], v16 offset:1024
ds_read_b128 v[48:51], v20 offset:0
v_mfma_f32_32x32x16_bf16 v[208:223], v[88:91], v[100:103], v[208:223]
ds_read_b128 v[52:55], v20 offset:512
ds_read_b64_tr_b16 v[44:45], v17 offset:0
ds_read_b64_tr_b16 v[46:47], v17 offset:1024
v_mfma_f32_32x32x16_bf16 v[224:239], v[92:95], v[96:99], v[224:239]
ds_read_b64_tr_b16 v[56:57], v16 offset:4096
ds_read_b64_tr_b16 v[58:59], v16 offset:5120
ds_read_b128 v[64:67], v20 offset:4096
v_mfma_f32_32x32x16_bf16 v[240:255], v[92:95], v[100:103], v[240:255]
ds_read_b128 v[68:71], v20 offset:4608
ds_read_b64_tr_b16 v[60:61], v17 offset:4096
ds_read_b64_tr_b16 v[62:63], v17 offset:5120
s_waitcnt lgkmcnt(6)
v_mfma_f32_32x32x16_bf16 v[192:207], v[40:43], v[48:51], v[192:207]
ds_read_b64_tr_b16 v[72:73], v16 offset:8192
ds_read_b64_tr_b16 v[74:75], v16 offset:9216
v_mfma_f32_32x32x16_bf16 v[208:223], v[40:43], v[52:55], v[208:223]
ds_read_b128 v[80:83], v20 offset:8192
ds_read_b128 v[84:87], v20 offset:8704
v_mfma_f32_32x32x16_bf16 v[224:239], v[44:47], v[48:51], v[224:239]
ds_read_b64_tr_b16 v[76:77], v17 offset:8192
ds_read_b64_tr_b16 v[78:79], v17 offset:9216
v_mfma_f32_32x32x16_bf16 v[240:255], v[44:47], v[52:55], v[240:255]
s_waitcnt lgkmcnt(6)
v_mfma_f32_32x32x16_bf16 v[192:207], v[56:59], v[64:67], v[192:207]
ds_read_b64_tr_b16 v[88:89], v16 offset:12288
ds_read_b64_tr_b16 v[90:91], v16 offset:13312
v_mfma_f32_32x32x16_bf16 v[208:223], v[56:59], v[68:71], v[208:223]
ds_read_b128 v[96:99], v20 offset:12288
ds_read_b128 v[100:103], v20 offset:12800
v_mfma_f32_32x32x16_bf16 v[224:239], v[60:63], v[64:67], v[224:239]
ds_read_b64_tr_b16 v[92:93], v17 offset:12288
ds_read_b64_tr_b16 v[94:95], v17 offset:13312
v_mfma_f32_32x32x16_bf16 v[240:255], v[60:63], v[68:71], v[240:255]
s_add_u32 s53, s53, 32768
s_cmp_ge_u32 s53, 131072
s_cselect_b32 s53, 0, s53
s_waitcnt lgkmcnt(6)
v_mfma_f32_32x32x16_bf16 v[192:207], v[72:75], v[80:83], v[192:207]
v_add_u32 v16, s53, v26
v_mfma_f32_32x32x16_bf16 v[208:223], v[72:75], v[84:87], v[208:223]
v_xor_b32 v17, 64, v16
v_mfma_f32_32x32x16_bf16 v[224:239], v[76:79], v[80:83], v[224:239]
v_add_u32 v20, s53, v27
v_mfma_f32_32x32x16_bf16 v[240:255], v[76:79], v[84:87], v[240:255]
s_waitcnt lgkmcnt(0)
s_barrier
v_mfma_f32_32x32x16_bf16 v[192:207], v[88:91], v[96:99], v[192:207]
ds_read_b64_tr_b16 v[40:41], v16 offset:0
ds_read_b64_tr_b16 v[42:43], v16 offset:1024
ds_read_b128 v[48:51], v20 offset:0
v_mfma_f32_32x32x16_bf16 v[208:223], v[88:91], v[100:103], v[208:223]
ds_read_b128 v[52:55], v20 offset:512
ds_read_b64_tr_b16 v[44:45], v17 offset:0
ds_read_b64_tr_b16 v[46:47], v17 offset:1024
v_mfma_f32_32x32x16_bf16 v[224:239], v[92:95], v[96:99], v[224:239]
ds_read_b64_tr_b16 v[56:57], v16 offset:4096
ds_read_b64_tr_b16 v[58:59], v16 offset:5120
ds_read_b128 v[64:67], v20 offset:4096
v_mfma_f32_32x32x16_bf16 v[240:255], v[92:95], v[100:103], v[240:255]
ds_read_b128 v[68:71], v20 offset:4608
ds_read_b64_tr_b16 v[60:61], v17 offset:4096
ds_read_b64_tr_b16 v[62:63], v17 offset:5120
s_waitcnt lgkmcnt(6)
v_mfma_f32_32x32x16_bf16 v[192:207], v[40:43], v[48:51], v[192:207]
ds_read_b64_tr_b16 v[72:73], v16 offset:8192
ds_read_b64_tr_b16 v[74:75], v16 offset:9216
v_mfma_f32_32x32x16_bf16 v[208:223], v[40:43], v[52:55], v[208:223]
ds_read_b128 v[80:83], v20 offset:8192
ds_read_b128 v[84:87], v20 offset:8704
v_mfma_f32_32x32x16_bf16 v[224:239], v[44:47], v[48:51], v[224:239]
ds_read_b64_tr_b16 v[76:77], v17 offset:8192
ds_read_b64_tr_b16 v[78:79], v17 offset:9216
v_mfma_f32_32x32x16_bf16 v[240:255], v[44:47], v[52:55], v[240:255]
s_waitcnt lgkmcnt(6)
v_mfma_f32_32x32x16_bf16 v[192:207], v[56:59], v[64:67], v[192:207]
ds_read_b64_tr_b16 v[88:89], v16 offset:12288
ds_read_b64_tr_b16 v[90:91], v16 offset:13312
v_mfma_f32_32x32x16_bf16 v[208:223], v[56:59], v[68:71], v[208:223]
ds_read_b128 v[96:99], v20 offset:12288
ds_read_b128 v[100:103], v20 offset:12800
v_mfma_f32_32x32x16_bf16 v[224:239], v[60:63], v[64:67], v[224:239]
ds_read_b64_tr_b16 v[92:93], v17 offset:12288
ds_read_b64_tr_b16 v[94:95], v17 offset:13312
v_mfma_f32_32x32x16_bf16 v[240:255], v[60:63], v[68:71], v[240:255]
s_add_u32 s53, s53, 32768
s_cmp_ge_u32 s53, 131072
s_cselect_b32 s53, 0, s53
s_waitcnt lgkmcnt(6)
v_mfma_f32_32x32x16_bf16 v[192:207], v[72:75], v[80:83], v[192:207]
v_add_u32 v16, s53, v26
v_mfma_f32_32x32x16_bf16 v[208:223], v[72:75], v[84:87], v[208:223]
v_xor_b32 v17, 64, v16
v_mfma_f32_32x32x16_bf16 v[224:239], v[76:79], v[80:83], v[224:239]
v_add_u32 v20, s53, v27
v_mfma_f32_32x32x16_bf16 v[240:255], v[76:79], v[84:87], v[240:255]
s_waitcnt lgkmcnt(0)
s_barrier
v_mfma_f32_32x32x16_bf16 v[192:207], v[88:91], v[96:99], v[192:207]
ds_read_b64_tr_b16 v[40:41], v16 offset:0
ds_read_b64_tr_b16 v[42:43], v16 offset:1024
ds_read_b128 v[48:51], v20 offset:0
v_mfma_f32_32x32x16_bf16 v[208:223], v[88:91], v[100:103], v[208:223]
ds_read_b128 v[52:55], v20 offset:512
ds_read_b64_tr_b16 v[44:45], v17 offset:0
ds_read_b64_tr_b16 v[46:47], v17 offset:1024
v_mfma_f32_32x32x16_bf16 v[224:239], v[92:95], v[96:99], v[224:239]
ds_read_b64_tr_b16 v[56:57], v16 offset:4096
ds_read_b64_tr_b16 v[58:59], v16 offset:5120
ds_read_b128 v[64:67], v20 offset:4096
v_mfma_f32_32x32x16_bf16 v[240:255], v[92:95], v[100:103], v[240:255]
ds_read_b128 v[68:71], v20 offset:4608
ds_read_b64_tr_b16 v[60:61], v17 offset:4096
ds_read_b64_tr_b16 v[62:63], v17 offset:5120
s_waitcnt lgkmcnt(6)
v_mfma_f32_32x32x16_bf16 v[192:207], v[40:43], v[48:51], v[192:207]
ds_read_b64_tr_b16 v[72:73], v16 offset:8192
ds_read_b64_tr_b16 v[74:75], v16 offset:9216
v_mfma_f32_32x32x16_bf16 v[208:223], v[40:43], v[52:55], v[208:223]
ds_read_b128 v[80:83], v20 offset:8192
ds_read_b128 v[84:87], v20 offset:8704
v_mfma_f32_32x32x16_bf16 v[224:239], v[44:47], v[48:51], v[224:239]
ds_read_b64_tr_b16 v[76:77], v17 offset:8192
ds_read_b64_tr_b16 v[78:79], v17 offset:9216
v_mfma_f32_32x32x16_bf16 v[240:255], v[44:47], v[52:55], v[240:255]
s_waitcnt lgkmcnt(6)
v_mfma_f32_32x32x16_bf16 v[192:207], v[56:59], v[64:67], v[192:207]
ds_read_b64_tr_b16 v[88:89], v16 offset:12288
ds_read_b64_tr_b16 v[90:91], v16 offset:13312
v_mfma_f32_32x32x16_bf16 v[208:223], v[56:59], v[68:71], v[208:223]
ds_read_b128 v[96:99], v20 offset:12288
ds_read_b128 v[100:103], v20 offset:12800
v_mfma_f32_32x32x16_bf16 v[224:239], v[60:63], v[64:67], v[224:239]
ds_read_b64_tr_b16 v[92:93], v17 offset:12288
ds_read_b64_tr_b16 v[94:95], v17 offset:13312
v_mfma_f32_32x32x16_bf16 v[240:255], v[60:63], v[68:71], v[240:255]
s_add_u32 s53, s53, 32768
s_cmp_ge_u32 s53, 131072
s_cselect_b32 s53, 0, s53
s_waitcnt lgkmcnt(6)
v_mfma_f32_32x32x16_bf16 v[192:207], v[72:75], v[80:83], v[192:207]
v_add_u32 v16, s53, v26
v_mfma_f32_32x32x16_bf16 v[208:223], v[72:75], v[84:87], v[208:223]
v_xor_b32 v17, 64, v16
v_mfma_f32_32x32x16_bf16 v[224:239], v[76:79], v[80:83], v[224:239]
v_add_u32 v20, s53, v27
v_mfma_f32_32x32x16_bf16 v[240:255], v[76:79], v[84:87], v[240:255]
s_waitcnt lgkmcnt(0)
s_barrier
v_mfma_f32_32x32x16_bf16 v[192:207], v[88:91], v[96:99], v[192:207]
ds_read_b64_tr_b16 v[40:41], v16 offset:0
ds_read_b64_tr_b16 v[42:43], v16 offset:1024
ds_read_b128 v[48:51], v20 offset:0
v_mfma_f32_32x32x16_bf16 v[208:223], v[88:91], v[100:103], v[208:223]
ds_read_b128 v[52:55], v20 offset:512
ds_read_b64_tr_b16 v[44:45], v17 offset:0
ds_read_b64_tr_b16 v[46:47], v17 offset:1024
v_mfma_f32_32x32x16_bf16 v[224:239], v[92:95], v[96:99], v[224:239]
ds_read_b64_tr_b16 v[56:57], v16 offset:4096
ds_read_b64_tr_b16 v[58:59], v16 offset:5120
ds_read_b128 v[64:67], v20 offset:4096
v_mfma_f32_32x32x16_bf16 v[240:255], v[92:95], v[100:103], v[240:255]
ds_read_b128 v[68:71], v20 offset:4608
ds_read_b64_tr_b16 v[60:61], v17 offset:4096
ds_read_b64_tr_b16 v[62:63], v17 offset:5120
s_waitcnt lgkmcnt(6)
v_mfma_f32_32x32x16_bf16 v[192:207], v[40:43], v[48:51], v[192:207]
ds_read_b64_tr_b16 v[72:73], v16 offset:8192
ds_read_b64_tr_b16 v[74:75], v16 offset:9216
v_mfma_f32_32x32x16_bf16 v[208:223], v[40:43], v[52:55], v[208:223]
ds_read_b128 v[80:83], v20 offset:8192
ds_read_b128 v[84:87], v20 offset:8704
v_mfma_f32_32x32x16_bf16 v[224:239], v[44:47], v[48:51], v[224:239]
ds_read_b64_tr_b16 v[76:77], v17 offset:8192
ds_read_b64_tr_b16 v[78:79], v17 offset:9216
v_mfma_f32_32x32x16_bf16 v[240:255], v[44:47], v[52:55], v[240:255]
s_waitcnt lgkmcnt(6)
v_mfma_f32_32x32x16_bf16 v[192:207], v[56:59], v[64:67], v[192:207]
ds_read_b64_tr_b16 v[88:89], v16 offset:12288
ds_read_b64_tr_b16 v[90:91], v16 offset:13312
v_mfma_f32_32x32x16_bf16 v[208:223], v[56:59], v[68:71], v[208:223]
ds_read_b128 v[96:99], v20 offset:12288
ds_read_b128 v[100:103], v20 offset:12800
v_mfma_f32_32x32x16_bf16 v[224:239], v[60:63], v[64:67], v[224:239]
ds_read_b64_tr_b16 v[92:93], v17 offset:12288
ds_read_b64_tr_b16 v[94:95], v17 offset:13312
v_mfma_f32_32x32x16_bf16 v[240:255], v[60:63], v[68:71], v[240:255]
s_add_u32 s53, s53, 32768
s_cmp_ge_u32 s53, 131072
s_cselect_b32 s53, 0, s53
s_waitcnt lgkmcnt(6)
v_mfma_f32_32x32x16_bf16 v[192:207], v[72:75], v[80:83], v[192:207]
v_add_u32 v16, s53, v26
v_mfma_f32_32x32x16_bf16 v[208:223], v[72:75], v[84:87], v[208:223]
v_xor_b32 v17, 64, v16
v_mfma_f32_32x32x16_bf16 v[224:239], v[76:79], v[80:83], v[224:239]
v_add_u32 v20, s53, v27
v_mfma_f32_32x32x16_bf16 v[240:255], v[76:79], v[84:87], v[240:255]
s_waitcnt lgkmcnt(0)
s_barrier
v_mfma_f32_32x32x16_bf16 v[192:207], v[88:91], v[96:99], v[192:207]
ds_read_b64_tr_b16 v[40:41], v16 offset:0
ds_read_b64_tr_b16 v[42:43], v16 offset:1024
ds_read_b128 v[48:51], v20 offset:0
v_mfma_f32_32x32x16_bf16 v[208:223], v[88:91], v[100:103], v[208:223]
ds_read_b128 v[52:55], v20 offset:512
ds_read_b64_tr_b16 v[44:45], v17 offset:0
ds_read_b64_tr_b16 v[46:47], v17 offset:1024
v_mfma_f32_32x32x16_bf16 v[224:239], v[92:95], v[96:99], v[224:239]
ds_read_b64_tr_b16 v[56:57], v16 offset:4096
ds_read_b64_tr_b16 v[58:59], v16 offset:5120
ds_read_b128 v[64:67], v20 offset:4096
v_mfma_f32_32x32x16_bf16 v[240:255], v[92:95], v[100:103], v[240:255]
ds_read_b128 v[68:71], v20 offset:4608
ds_read_b64_tr_b16 v[60:61], v17 offset:4096
ds_read_b64_tr_b16 v[62:63], v17 offset:5120
s_waitcnt lgkmcnt(6)
v_mfma_f32_32x32x16_bf16 v[192:207], v[40:43], v[48:51], v[192:207]
ds_read_b64_tr_b16 v[72:73], v16 offset:8192
ds_read_b64_tr_b16 v[74:75], v16 offset:9216
v_mfma_f32_32x32x16_bf16 v[208:223], v[40:43], v[52:55], v[208:223]
ds_read_b128 v[80:83], v20 offset:8192
ds_read_b128 v[84:87], v20 offset:8704
v_mfma_f32_32x32x16_bf16 v[224:239], v[44:47], v[48:51], v[224:239]
ds_read_b64_tr_b16 v[76:77], v17 offset:8192
ds_read_b64_tr_b16 v[78:79], v17 offset:9216
v_mfma_f32_32x32x16_bf16 v[240:255], v[44:47], v[52:55], v[240:255]
s_waitcnt lgkmcnt(6)
v_mfma_f32_32x32x16_bf16 v[192:207], v[56:59], v[64:67], v[192:207]
ds_read_b64_tr_b16 v[88:89], v16 offset:12288
ds_read_b64_tr_b16 v[90:91], v16 offset:13312
v_mfma_f32_32x32x16_bf16 v[208:223], v[56:59], v[68:71], v[208:223]
ds_read_b128 v[96:99], v20 offset:12288
ds_read_b128 v[100:103], v20 offset:12800
v_mfma_f32_32x32x16_bf16 v[224:239], v[60:63], v[64:67], v[224:239]
ds_read_b64_tr_b16 v[92:93], v17 offset:12288
ds_read_b64_tr_b16 v[94:95], v17 offset:13312
v_mfma_f32_32x32x16_bf16 v[240:255], v[60:63], v[68:71], v[240:255]
s_add_u32 s53, s53, 32768
s_cmp_ge_u32 s53, 131072
s_cselect_b32 s53, 0, s53
s_waitcnt lgkmcnt(6)
v_mfma_f32_32x32x16_bf16 v[192:207], v[72:75], v[80:83], v[192:207]
v_add_u32 v16, s53, v26
v_mfma_f32_32x32x16_bf16 v[208:223], v[72:75], v[84:87], v[208:223]
v_xor_b32 v17, 64, v16
v_mfma_f32_32x32x16_bf16 v[224:239], v[76:79], v[80:83], v[224:239]
v_add_u32 v20, s53, v27
v_mfma_f32_32x32x16_bf16 v[240:255], v[76:79], v[84:87], v[240:255]
s_waitcnt lgkmcnt(0)
s_barrier
v_mfma_f32_32x32x16_bf16 v[192:207], v[88:91], v[96:99], v[192:207]
ds_read_b64_tr_b16 v[40:41], v16 offset:0
ds_read_b64_tr_b16 v[42:43], v16 offset:1024
ds_read_b128 v[48:51], v20 offset:0
v_mfma_f32_32x32x16_bf16 v[208:223], v[88:91], v[100:103], v[208:223]
ds_read_b128 v[52:55], v20 offset:512
ds_read_b64_tr_b16 v[44:45], v17 offset:0
ds_read_b64_tr_b16 v[46:47], v17 offset:1024
v_mfma_f32_32x32x16_bf16 v[224:239], v[92:95], v[96:99], v[224:239]
ds_read_b64_tr_b16 v[56:57], v16 offset:4096
ds_read_b64_tr_b16 v[58:59], v16 offset:5120
ds_read_b128 v[64:67], v20 offset:4096
v_mfma_f32_32x32x16_bf16 v[240:255], v[92:95], v[100:103], v[240:255]
ds_read_b128 v[68:71], v20 offset:4608
ds_read_b64_tr_b16 v[60:61], v17 offset:4096
ds_read_b64_tr_b16 v[62:63], v17 offset:5120
s_waitcnt lgkmcnt(6)
v_mfma_f32_32x32x16_bf16 v[192:207], v[40:43], v[48:51], v[192:207]
ds_read_b64_tr_b16 v[72:73], v16 offset:8192
ds_read_b64_tr_b16 v[74:75], v16 offset:9216
v_mfma_f32_32x32x16_bf16 v[208:223], v[40:43], v[52:55], v[208:223]
ds_read_b128 v[80:83], v20 offset:8192
ds_read_b128 v[84:87], v20 offset:8704
v_mfma_f32_32x32x16_bf16 v[224:239], v[44:47], v[48:51], v[224:239]
ds_read_b64_tr_b16 v[76:77], v17 offset:8192
ds_read_b64_tr_b16 v[78:79], v17 offset:9216
v_mfma_f32_32x32x16_bf16 v[240:255], v[44:47], v[52:55], v[240:255]
s_waitcnt lgkmcnt(6)
v_mfma_f32_32x32x16_bf16 v[192:207], v[56:59], v[64:67], v[192:207]
ds_read_b64_tr_b16 v[88:89], v16 offset:12288
ds_read_b64_tr_b16 v[90:91], v16 offset:13312
v_mfma_f32_32x32x16_bf16 v[208:223], v[56:59], v[68:71], v[208:223]
ds_read_b128 v[96:99], v20 offset:12288
ds_read_b128 v[100:103], v20 offset:12800
v_mfma_f32_32x32x16_bf16 v[224:239], v[60:63], v[64:67], v[224:239]
ds_read_b64_tr_b16 v[92:93], v17 offset:12288
ds_read_b64_tr_b16 v[94:95], v17 offset:13312
v_mfma_f32_32x32x16_bf16 v[240:255], v[60:63], v[68:71], v[240:255]
s_add_u32 s53, s53, 32768
s_cmp_ge_u32 s53, 131072
s_cselect_b32 s53, 0, s53
s_waitcnt lgkmcnt(6)
v_mfma_f32_32x32x16_bf16 v[192:207], v[72:75], v[80:83], v[192:207]
v_add_u32 v16, s53, v26
v_mfma_f32_32x32x16_bf16 v[208:223], v[72:75], v[84:87], v[208:223]
v_xor_b32 v17, 64, v16
v_mfma_f32_32x32x16_bf16 v[224:239], v[76:79], v[80:83], v[224:239]
v_add_u32 v20, s53, v27
v_mfma_f32_32x32x16_bf16 v[240:255], v[76:79], v[84:87], v[240:255]
s_waitcnt lgkmcnt(0)
s_barrier
v_mfma_f32_32x32x16_bf16 v[192:207], v[88:91], v[96:99], v[192:207]
ds_read_b64_tr_b16 v[40:41], v16 offset:0
ds_read_b64_tr_b16 v[42:43], v16 offset:1024
ds_read_b128 v[48:51], v20 offset:0
v_mfma_f32_32x32x16_bf16 v[208:223], v[88:91], v[100:103], v[208:223]
ds_read_b128 v[52:55], v20 offset:512
ds_read_b64_tr_b16 v[44:45], v17 offset:0
ds_read_b64_tr_b16 v[46:47], v17 offset:1024
v_mfma_f32_32x32x16_bf16 v[224:239], v[92:95], v[96:99], v[224:239]
ds_read_b64_tr_b16 v[56:57], v16 offset:4096
ds_read_b64_tr_b16 v[58:59], v16 offset:5120
ds_read_b128 v[64:67], v20 offset:4096
v_mfma_f32_32x32x16_bf16 v[240:255], v[92:95], v[100:103], v[240:255]
ds_read_b128 v[68:71], v20 offset:4608
ds_read_b64_tr_b16 v[60:61], v17 offset:4096
ds_read_b64_tr_b16 v[62:63], v17 offset:5120
s_waitcnt lgkmcnt(6)
v_mfma_f32_32x32x16_bf16 v[192:207], v[40:43], v[48:51], v[192:207]
ds_read_b64_tr_b16 v[72:73], v16 offset:8192
ds_read_b64_tr_b16 v[74:75], v16 offset:9216
v_mfma_f32_32x32x16_bf16 v[208:223], v[40:43], v[52:55], v[208:223]
ds_read_b128 v[80:83], v20 offset:8192
ds_read_b128 v[84:87], v20 offset:8704
v_mfma_f32_32x32x16_bf16 v[224:239], v[44:47], v[48:51], v[224:239]
ds_read_b64_tr_b16 v[76:77], v17 offset:8192
ds_read_b64_tr_b16 v[78:79], v17 offset:9216
v_mfma_f32_32x32x16_bf16 v[240:255], v[44:47], v[52:55], v[240:255]
s_waitcnt lgkmcnt(6)
v_mfma_f32_32x32x16_bf16 v[192:207], v[56:59], v[64:67], v[192:207]
ds_read_b64_tr_b16 v[88:89], v16 offset:12288
ds_read_b64_tr_b16 v[90:91], v16 offset:13312
v_mfma_f32_32x32x16_bf16 v[208:223], v[56:59], v[68:71], v[208:223]
ds_read_b128 v[96:99], v20 offset:12288
ds_read_b128 v[100:103], v20 offset:12800
v_mfma_f32_32x32x16_bf16 v[224:239], v[60:63], v[64:67], v[224:239]
ds_read_b64_tr_b16 v[92:93], v17 offset:12288
ds_read_b64_tr_b16 v[94:95], v17 offset:13312
v_mfma_f32_32x32x16_bf16 v[240:255], v[60:63], v[68:71], v[240:255]
s_add_u32 s53, s53, 32768
s_cmp_ge_u32 s53, 131072
s_cselect_b32 s53, 0, s53
s_waitcnt lgkmcnt(6)
v_mfma_f32_32x32x16_bf16 v[192:207], v[72:75], v[80:83], v[192:207]
v_add_u32 v16, s53, v26
v_mfma_f32_32x32x16_bf16 v[208:223], v[72:75], v[84:87], v[208:223]
v_xor_b32 v17, 64, v16
v_mfma_f32_32x32x16_bf16 v[224:239], v[76:79], v[80:83], v[224:239]
v_add_u32 v20, s53, v27
v_mfma_f32_32x32x16_bf16 v[240:255], v[76:79], v[84:87], v[240:255]
s_waitcnt lgkmcnt(0)
s_barrier
v_mfma_f32_32x32x16_bf16 v[192:207], v[88:91], v[96:99], v[192:207]
ds_read_b64_tr_b16 v[40:41], v16 offset:0
ds_read_b64_tr_b16 v[42:43], v16 offset:1024
ds_read_b128 v[48:51], v20 offset:0
v_mfma_f32_32x32x16_bf16 v[208:223], v[88:91], v[100:103], v[208:223]
ds_read_b128 v[52:55], v20 offset:512
ds_read_b64_tr_b16 v[44:45], v17 offset:0
ds_read_b64_tr_b16 v[46:47], v17 offset:1024
v_mfma_f32_32x32x16_bf16 v[224:239], v[92:95], v[96:99], v[224:239]
ds_read_b64_tr_b16 v[56:57], v16 offset:4096
ds_read_b64_tr_b16 v[58:59], v16 offset:5120
ds_read_b128 v[64:67], v20 offset:4096
v_mfma_f32_32x32x16_bf16 v[240:255], v[92:95], v[100:103], v[240:255]
ds_read_b128 v[68:71], v20 offset:4608
ds_read_b64_tr_b16 v[60:61], v17 offset:4096
ds_read_b64_tr_b16 v[62:63], v17 offset:5120
s_waitcnt lgkmcnt(6)
v_mfma_f32_32x32x16_bf16 v[192:207], v[40:43], v[48:51], v[192:207]
ds_read_b64_tr_b16 v[72:73], v16 offset:8192
ds_read_b64_tr_b16 v[74:75], v16 offset:9216
v_mfma_f32_32x32x16_bf16 v[208:223], v[40:43], v[52:55], v[208:223]
ds_read_b128 v[80:83], v20 offset:8192
ds_read_b128 v[84:87], v20 offset:8704
v_mfma_f32_32x32x16_bf16 v[224:239], v[44:47], v[48:51], v[224:239]
ds_read_b64_tr_b16 v[76:77], v17 offset:8192
ds_read_b64_tr_b16 v[78:79], v17 offset:9216
v_mfma_f32_32x32x16_bf16 v[240:255], v[44:47], v[52:55], v[240:255]
s_waitcnt lgkmcnt(6)
v_mfma_f32_32x32x16_bf16 v[192:207], v[56:59], v[64:67], v[192:207]
ds_read_b64_tr_b16 v[88:89], v16 offset:12288
ds_read_b64_tr_b16 v[90:91], v16 offset:13312
v_mfma_f32_32x32x16_bf16 v[208:223], v[56:59], v[68:71], v[208:223]
ds_read_b128 v[96:99], v20 offset:12288
ds_read_b128 v[100:103], v20 offset:12800
v_mfma_f32_32x32x16_bf16 v[224:239], v[60:63], v[64:67], v[224:239]
ds_read_b64_tr_b16 v[92:93], v17 offset:12288
ds_read_b64_tr_b16 v[94:95], v17 offset:13312
v_mfma_f32_32x32x16_bf16 v[240:255], v[60:63], v[68:71], v[240:255]
s_add_u32 s53, s53, 32768
s_cmp_ge_u32 s53, 131072
s_cselect_b32 s53, 0, s53
s_waitcnt lgkmcnt(6)
v_mfma_f32_32x32x16_bf16 v[192:207], v[72:75], v[80:83], v[192:207]
v_add_u32 v16, s53, v26
v_mfma_f32_32x32x16_bf16 v[208:223], v[72:75], v[84:87], v[208:223]
v_xor_b32 v17, 64, v16
v_mfma_f32_32x32x16_bf16 v[224:239], v[76:79], v[80:83], v[224:239]
v_add_u32 v20, s53, v27
v_mfma_f32_32x32x16_bf16 v[240:255], v[76:79], v[84:87], v[240:255]
s_waitcnt lgkmcnt(0)
s_barrier
v_mfma_f32_32x32x16_bf16 v[192:207], v[88:91], v[96:99], v[192:207]
ds_read_b64_tr_b16 v[40:41], v16 offset:0
ds_read_b64_tr_b16 v[42:43], v16 offset:1024
ds_read_b128 v[48:51], v20 offset:0
v_mfma_f32_32x32x16_bf16 v[208:223], v[88:91], v[100:103], v[208:223]
ds_read_b128 v[52:55], v20 offset:512
ds_read_b64_tr_b16 v[44:45], v17 offset:0
ds_read_b64_tr_b16 v[46:47], v17 offset:1024
v_mfma_f32_32x32x16_bf16 v[224:239], v[92:95], v[96:99], v[224:239]
ds_read_b64_tr_b16 v[56:57], v16 offset:4096
ds_read_b64_tr_b16 v[58:59], v16 offset:5120
ds_read_b128 v[64:67], v20 offset:4096
v_mfma_f32_32x32x16_bf16 v[240:255], v[92:95], v[100:103], v[240:255]
ds_read_b128 v[68:71], v20 offset:4608
ds_read_b64_tr_b16 v[60:61], v17 offset:4096
ds_read_b64_tr_b16 v[62:63], v17 offset:5120
s_waitcnt lgkmcnt(6)
v_mfma_f32_32x32x16_bf16 v[192:207], v[40:43], v[48:51], v[192:207]
ds_read_b64_tr_b16 v[72:73], v16 offset:8192
ds_read_b64_tr_b16 v[74:75], v16 offset:9216
v_mfma_f32_32x32x16_bf16 v[208:223], v[40:43], v[52:55], v[208:223]
ds_read_b128 v[80:83], v20 offset:8192
ds_read_b128 v[84:87], v20 offset:8704
v_mfma_f32_32x32x16_bf16 v[224:239], v[44:47], v[48:51], v[224:239]
ds_read_b64_tr_b16 v[76:77], v17 offset:8192
ds_read_b64_tr_b16 v[78:79], v17 offset:9216
v_mfma_f32_32x32x16_bf16 v[240:255], v[44:47], v[52:55], v[240:255]
s_waitcnt lgkmcnt(6)
v_mfma_f32_32x32x16_bf16 v[192:207], v[56:59], v[64:67], v[192:207]
ds_read_b64_tr_b16 v[88:89], v16 offset:12288
ds_read_b64_tr_b16 v[90:91], v16 offset:13312
v_mfma_f32_32x32x16_bf16 v[208:223], v[56:59], v[68:71], v[208:223]
ds_read_b128 v[96:99], v20 offset:12288
ds_read_b128 v[100:103], v20 offset:12800
v_mfma_f32_32x32x16_bf16 v[224:239], v[60:63], v[64:67], v[224:239]
ds_read_b64_tr_b16 v[92:93], v17 offset:12288
ds_read_b64_tr_b16 v[94:95], v17 offset:13312
v_mfma_f32_32x32x16_bf16 v[240:255], v[60:63], v[68:71], v[240:255]
s_add_u32 s53, s53, 32768
s_cmp_ge_u32 s53, 131072
s_cselect_b32 s53, 0, s53
s_waitcnt lgkmcnt(6)
v_mfma_f32_32x32x16_bf16 v[192:207], v[72:75], v[80:83], v[192:207]
v_add_u32 v16, s53, v26
v_mfma_f32_32x32x16_bf16 v[208:223], v[72:75], v[84:87], v[208:223]
v_xor_b32 v17, 64, v16
v_mfma_f32_32x32x16_bf16 v[224:239], v[76:79], v[80:83], v[224:239]
v_add_u32 v20, s53, v27
v_mfma_f32_32x32x16_bf16 v[240:255], v[76:79], v[84:87], v[240:255]
s_waitcnt lgkmcnt(0)
s_barrier
v_mfma_f32_32x32x16_bf16 v[192:207], v[88:91], v[96:99], v[192:207]
ds_read_b64_tr_b16 v[40:41], v16 offset:0
ds_read_b64_tr_b16 v[42:43], v16 offset:1024
ds_read_b128 v[48:51], v20 offset:0
ds_read_b64 v[104:105], v38 offset:1024
v_mfma_f32_32x32x16_bf16 v[208:223], v[88:91], v[100:103], v[208:223]
ds_read_b128 v[52:55], v20 offset:512
ds_read_b64_tr_b16 v[44:45], v17 offset:0
ds_read_b64_tr_b16 v[46:47], v17 offset:1024
v_mfma_f32_32x32x16_bf16 v[224:239], v[92:95], v[96:99], v[224:239]
ds_read_b64_tr_b16 v[56:57], v16 offset:4096
ds_read_b64_tr_b16 v[58:59], v16 offset:5120
ds_read_b128 v[64:67], v20 offset:4096
v_lshrrev_b32 v36, 5, v1
v_lshlrev_b32 v36, 4, v36
s_lshl_b32 s51, s44, 1
s_add_u32 s51, s51, s22
s_lshl_b32 s51, s51, 7
v_mfma_f32_32x32x16_bf16 v[240:255], v[92:95], v[100:103], v[240:255]
ds_read_b128 v[68:71], v20 offset:4608
ds_read_b64_tr_b16 v[60:61], v17 offset:4096
ds_read_b64_tr_b16 v[62:63], v17 offset:5120
buffer_load_dwordx4 v[120:123], v36, s[72:75], s51 offen offset:0
s_waitcnt lgkmcnt(6)
v_mfma_f32_32x32x16_bf16 v[192:207], v[40:43], v[48:51], v[192:207]
ds_read_b64_tr_b16 v[72:73], v16 offset:8192
ds_read_b64_tr_b16 v[74:75], v16 offset:9216
buffer_load_dwordx4 v[124:127], v36, s[72:75], s51 offen offset:64
v_mfma_f32_32x32x16_bf16 v[208:223], v[40:43], v[52:55], v[208:223]
ds_read_b128 v[80:83], v20 offset:8192
ds_read_b128 v[84:87], v20 offset:8704
v_mfma_f32_32x32x16_bf16 v[224:239], v[44:47], v[48:51], v[224:239]
ds_read_b64_tr_b16 v[76:77], v17 offset:8192
ds_read_b64_tr_b16 v[78:79], v17 offset:9216
v_mfma_f32_32x32x16_bf16 v[240:255], v[44:47], v[52:55], v[240:255]
s_waitcnt lgkmcnt(6)
v_mfma_f32_32x32x16_bf16 v[192:207], v[56:59], v[64:67], v[192:207]
ds_read_b64_tr_b16 v[88:89], v16 offset:12288
ds_read_b64_tr_b16 v[90:91], v16 offset:13312
v_mfma_f32_32x32x16_bf16 v[208:223], v[56:59], v[68:71], v[208:223]
ds_read_b128 v[96:99], v20 offset:12288
ds_read_b128 v[100:103], v20 offset:12800
v_mfma_f32_32x32x16_bf16 v[224:239], v[60:63], v[64:67], v[224:239]
ds_read_b64_tr_b16 v[92:93], v17 offset:12288
ds_read_b64_tr_b16 v[94:95], v17 offset:13312
v_mfma_f32_32x32x16_bf16 v[240:255], v[60:63], v[68:71], v[240:255]
s_add_u32 s53, s53, 32768
s_cmp_ge_u32 s53, 131072
s_cselect_b32 s53, 0, s53
s_waitcnt lgkmcnt(6)
v_mfma_f32_32x32x16_bf16 v[192:207], v[72:75], v[80:83], v[192:207]
v_add_u32 v16, s53, v26
v_mfma_f32_32x32x16_bf16 v[208:223], v[72:75], v[84:87], v[208:223]
v_xor_b32 v17, 64, v16
v_mfma_f32_32x32x16_bf16 v[224:239], v[76:79], v[80:83], v[224:239]
v_add_u32 v20, s53, v27
v_mfma_f32_32x32x16_bf16 v[240:255], v[76:79], v[84:87], v[240:255]
s_waitcnt lgkmcnt(0)
s_barrier
v_mfma_f32_32x32x16_bf16 v[192:207], v[88:91], v[96:99], v[192:207]
ds_read_b64_tr_b16 v[40:41], v16 offset:0
ds_read_b64_tr_b16 v[42:43], v16 offset:1024
ds_read_b128 v[48:51], v20 offset:0
v_mfma_f32_32x32x16_bf16 v[208:223], v[88:91], v[100:103], v[208:223]
ds_read_b128 v[52:55], v20 offset:512
ds_read_b64_tr_b16 v[44:45], v17 offset:0
ds_read_b64_tr_b16 v[46:47], v17 offset:1024
v_fma_f32 v106, v12, v104, v34
v_fma_f32 v107, v12, v105, v35
v_fma_f32 v106, -v13, v105, v106
v_fma_f32 v107, v13, v104, v107
v_mfma_f32_32x32x16_bf16 v[224:239], v[92:95], v[96:99], v[224:239]
ds_read_b64_tr_b16 v[56:57], v16 offset:4096
ds_read_b64_tr_b16 v[58:59], v16 offset:5120
ds_read_b128 v[64:67], v20 offset:4096
v_cmp_lt_u32 vcc, 31, v1
s_nop 1
v_cndmask_b32 v104, v104, v106, vcc
v_cndmask_b32 v105, v105, v107, vcc
v_mfma_f32_32x32x16_bf16 v[240:255], v[92:95], v[100:103], v[240:255]
ds_read_b128 v[68:71], v20 offset:4608
ds_read_b64_tr_b16 v[60:61], v17 offset:4096
ds_read_b64_tr_b16 v[62:63], v17 offset:5120
v_fma_f32 v106, v8, v104, v128
v_fma_f32 v107, v8, v105, v144
s_waitcnt lgkmcnt(6)
v_mfma_f32_32x32x16_bf16 v[192:207], v[40:43], v[48:51], v[192:207]
ds_read_b64_tr_b16 v[72:73], v16 offset:8192
ds_read_b64_tr_b16 v[74:75], v16 offset:9216
v_fma_f32 v106, -v9, v105, v106
v_fma_f32 v107, v9, v104, v107
v_mul_f32 v128, v10, v106
v_mul_f32 v144, v10, v107
v_fma_f32 v128, -v11, v107, v128
v_fma_f32 v144, -v11, v106, -v144
v_mfma_f32_32x32x16_bf16 v[208:223], v[40:43], v[52:55], v[208:223]
ds_read_b128 v[80:83], v20 offset:8192
ds_read_b128 v[84:87], v20 offset:8704
v_fma_f32 v104, v8, v106, v129
v_fma_f32 v105, v8, v107, v145
v_fma_f32 v104, -v9, v107, v104
v_fma_f32 v105, v9, v106, v105
v_mfma_f32_32x32x16_bf16 v[224:239], v[44:47], v[48:51], v[224:239]
ds_read_b64_tr_b16 v[76:77], v17 offset:8192
ds_read_b64_tr_b16 v[78:79], v17 offset:9216
v_mul_f32 v129, v10, v104
v_mul_f32 v145, v10, v105
v_fma_f32 v129, -v11, v105, v129
v_fma_f32 v145, -v11, v104, -v145
v_mfma_f32_32x32x16_bf16 v[240:255], v[44:47], v[52:55], v[240:255]
v_fma_f32 v106, v8, v104, v130
v_fma_f32 v107, v8, v105, v146
v_fma_f32 v106, -v9, v105, v106
v_fma_f32 v107, v9, v104, v107
v_mul_f32 v130, v10, v106
v_mul_f32 v146, v10, v107
v_fma_f32 v130, -v11, v107, v130
v_fma_f32 v146, -v11, v106, -v146
s_waitcnt lgkmcnt(6)
v_mfma_f32_32x32x16_bf16 v[192:207], v[56:59], v[64:67], v[192:207]
ds_read_b64_tr_b16 v[88:89], v16 offset:12288
ds_read_b64_tr_b16 v[90:91], v16 offset:13312
v_fma_f32 v104, v8, v106, v131
v_fma_f32 v105, v8, v107, v147
v_fma_f32 v104, -v9, v107, v104
v_fma_f32 v105, v9, v106, v105
v_mul_f32 v131, v10, v104
v_mul_f32 v147, v10, v105
v_mfma_f32_32x32x16_bf16 v[208:223], v[56:59], v[68:71], v[208:223]
ds_read_b128 v[96:99], v20 offset:12288
ds_read_b128 v[100:103], v20 offset:12800
v_fma_f32 v131, -v11, v105, v131
v_fma_f32 v147, -v11, v104, -v147
v_fma_f32 v106, v8, v104, v132
v_fma_f32 v107, v8, v105, v148
v_mfma_f32_32x32x16_bf16 v[224:239], v[60:63], v[64:67], v[224:239]
ds_read_b64_tr_b16 v[92:93], v17 offset:12288
ds_read_b64_tr_b16 v[94:95], v17 offset:13312
v_fma_f32 v106, -v9, v105, v106
v_fma_f32 v107, v9, v104, v107
v_mul_f32 v132, v10, v106
v_mul_f32 v148, v10, v107
v_mfma_f32_32x32x16_bf16 v[240:255], v[60:63], v[68:71], v[240:255]
v_fma_f32 v132, -v11, v107, v132
v_fma_f32 v148, -v11, v106, -v148
v_fma_f32 v104, v8, v106, v133
v_fma_f32 v105, v8, v107, v149
v_fma_f32 v104, -v9, v107, v104
v_fma_f32 v105, v9, v106, v105
v_mul_f32 v133, v10, v104
v_mul_f32 v149, v10, v105
s_add_u32 s53, s53, 32768
s_cmp_ge_u32 s53, 131072
s_cselect_b32 s53, 0, s53
s_waitcnt lgkmcnt(6)
v_mfma_f32_32x32x16_bf16 v[192:207], v[72:75], v[80:83], v[192:207]
v_add_u32 v16, s53, v26
v_fma_f32 v133, -v11, v105, v133
v_fma_f32 v149, -v11, v104, -v149
v_fma_f32 v106, v8, v104, v134
v_fma_f32 v107, v8, v105, v150
v_fma_f32 v106, -v9, v105, v106
v_fma_f32 v107, v9, v104, v107
v_mul_f32 v134, v10, v106
v_mul_f32 v150, v10, v107
v_mfma_f32_32x32x16_bf16 v[208:223], v[72:75], v[84:87], v[208:223]
v_xor_b32 v17, 64, v16
v_fma_f32 v134, -v11, v107, v134
v_fma_f32 v150, -v11, v106, -v150
v_fma_f32 v104, v8, v106, v135
v_fma_f32 v105, v8, v107, v151
v_fma_f32 v104, -v9, v107, v104
v_fma_f32 v105, v9, v106, v105
v_mfma_f32_32x32x16_bf16 v[224:239], v[76:79], v[80:83], v[224:239]
v_add_u32 v20, s53, v27
v_mul_f32 v135, v10, v104
v_mul_f32 v151, v10, v105
v_fma_f32 v135, -v11, v105, v135
v_fma_f32 v151, -v11, v104, -v151
v_cvt_pk_bf16_f32 v128, v128, v129
v_cvt_pk_bf16_f32 v129, v130, v131
v_cvt_pk_bf16_f32 v130, v132, v133
v_cvt_pk_bf16_f32 v131, v134, v135
v_mfma_f32_32x32x16_bf16 v[240:255], v[76:79], v[84:87], v[240:255]
buffer_store_dwordx4 v[128:131], v2, s[64:67], s81 offen offset:0 sc1
s_waitcnt lgkmcnt(0)
s_barrier
v_mfma_f32_32x32x16_bf16 v[192:207], v[88:91], v[96:99], v[192:207]
ds_read_b64_tr_b16 v[40:41], v16 offset:0
ds_read_b64_tr_b16 v[42:43], v16 offset:1024
ds_read_b128 v[48:51], v20 offset:0
v_mfma_f32_32x32x16_bf16 v[208:223], v[88:91], v[100:103], v[208:223]
ds_read_b128 v[52:55], v20 offset:512
ds_read_b64_tr_b16 v[44:45], v17 offset:0
ds_read_b64_tr_b16 v[46:47], v17 offset:1024
v_mfma_f32_32x32x16_bf16 v[224:239], v[92:95], v[96:99], v[224:239]
ds_read_b64_tr_b16 v[56:57], v16 offset:4096
ds_read_b64_tr_b16 v[58:59], v16 offset:5120
ds_read_b128 v[64:67], v20 offset:4096
v_mfma_f32_32x32x16_bf16 v[240:255], v[92:95], v[100:103], v[240:255]
ds_read_b128 v[68:71], v20 offset:4608
ds_read_b64_tr_b16 v[60:61], v17 offset:4096
ds_read_b64_tr_b16 v[62:63], v17 offset:5120
s_waitcnt lgkmcnt(6)
v_mfma_f32_32x32x16_bf16 v[192:207], v[40:43], v[48:51], v[192:207]
ds_read_b64_tr_b16 v[72:73], v16 offset:8192
ds_read_b64_tr_b16 v[74:75], v16 offset:9216
v_mfma_f32_32x32x16_bf16 v[208:223], v[40:43], v[52:55], v[208:223]
ds_read_b128 v[80:83], v20 offset:8192
ds_read_b128 v[84:87], v20 offset:8704
v_cvt_pk_bf16_f32 v144, v144, v145
v_cvt_pk_bf16_f32 v145, v146, v147
v_cvt_pk_bf16_f32 v146, v148, v149
v_cvt_pk_bf16_f32 v147, v150, v151
v_mfma_f32_32x32x16_bf16 v[224:239], v[44:47], v[48:51], v[224:239]
ds_read_b64_tr_b16 v[76:77], v17 offset:8192
ds_read_b64_tr_b16 v[78:79], v17 offset:9216
buffer_store_dwordx4 v[144:147], v2, s[64:67], s82 offen offset:0 sc1
v_mfma_f32_32x32x16_bf16 v[240:255], v[44:47], v[52:55], v[240:255]
s_waitcnt lgkmcnt(6)
v_mfma_f32_32x32x16_bf16 v[192:207], v[56:59], v[64:67], v[192:207]
ds_read_b64_tr_b16 v[88:89], v16 offset:12288
ds_read_b64_tr_b16 v[90:91], v16 offset:13312
v_mfma_f32_32x32x16_bf16 v[208:223], v[56:59], v[68:71], v[208:223]
ds_read_b128 v[96:99], v20 offset:12288
ds_read_b128 v[100:103], v20 offset:12800
v_mfma_f32_32x32x16_bf16 v[224:239], v[60:63], v[64:67], v[224:239]
ds_read_b64_tr_b16 v[92:93], v17 offset:12288
ds_read_b64_tr_b16 v[94:95], v17 offset:13312
v_mfma_f32_32x32x16_bf16 v[240:255], v[60:63], v[68:71], v[240:255]
s_add_u32 s53, s53, 32768
s_cmp_ge_u32 s53, 131072
s_cselect_b32 s53, 0, s53
s_waitcnt lgkmcnt(6)
v_mfma_f32_32x32x16_bf16 v[192:207], v[72:75], v[80:83], v[192:207]
v_add_u32 v16, s53, v26
v_fma_f32 v106, v8, v104, v136
v_fma_f32 v107, v8, v105, v152
v_fma_f32 v106, -v9, v105, v106
v_fma_f32 v107, v9, v104, v107
v_mul_f32 v136, v10, v106
v_mul_f32 v152, v10, v107
v_mfma_f32_32x32x16_bf16 v[208:223], v[72:75], v[84:87], v[208:223]
v_xor_b32 v17, 64, v16
v_fma_f32 v136, -v11, v107, v136
v_fma_f32 v152, -v11, v106, -v152
v_fma_f32 v104, v8, v106, v137
v_fma_f32 v105, v8, v107, v153
v_fma_f32 v104, -v9, v107, v104
v_fma_f32 v105, v9, v106, v105
v_mul_f32 v137, v10, v104
v_mul_f32 v153, v10, v105
v_mfma_f32_32x32x16_bf16 v[224:239], v[76:79], v[80:83], v[224:239]
v_add_u32 v20, s53, v27
v_fma_f32 v137, -v11, v105, v137
v_fma_f32 v153, -v11, v104, -v153
v_fma_f32 v106, v8, v104, v138
v_fma_f32 v107, v8, v105, v154
v_fma_f32 v106, -v9, v105, v106
v_fma_f32 v107, v9, v104, v107
v_mfma_f32_32x32x16_bf16 v[240:255], v[76:79], v[84:87], v[240:255]
v_mul_f32 v138, v10, v106
v_mul_f32 v154, v10, v107
v_fma_f32 v138, -v11, v107, v138
v_fma_f32 v154, -v11, v106, -v154
v_fma_f32 v104, v8, v106, v139
v_fma_f32 v105, v8, v107, v155
v_fma_f32 v104, -v9, v107, v104
v_fma_f32 v105, v9, v106, v105
s_waitcnt lgkmcnt(0)
s_barrier
v_mfma_f32_32x32x16_bf16 v[192:207], v[88:91], v[96:99], v[192:207]
ds_read_b64_tr_b16 v[40:41], v16 offset:0
ds_read_b64_tr_b16 v[42:43], v16 offset:1024
ds_read_b128 v[48:51], v20 offset:0
v_mul_f32 v139, v10, v104
v_mul_f32 v155, v10, v105
v_fma_f32 v139, -v11, v105, v139
v_fma_f32 v155, -v11, v104, -v155
v_mfma_f32_32x32x16_bf16 v[208:223], v[88:91], v[100:103], v[208:223]
ds_read_b128 v[52:55], v20 offset:512
ds_read_b64_tr_b16 v[44:45], v17 offset:0
ds_read_b64_tr_b16 v[46:47], v17 offset:1024
v_fma_f32 v106, v8, v104, v140
v_fma_f32 v107, v8, v105, v156
v_mfma_f32_32x32x16_bf16 v[224:239], v[92:95], v[96:99], v[224:239]
ds_read_b64_tr_b16 v[56:57], v16 offset:4096
ds_read_b64_tr_b16 v[58:59], v16 offset:5120
ds_read_b128 v[64:67], v20 offset:4096
v_fma_f32 v106, -v9, v105, v106
v_fma_f32 v107, v9, v104, v107
v_mul_f32 v140, v10, v106
v_mul_f32 v156, v10, v107
v_mfma_f32_32x32x16_bf16 v[240:255], v[92:95], v[100:103], v[240:255]
ds_read_b128 v[68:71], v20 offset:4608
ds_read_b64_tr_b16 v[60:61], v17 offset:4096
ds_read_b64_tr_b16 v[62:63], v17 offset:5120
v_fma_f32 v140, -v11, v107, v140
v_fma_f32 v156, -v11, v106, -v156
s_waitcnt lgkmcnt(6)
v_mfma_f32_32x32x16_bf16 v[192:207], v[40:43], v[48:51], v[192:207]
ds_read_b64_tr_b16 v[72:73], v16 offset:8192
ds_read_b64_tr_b16 v[74:75], v16 offset:9216
v_fma_f32 v104, v8, v106, v141
v_fma_f32 v105, v8, v107, v157
v_fma_f32 v104, -v9, v107, v104
v_fma_f32 v105, v9, v106, v105
v_mul_f32 v141, v10, v104
v_mul_f32 v157, v10, v105
v_mfma_f32_32x32x16_bf16 v[208:223], v[40:43], v[52:55], v[208:223]
ds_read_b128 v[80:83], v20 offset:8192
ds_read_b128 v[84:87], v20 offset:8704
v_fma_f32 v141, -v11, v105, v141
v_fma_f32 v157, -v11, v104, -v157
v_fma_f32 v106, v8, v104, v142
v_fma_f32 v107, v8, v105, v158
v_mfma_f32_32x32x16_bf16 v[224:239], v[44:47], v[48:51], v[224:239]
ds_read_b64_tr_b16 v[76:77], v17 offset:8192
ds_read_b64_tr_b16 v[78:79], v17 offset:9216
v_fma_f32 v106, -v9, v105, v106
v_fma_f32 v107, v9, v104, v107
v_mul_f32 v142, v10, v106
v_mul_f32 v158, v10, v107
v_mfma_f32_32x32x16_bf16 v[240:255], v[44:47], v[52:55], v[240:255]
v_fma_f32 v142, -v11, v107, v142
v_fma_f32 v158, -v11, v106, -v158
v_fma_f32 v104, v8, v106, v143
v_fma_f32 v105, v8, v107, v159
v_fma_f32 v104, -v9, v107, v104
v_fma_f32 v105, v9, v106, v105
v_mul_f32 v143, v10, v104
v_mul_f32 v159, v10, v105
s_waitcnt lgkmcnt(6)
v_mfma_f32_32x32x16_bf16 v[192:207], v[56:59], v[64:67], v[192:207]
ds_read_b64_tr_b16 v[88:89], v16 offset:12288
ds_read_b64_tr_b16 v[90:91], v16 offset:13312
v_fma_f32 v143, -v11, v105, v143
v_fma_f32 v159, -v11, v104, -v159
v_cvt_pk_bf16_f32 v136, v136, v137
v_cvt_pk_bf16_f32 v137, v138, v139
v_cvt_pk_bf16_f32 v138, v140, v141
v_cvt_pk_bf16_f32 v139, v142, v143
v_mfma_f32_32x32x16_bf16 v[208:223], v[56:59], v[68:71], v[208:223]
ds_read_b128 v[96:99], v20 offset:12288
ds_read_b128 v[100:103], v20 offset:12800
buffer_store_dwordx4 v[136:139], v2, s[64:67], s81 offen offset:1024 sc1
v_mfma_f32_32x32x16_bf16 v[224:239], v[60:63], v[64:67], v[224:239]
ds_read_b64_tr_b16 v[92:93], v17 offset:12288
ds_read_b64_tr_b16 v[94:95], v17 offset:13312
v_mfma_f32_32x32x16_bf16 v[240:255], v[60:63], v[68:71], v[240:255]
s_add_u32 s53, s53, 32768
s_cmp_ge_u32 s53, 131072
s_cselect_b32 s53, 0, s53
s_waitcnt lgkmcnt(6)
v_mfma_f32_32x32x16_bf16 v[192:207], v[72:75], v[80:83], v[192:207]
v_add_u32 v16, s53, v26
v_mfma_f32_32x32x16_bf16 v[208:223], v[72:75], v[84:87], v[208:223]
v_xor_b32 v17, 64, v16
v_mfma_f32_32x32x16_bf16 v[224:239], v[76:79], v[80:83], v[224:239]
v_add_u32 v20, s53, v27
v_mfma_f32_32x32x16_bf16 v[240:255], v[76:79], v[84:87], v[240:255]
v_cvt_pk_bf16_f32 v152, v152, v153
v_cvt_pk_bf16_f32 v153, v154, v155
v_cvt_pk_bf16_f32 v154, v156, v157
v_cvt_pk_bf16_f32 v155, v158, v159
buffer_store_dwordx4 v[152:155], v2, s[64:67], s82 offen offset:1024 sc1
s_waitcnt lgkmcnt(0)
s_barrier
v_mfma_f32_32x32x16_bf16 v[192:207], v[88:91], v[96:99], v[192:207]
ds_read_b64_tr_b16 v[40:41], v16 offset:0
ds_read_b64_tr_b16 v[42:43], v16 offset:1024
ds_read_b128 v[48:51], v20 offset:0
v_mfma_f32_32x32x16_bf16 v[208:223], v[88:91], v[100:103], v[208:223]
ds_read_b128 v[52:55], v20 offset:512
ds_read_b64_tr_b16 v[44:45], v17 offset:0
ds_read_b64_tr_b16 v[46:47], v17 offset:1024
v_mfma_f32_32x32x16_bf16 v[224:239], v[92:95], v[96:99], v[224:239]
ds_read_b64_tr_b16 v[56:57], v16 offset:4096
ds_read_b64_tr_b16 v[58:59], v16 offset:5120
ds_read_b128 v[64:67], v20 offset:4096
v_mfma_f32_32x32x16_bf16 v[240:255], v[92:95], v[100:103], v[240:255]
ds_read_b128 v[68:71], v20 offset:4608
ds_read_b64_tr_b16 v[60:61], v17 offset:4096
ds_read_b64_tr_b16 v[62:63], v17 offset:5120
s_waitcnt lgkmcnt(6)
v_mfma_f32_32x32x16_bf16 v[192:207], v[40:43], v[48:51], v[192:207]
ds_read_b64_tr_b16 v[72:73], v16 offset:8192
ds_read_b64_tr_b16 v[74:75], v16 offset:9216
v_mfma_f32_32x32x16_bf16 v[208:223], v[40:43], v[52:55], v[208:223]
ds_read_b128 v[80:83], v20 offset:8192
ds_read_b128 v[84:87], v20 offset:8704
v_fma_f32 v106, v8, v104, v160
v_fma_f32 v107, v8, v105, v176
v_fma_f32 v106, -v9, v105, v106
v_fma_f32 v107, v9, v104, v107
v_mfma_f32_32x32x16_bf16 v[224:239], v[44:47], v[48:51], v[224:239]
ds_read_b64_tr_b16 v[76:77], v17 offset:8192
ds_read_b64_tr_b16 v[78:79], v17 offset:9216
v_mul_f32 v160, v10, v106
v_mul_f32 v176, v10, v107
v_fma_f32 v160, -v11, v107, v160
v_fma_f32 v176, -v11, v106, -v176
v_mfma_f32_32x32x16_bf16 v[240:255], v[44:47], v[52:55], v[240:255]
v_fma_f32 v104, v8, v106, v161
v_fma_f32 v105, v8, v107, v177
v_fma_f32 v104, -v9, v107, v104
v_fma_f32 v105, v9, v106, v105
v_mul_f32 v161, v10, v104
v_mul_f32 v177, v10, v105
v_fma_f32 v161, -v11, v105, v161
v_fma_f32 v177, -v11, v104, -v177
s_waitcnt lgkmcnt(6)
v_mfma_f32_32x32x16_bf16 v[192:207], v[56:59], v[64:67], v[192:207]
ds_read_b64_tr_b16 v[88:89], v16 offset:12288
ds_read_b64_tr_b16 v[90:91], v16 offset:13312
v_fma_f32 v106, v8, v104, v162
v_fma_f32 v107, v8, v105, v178
v_fma_f32 v106, -v9, v105, v106
v_fma_f32 v107, v9, v104, v107
v_mul_f32 v162, v10, v106
v_mul_f32 v178, v10, v107
v_mfma_f32_32x32x16_bf16 v[208:223], v[56:59], v[68:71], v[208:223]
ds_read_b128 v[96:99], v20 offset:12288
ds_read_b128 v[100:103], v20 offset:12800
v_fma_f32 v162, -v11, v107, v162
v_fma_f32 v178, -v11, v106, -v178
v_fma_f32 v104, v8, v106, v163
v_fma_f32 v105, v8, v107, v179
v_mfma_f32_32x32x16_bf16 v[224:239], v[60:63], v[64:67], v[224:239]
ds_read_b64_tr_b16 v[92:93], v17 offset:12288
ds_read_b64_tr_b16 v[94:95], v17 offset:13312
v_fma_f32 v104, -v9, v107, v104
v_fma_f32 v105, v9, v106, v105
v_mul_f32 v163, v10, v104
v_mul_f32 v179, v10, v105
v_mfma_f32_32x32x16_bf16 v[240:255], v[60:63], v[68:71], v[240:255]
v_fma_f32 v163, -v11, v105, v163
v_fma_f32 v179, -v11, v104, -v179
v_fma_f32 v106, v8, v104, v164
v_fma_f32 v107, v8, v105, v180
v_fma_f32 v106, -v9, v105, v106
v_fma_f32 v107, v9, v104, v107
v_mul_f32 v164, v10, v106
v_mul_f32 v180, v10, v107
s_add_u32 s53, s53, 32768
s_cmp_ge_u32 s53, 131072
s_cselect_b32 s53, 0, s53
s_waitcnt lgkmcnt(6)
v_mfma_f32_32x32x16_bf16 v[192:207], v[72:75], v[80:83], v[192:207]
v_add_u32 v16, s53, v26
v_fma_f32 v164, -v11, v107, v164
v_fma_f32 v180, -v11, v106, -v180
v_fma_f32 v104, v8, v106, v165
v_fma_f32 v105, v8, v107, v181
v_fma_f32 v104, -v9, v107, v104
v_fma_f32 v105, v9, v106, v105
v_mul_f32 v165, v10, v104
v_mul_f32 v181, v10, v105
v_mfma_f32_32x32x16_bf16 v[208:223], v[72:75], v[84:87], v[208:223]
v_xor_b32 v17, 64, v16
v_fma_f32 v165, -v11, v105, v165
v_fma_f32 v181, -v11, v104, -v181
v_fma_f32 v106, v8, v104, v166
v_fma_f32 v107, v8, v105, v182
v_fma_f32 v106, -v9, v105, v106
v_fma_f32 v107, v9, v104, v107
v_mfma_f32_32x32x16_bf16 v[224:239], v[76:79], v[80:83], v[224:239]
v_add_u32 v20, s53, v27
v_mul_f32 v166, v10, v106
v_mul_f32 v182, v10, v107
v_fma_f32 v166, -v11, v107, v166
v_fma_f32 v182, -v11, v106, -v182
v_fma_f32 v104, v8, v106, v167
v_fma_f32 v105, v8, v107, v183
v_fma_f32 v104, -v9, v107, v104
v_fma_f32 v105, v9, v106, v105
v_mfma_f32_32x32x16_bf16 v[240:255], v[76:79], v[84:87], v[240:255]
v_mul_f32 v167, v10, v104
v_mul_f32 v183, v10, v105
v_fma_f32 v167, -v11, v105, v167
v_fma_f32 v183, -v11, v104, -v183
v_cvt_pk_bf16_f32 v160, v160, v161
v_cvt_pk_bf16_f32 v161, v162, v163
v_cvt_pk_bf16_f32 v162, v164, v165
v_cvt_pk_bf16_f32 v163, v166, v167
s_waitcnt lgkmcnt(0)
s_barrier
v_mfma_f32_32x32x16_bf16 v[192:207], v[88:91], v[96:99], v[192:207]
ds_read_b64_tr_b16 v[40:41], v16 offset:0
ds_read_b64_tr_b16 v[42:43], v16 offset:1024
ds_read_b128 v[48:51], v20 offset:0
buffer_store_dwordx4 v[160:163], v2, s[64:67], s81 offen offset:2048 sc1
v_mfma_f32_32x32x16_bf16 v[208:223], v[88:91], v[100:103], v[208:223]
ds_read_b128 v[52:55], v20 offset:512
ds_read_b64_tr_b16 v[44:45], v17 offset:0
ds_read_b64_tr_b16 v[46:47], v17 offset:1024
v_mfma_f32_32x32x16_bf16 v[224:239], v[92:95], v[96:99], v[224:239]
ds_read_b64_tr_b16 v[56:57], v16 offset:4096
ds_read_b64_tr_b16 v[58:59], v16 offset:5120
ds_read_b128 v[64:67], v20 offset:4096
v_mfma_f32_32x32x16_bf16 v[240:255], v[92:95], v[100:103], v[240:255]
ds_read_b128 v[68:71], v20 offset:4608
ds_read_b64_tr_b16 v[60:61], v17 offset:4096
ds_read_b64_tr_b16 v[62:63], v17 offset:5120
s_waitcnt lgkmcnt(6)
v_mfma_f32_32x32x16_bf16 v[192:207], v[40:43], v[48:51], v[192:207]
ds_read_b64_tr_b16 v[72:73], v16 offset:8192
ds_read_b64_tr_b16 v[74:75], v16 offset:9216
v_mfma_f32_32x32x16_bf16 v[208:223], v[40:43], v[52:55], v[208:223]
ds_read_b128 v[80:83], v20 offset:8192
ds_read_b128 v[84:87], v20 offset:8704
v_mfma_f32_32x32x16_bf16 v[224:239], v[44:47], v[48:51], v[224:239]
ds_read_b64_tr_b16 v[76:77], v17 offset:8192
ds_read_b64_tr_b16 v[78:79], v17 offset:9216
v_cvt_pk_bf16_f32 v176, v176, v177
v_cvt_pk_bf16_f32 v177, v178, v179
v_cvt_pk_bf16_f32 v178, v180, v181
v_cvt_pk_bf16_f32 v179, v182, v183
v_mfma_f32_32x32x16_bf16 v[240:255], v[44:47], v[52:55], v[240:255]
buffer_store_dwordx4 v[176:179], v2, s[64:67], s82 offen offset:2048 sc1
s_waitcnt lgkmcnt(6)
v_mfma_f32_32x32x16_bf16 v[192:207], v[56:59], v[64:67], v[192:207]
ds_read_b64_tr_b16 v[88:89], v16 offset:12288
ds_read_b64_tr_b16 v[90:91], v16 offset:13312
v_mfma_f32_32x32x16_bf16 v[208:223], v[56:59], v[68:71], v[208:223]
ds_read_b128 v[96:99], v20 offset:12288
ds_read_b128 v[100:103], v20 offset:12800
v_mfma_f32_32x32x16_bf16 v[224:239], v[60:63], v[64:67], v[224:239]
ds_read_b64_tr_b16 v[92:93], v17 offset:12288
ds_read_b64_tr_b16 v[94:95], v17 offset:13312
v_mfma_f32_32x32x16_bf16 v[240:255], v[60:63], v[68:71], v[240:255]
s_add_u32 s53, s53, 32768
s_cmp_ge_u32 s53, 131072
s_cselect_b32 s53, 0, s53
s_waitcnt lgkmcnt(6)
v_mfma_f32_32x32x16_bf16 v[192:207], v[72:75], v[80:83], v[192:207]
v_add_u32 v16, s53, v26
v_mfma_f32_32x32x16_bf16 v[208:223], v[72:75], v[84:87], v[208:223]
v_xor_b32 v17, 64, v16
v_fma_f32 v106, v8, v104, v168
v_fma_f32 v107, v8, v105, v184
v_fma_f32 v106, -v9, v105, v106
v_fma_f32 v107, v9, v104, v107
v_mul_f32 v168, v10, v106
v_mul_f32 v184, v10, v107
v_mfma_f32_32x32x16_bf16 v[224:239], v[76:79], v[80:83], v[224:239]
v_add_u32 v20, s53, v27
v_fma_f32 v168, -v11, v107, v168
v_fma_f32 v184, -v11, v106, -v184
v_fma_f32 v104, v8, v106, v169
v_fma_f32 v105, v8, v107, v185
v_fma_f32 v104, -v9, v107, v104
v_fma_f32 v105, v9, v106, v105
v_mul_f32 v169, v10, v104
v_mul_f32 v185, v10, v105
v_mfma_f32_32x32x16_bf16 v[240:255], v[76:79], v[84:87], v[240:255]
v_fma_f32 v169, -v11, v105, v169
v_fma_f32 v185, -v11, v104, -v185
v_fma_f32 v106, v8, v104, v170
v_fma_f32 v107, v8, v105, v186
v_fma_f32 v106, -v9, v105, v106
v_fma_f32 v107, v9, v104, v107
v_mul_f32 v170, v10, v106
v_mul_f32 v186, v10, v107
s_waitcnt lgkmcnt(0)
s_barrier
v_mfma_f32_32x32x16_bf16 v[192:207], v[88:91], v[96:99], v[192:207]
ds_read_b64_tr_b16 v[40:41], v16 offset:0
ds_read_b64_tr_b16 v[42:43], v16 offset:1024
ds_read_b128 v[48:51], v20 offset:0
v_fma_f32 v170, -v11, v107, v170
v_fma_f32 v186, -v11, v106, -v186
v_mfma_f32_32x32x16_bf16 v[208:223], v[88:91], v[100:103], v[208:223]
ds_read_b128 v[52:55], v20 offset:512
ds_read_b64_tr_b16 v[44:45], v17 offset:0
ds_read_b64_tr_b16 v[46:47], v17 offset:1024
v_fma_f32 v104, v8, v106, v171
v_fma_f32 v105, v8, v107, v187
v_fma_f32 v104, -v9, v107, v104
v_fma_f32 v105, v9, v106, v105
v_mfma_f32_32x32x16_bf16 v[224:239], v[92:95], v[96:99], v[224:239]
ds_read_b64_tr_b16 v[56:57], v16 offset:4096
ds_read_b64_tr_b16 v[58:59], v16 offset:5120
ds_read_b128 v[64:67], v20 offset:4096
v_mul_f32 v171, v10, v104
v_mul_f32 v187, v10, v105
v_mfma_f32_32x32x16_bf16 v[240:255], v[92:95], v[100:103], v[240:255]
ds_read_b128 v[68:71], v20 offset:4608
ds_read_b64_tr_b16 v[60:61], v17 offset:4096
ds_read_b64_tr_b16 v[62:63], v17 offset:5120
v_fma_f32 v171, -v11, v105, v171
v_fma_f32 v187, -v11, v104, -v187
v_fma_f32 v106, v8, v104, v172
v_fma_f32 v107, v8, v105, v188
s_waitcnt lgkmcnt(6)
v_mfma_f32_32x32x16_bf16 v[192:207], v[40:43], v[48:51], v[192:207]
ds_read_b64_tr_b16 v[72:73], v16 offset:8192
ds_read_b64_tr_b16 v[74:75], v16 offset:9216
v_fma_f32 v106, -v9, v105, v106
v_fma_f32 v107, v9, v104, v107
v_mul_f32 v172, v10, v106
v_mul_f32 v188, v10, v107
v_mfma_f32_32x32x16_bf16 v[208:223], v[40:43], v[52:55], v[208:223]
ds_read_b128 v[80:83], v20 offset:8192
ds_read_b128 v[84:87], v20 offset:8704
v_fma_f32 v172, -v11, v107, v172
v_fma_f32 v188, -v11, v106, -v188
v_fma_f32 v104, v8, v106, v173
v_fma_f32 v105, v8, v107, v189
v_mfma_f32_32x32x16_bf16 v[224:239], v[44:47], v[48:51], v[224:239]
ds_read_b64_tr_b16 v[76:77], v17 offset:8192
ds_read_b64_tr_b16 v[78:79], v17 offset:9216
v_fma_f32 v104, -v9, v107, v104
v_fma_f32 v105, v9, v106, v105
v_mul_f32 v173, v10, v104
v_mul_f32 v189, v10, v105
v_fma_f32 v173, -v11, v105, v173
v_fma_f32 v189, -v11, v104, -v189
v_mfma_f32_32x32x16_bf16 v[240:255], v[44:47], v[52:55], v[240:255]
v_fma_f32 v106, v8, v104, v174
v_fma_f32 v107, v8, v105, v190
v_fma_f32 v106, -v9, v105, v106
v_fma_f32 v107, v9, v104, v107
v_mul_f32 v174, v10, v106
v_mul_f32 v190, v10, v107
v_fma_f32 v174, -v11, v107, v174
v_fma_f32 v190, -v11, v106, -v190
s_waitcnt lgkmcnt(6)
v_mfma_f32_32x32x16_bf16 v[192:207], v[56:59], v[64:67], v[192:207]
ds_read_b64_tr_b16 v[88:89], v16 offset:12288
ds_read_b64_tr_b16 v[90:91], v16 offset:13312
v_fma_f32 v104, v8, v106, v175
v_fma_f32 v105, v8, v107, v191
v_fma_f32 v104, -v9, v107, v104
v_fma_f32 v105, v9, v106, v105
v_mfma_f32_32x32x16_bf16 v[208:223], v[56:59], v[68:71], v[208:223]
ds_read_b128 v[96:99], v20 offset:12288
ds_read_b128 v[100:103], v20 offset:12800
v_mul_f32 v175, v10, v104
v_mul_f32 v191, v10, v105
v_fma_f32 v175, -v11, v105, v175
v_fma_f32 v191, -v11, v104, -v191
v_mfma_f32_32x32x16_bf16 v[224:239], v[60:63], v[64:67], v[224:239]
ds_read_b64_tr_b16 v[92:93], v17 offset:12288
ds_read_b64_tr_b16 v[94:95], v17 offset:13312
v_cvt_pk_bf16_f32 v168, v168, v169
v_cvt_pk_bf16_f32 v169, v170, v171
v_cvt_pk_bf16_f32 v170, v172, v173
v_cvt_pk_bf16_f32 v171, v174, v175
buffer_store_dwordx4 v[168:171], v2, s[64:67], s81 offen offset:3072 sc1
v_mfma_f32_32x32x16_bf16 v[240:255], v[60:63], v[68:71], v[240:255]
s_add_u32 s53, s53, 32768
s_cmp_ge_u32 s53, 131072
s_cselect_b32 s53, 0, s53
s_waitcnt lgkmcnt(6)
v_mfma_f32_32x32x16_bf16 v[192:207], v[72:75], v[80:83], v[192:207]
v_add_u32 v16, s53, v26
v_mfma_f32_32x32x16_bf16 v[208:223], v[72:75], v[84:87], v[208:223]
v_xor_b32 v17, 64, v16
v_mfma_f32_32x32x16_bf16 v[224:239], v[76:79], v[80:83], v[224:239]
v_add_u32 v20, s53, v27
v_mfma_f32_32x32x16_bf16 v[240:255], v[76:79], v[84:87], v[240:255]
s_waitcnt lgkmcnt(0)
s_barrier
v_mfma_f32_32x32x16_bf16 v[192:207], v[88:91], v[96:99], v[192:207]
ds_read_b64_tr_b16 v[40:41], v16 offset:0
ds_read_b64_tr_b16 v[42:43], v16 offset:1024
ds_read_b128 v[48:51], v20 offset:0
v_mfma_f32_32x32x16_bf16 v[208:223], v[88:91], v[100:103], v[208:223]
ds_read_b128 v[52:55], v20 offset:512
ds_read_b64_tr_b16 v[44:45], v17 offset:0
ds_read_b64_tr_b16 v[46:47], v17 offset:1024
v_cvt_pk_bf16_f32 v184, v184, v185
v_cvt_pk_bf16_f32 v185, v186, v187
v_cvt_pk_bf16_f32 v186, v188, v189
v_cvt_pk_bf16_f32 v187, v190, v191
v_mfma_f32_32x32x16_bf16 v[224:239], v[92:95], v[96:99], v[224:239]
ds_read_b64_tr_b16 v[56:57], v16 offset:4096
ds_read_b64_tr_b16 v[58:59], v16 offset:5120
ds_read_b128 v[64:67], v20 offset:4096
buffer_store_dwordx4 v[184:187], v2, s[64:67], s82 offen offset:3072 sc1
s_mov_b32 s84, 0
v_mfma_f32_32x32x16_bf16 v[240:255], v[92:95], v[100:103], v[240:255]
ds_read_b128 v[68:71], v20 offset:4608
ds_read_b64_tr_b16 v[60:61], v17 offset:4096
ds_read_b64_tr_b16 v[62:63], v17 offset:5120
s_waitcnt lgkmcnt(6)
v_mfma_f32_32x32x16_bf16 v[192:207], v[40:43], v[48:51], v[192:207]
ds_read_b64_tr_b16 v[72:73], v16 offset:8192
ds_read_b64_tr_b16 v[74:75], v16 offset:9216
v_mfma_f32_32x32x16_bf16 v[208:223], v[40:43], v[52:55], v[208:223]
ds_read_b128 v[80:83], v20 offset:8192
ds_read_b128 v[84:87], v20 offset:8704
v_mfma_f32_32x32x16_bf16 v[224:239], v[44:47], v[48:51], v[224:239]
ds_read_b64_tr_b16 v[76:77], v17 offset:8192
ds_read_b64_tr_b16 v[78:79], v17 offset:9216
v_mfma_f32_32x32x16_bf16 v[240:255], v[44:47], v[52:55], v[240:255]
s_waitcnt lgkmcnt(6)
v_mfma_f32_32x32x16_bf16 v[192:207], v[56:59], v[64:67], v[192:207]
ds_read_b64_tr_b16 v[88:89], v16 offset:12288
ds_read_b64_tr_b16 v[90:91], v16 offset:13312
v_mfma_f32_32x32x16_bf16 v[208:223], v[56:59], v[68:71], v[208:223]
ds_read_b128 v[96:99], v20 offset:12288
ds_read_b128 v[100:103], v20 offset:12800
v_mfma_f32_32x32x16_bf16 v[224:239], v[60:63], v[64:67], v[224:239]
ds_read_b64_tr_b16 v[92:93], v17 offset:12288
ds_read_b64_tr_b16 v[94:95], v17 offset:13312
v_mfma_f32_32x32x16_bf16 v[240:255], v[60:63], v[68:71], v[240:255]
s_add_u32 s53, s53, 32768
s_cmp_ge_u32 s53, 131072
s_cselect_b32 s53, 0, s53
s_waitcnt lgkmcnt(6)
v_mfma_f32_32x32x16_bf16 v[192:207], v[72:75], v[80:83], v[192:207]
v_add_u32 v16, s53, v26
v_mfma_f32_32x32x16_bf16 v[208:223], v[72:75], v[84:87], v[208:223]
v_xor_b32 v17, 64, v16
v_mfma_f32_32x32x16_bf16 v[224:239], v[76:79], v[80:83], v[224:239]
v_add_u32 v20, s53, v27
v_mfma_f32_32x32x16_bf16 v[240:255], v[76:79], v[84:87], v[240:255]
s_waitcnt lgkmcnt(0)
s_barrier
v_mfma_f32_32x32x16_bf16 v[192:207], v[88:91], v[96:99], v[192:207]
ds_read_b64_tr_b16 v[40:41], v16 offset:0
ds_read_b64_tr_b16 v[42:43], v16 offset:1024
ds_read_b128 v[48:51], v20 offset:0
v_mfma_f32_32x32x16_bf16 v[208:223], v[88:91], v[100:103], v[208:223]
ds_read_b128 v[52:55], v20 offset:512
ds_read_b64_tr_b16 v[44:45], v17 offset:0
ds_read_b64_tr_b16 v[46:47], v17 offset:1024
v_mfma_f32_32x32x16_bf16 v[224:239], v[92:95], v[96:99], v[224:239]
ds_read_b64_tr_b16 v[56:57], v16 offset:4096
ds_read_b64_tr_b16 v[58:59], v16 offset:5120
ds_read_b128 v[64:67], v20 offset:4096
s_getreg_b32 s51, hwreg(HW_REG_IB_STS)
s_and_b32 s51, s51, 0xc0000f
s_or_b32 s51, s51, s84
s_cbranch_scc1 Lf_8
v_mov_b32 v36, 0
v_mov_b32 v3, 1
s_mov_b64 exec, 1
buffer_store_dword v3, v36, s[60:63], s76 offen sc1
s_mov_b64 exec, -1
s_mov_b32 s84, 1
Lf_8:
v_mfma_f32_32x32x16_bf16 v[240:255], v[92:95], v[100:103], v[240:255]
ds_read_b128 v[68:71], v20 offset:4608
ds_read_b64_tr_b16 v[60:61], v17 offset:4096
ds_read_b64_tr_b16 v[62:63], v17 offset:5120
s_waitcnt lgkmcnt(6)
v_mfma_f32_32x32x16_bf16 v[192:207], v[40:43], v[48:51], v[192:207]
ds_read_b64_tr_b16 v[72:73], v16 offset:8192
ds_read_b64_tr_b16 v[74:75], v16 offset:9216
v_mfma_f32_32x32x16_bf16 v[208:223], v[40:43], v[52:55], v[208:223]
ds_read_b128 v[80:83], v20 offset:8192
ds_read_b128 v[84:87], v20 offset:8704
v_mfma_f32_32x32x16_bf16 v[224:239], v[44:47], v[48:51], v[224:239]
ds_read_b64_tr_b16 v[76:77], v17 offset:8192
ds_read_b64_tr_b16 v[78:79], v17 offset:9216
v_mfma_f32_32x32x16_bf16 v[240:255], v[44:47], v[52:55], v[240:255]
s_waitcnt lgkmcnt(6)
v_mfma_f32_32x32x16_bf16 v[192:207], v[56:59], v[64:67], v[192:207]
ds_read_b64_tr_b16 v[88:89], v16 offset:12288
ds_read_b64_tr_b16 v[90:91], v16 offset:13312
v_mfma_f32_32x32x16_bf16 v[208:223], v[56:59], v[68:71], v[208:223]
ds_read_b128 v[96:99], v20 offset:12288
ds_read_b128 v[100:103], v20 offset:12800
v_mfma_f32_32x32x16_bf16 v[224:239], v[60:63], v[64:67], v[224:239]
ds_read_b64_tr_b16 v[92:93], v17 offset:12288
ds_read_b64_tr_b16 v[94:95], v17 offset:13312
v_mfma_f32_32x32x16_bf16 v[240:255], v[60:63], v[68:71], v[240:255]
s_add_u32 s53, s53, 32768
s_cmp_ge_u32 s53, 131072
s_cselect_b32 s53, 0, s53
s_waitcnt lgkmcnt(6)
v_mfma_f32_32x32x16_bf16 v[192:207], v[72:75], v[80:83], v[192:207]
v_add_u32 v16, s53, v26
v_mfma_f32_32x32x16_bf16 v[208:223], v[72:75], v[84:87], v[208:223]
v_xor_b32 v17, 64, v16
v_mfma_f32_32x32x16_bf16 v[224:239], v[76:79], v[80:83], v[224:239]
v_add_u32 v20, s53, v27
v_mfma_f32_32x32x16_bf16 v[240:255], v[76:79], v[84:87], v[240:255]
s_waitcnt lgkmcnt(0)
s_barrier
v_mfma_f32_32x32x16_bf16 v[192:207], v[88:91], v[96:99], v[192:207]
ds_read_b64_tr_b16 v[40:41], v16 offset:0
ds_read_b64_tr_b16 v[42:43], v16 offset:1024
ds_read_b128 v[48:51], v20 offset:0
v_mfma_f32_32x32x16_bf16 v[208:223], v[88:91], v[100:103], v[208:223]
ds_read_b128 v[52:55], v20 offset:512
ds_read_b64_tr_b16 v[44:45], v17 offset:0
ds_read_b64_tr_b16 v[46:47], v17 offset:1024
v_mfma_f32_32x32x16_bf16 v[224:239], v[92:95], v[96:99], v[224:239]
ds_read_b64_tr_b16 v[56:57], v16 offset:4096
ds_read_b64_tr_b16 v[58:59], v16 offset:5120
ds_read_b128 v[64:67], v20 offset:4096
s_getreg_b32 s51, hwreg(HW_REG_IB_STS)
s_and_b32 s51, s51, 0xc0000f
s_or_b32 s51, s51, s84
s_cbranch_scc1 Lf_9
v_mov_b32 v36, 0
v_mov_b32 v3, 1
s_mov_b64 exec, 1
buffer_store_dword v3, v36, s[60:63], s76 offen sc1
s_mov_b64 exec, -1
s_mov_b32 s84, 1
Lf_9:
v_mfma_f32_32x32x16_bf16 v[240:255], v[92:95], v[100:103], v[240:255]
ds_read_b128 v[68:71], v20 offset:4608
ds_read_b64_tr_b16 v[60:61], v17 offset:4096
ds_read_b64_tr_b16 v[62:63], v17 offset:5120
s_waitcnt lgkmcnt(6)
v_mfma_f32_32x32x16_bf16 v[192:207], v[40:43], v[48:51], v[192:207]
ds_read_b64_tr_b16 v[72:73], v16 offset:8192
ds_read_b64_tr_b16 v[74:75], v16 offset:9216
v_mfma_f32_32x32x16_bf16 v[208:223], v[40:43], v[52:55], v[208:223]
ds_read_b128 v[80:83], v20 offset:8192
ds_read_b128 v[84:87], v20 offset:8704
v_mfma_f32_32x32x16_bf16 v[224:239], v[44:47], v[48:51], v[224:239]
ds_read_b64_tr_b16 v[76:77], v17 offset:8192
ds_read_b64_tr_b16 v[78:79], v17 offset:9216
v_mfma_f32_32x32x16_bf16 v[240:255], v[44:47], v[52:55], v[240:255]
s_waitcnt lgkmcnt(6)
v_mfma_f32_32x32x16_bf16 v[192:207], v[56:59], v[64:67], v[192:207]
ds_read_b64_tr_b16 v[88:89], v16 offset:12288
ds_read_b64_tr_b16 v[90:91], v16 offset:13312
v_mfma_f32_32x32x16_bf16 v[208:223], v[56:59], v[68:71], v[208:223]
ds_read_b128 v[96:99], v20 offset:12288
ds_read_b128 v[100:103], v20 offset:12800
v_mfma_f32_32x32x16_bf16 v[224:239], v[60:63], v[64:67], v[224:239]
ds_read_b64_tr_b16 v[92:93], v17 offset:12288
ds_read_b64_tr_b16 v[94:95], v17 offset:13312
v_mfma_f32_32x32x16_bf16 v[240:255], v[60:63], v[68:71], v[240:255]
s_add_u32 s53, s53, 32768
s_cmp_ge_u32 s53, 131072
s_cselect_b32 s53, 0, s53
s_waitcnt lgkmcnt(6)
v_mfma_f32_32x32x16_bf16 v[192:207], v[72:75], v[80:83], v[192:207]
v_add_u32 v16, s53, v26
v_mfma_f32_32x32x16_bf16 v[208:223], v[72:75], v[84:87], v[208:223]
v_xor_b32 v17, 64, v16
v_mfma_f32_32x32x16_bf16 v[224:239], v[76:79], v[80:83], v[224:239]
v_add_u32 v20, s53, v27
v_mfma_f32_32x32x16_bf16 v[240:255], v[76:79], v[84:87], v[240:255]
s_waitcnt lgkmcnt(0)
s_barrier
v_mfma_f32_32x32x16_bf16 v[192:207], v[88:91], v[96:99], v[192:207]
ds_read_b64_tr_b16 v[40:41], v16 offset:0
ds_read_b64_tr_b16 v[42:43], v16 offset:1024
ds_read_b128 v[48:51], v20 offset:0
v_mfma_f32_32x32x16_bf16 v[208:223], v[88:91], v[100:103], v[208:223]
ds_read_b128 v[52:55], v20 offset:512
ds_read_b64_tr_b16 v[44:45], v17 offset:0
ds_read_b64_tr_b16 v[46:47], v17 offset:1024
v_mfma_f32_32x32x16_bf16 v[224:239], v[92:95], v[96:99], v[224:239]
ds_read_b64_tr_b16 v[56:57], v16 offset:4096
ds_read_b64_tr_b16 v[58:59], v16 offset:5120
ds_read_b128 v[64:67], v20 offset:4096
s_getreg_b32 s51, hwreg(HW_REG_IB_STS)
s_and_b32 s51, s51, 0xc0000f
s_or_b32 s51, s51, s84
s_cbranch_scc1 Lf_10
v_mov_b32 v36, 0
v_mov_b32 v3, 1
s_mov_b64 exec, 1
buffer_store_dword v3, v36, s[60:63], s76 offen sc1
s_mov_b64 exec, -1
s_mov_b32 s84, 1
Lf_10:
v_mfma_f32_32x32x16_bf16 v[240:255], v[92:95], v[100:103], v[240:255]
ds_read_b128 v[68:71], v20 offset:4608
ds_read_b64_tr_b16 v[60:61], v17 offset:4096
ds_read_b64_tr_b16 v[62:63], v17 offset:5120
s_waitcnt lgkmcnt(6)
v_mfma_f32_32x32x16_bf16 v[192:207], v[40:43], v[48:51], v[192:207]
ds_read_b64_tr_b16 v[72:73], v16 offset:8192
ds_read_b64_tr_b16 v[74:75], v16 offset:9216
v_mfma_f32_32x32x16_bf16 v[208:223], v[40:43], v[52:55], v[208:223]
ds_read_b128 v[80:83], v20 offset:8192
ds_read_b128 v[84:87], v20 offset:8704
v_mfma_f32_32x32x16_bf16 v[224:239], v[44:47], v[48:51], v[224:239]
ds_read_b64_tr_b16 v[76:77], v17 offset:8192
ds_read_b64_tr_b16 v[78:79], v17 offset:9216
v_mfma_f32_32x32x16_bf16 v[240:255], v[44:47], v[52:55], v[240:255]
s_waitcnt lgkmcnt(6)
v_mfma_f32_32x32x16_bf16 v[192:207], v[56:59], v[64:67], v[192:207]
ds_read_b64_tr_b16 v[88:89], v16 offset:12288
ds_read_b64_tr_b16 v[90:91], v16 offset:13312
v_mfma_f32_32x32x16_bf16 v[208:223], v[56:59], v[68:71], v[208:223]
ds_read_b128 v[96:99], v20 offset:12288
ds_read_b128 v[100:103], v20 offset:12800
v_mfma_f32_32x32x16_bf16 v[224:239], v[60:63], v[64:67], v[224:239]
ds_read_b64_tr_b16 v[92:93], v17 offset:12288
ds_read_b64_tr_b16 v[94:95], v17 offset:13312
v_mfma_f32_32x32x16_bf16 v[240:255], v[60:63], v[68:71], v[240:255]
s_add_u32 s53, s53, 32768
s_cmp_ge_u32 s53, 131072
s_cselect_b32 s53, 0, s53
s_waitcnt lgkmcnt(6)
v_mfma_f32_32x32x16_bf16 v[192:207], v[72:75], v[80:83], v[192:207]
v_add_u32 v16, s53, v26
v_mfma_f32_32x32x16_bf16 v[208:223], v[72:75], v[84:87], v[208:223]
v_xor_b32 v17, 64, v16
v_mfma_f32_32x32x16_bf16 v[224:239], v[76:79], v[80:83], v[224:239]
v_add_u32 v20, s53, v27
v_mfma_f32_32x32x16_bf16 v[240:255], v[76:79], v[84:87], v[240:255]
s_waitcnt lgkmcnt(0)
s_barrier
v_mfma_f32_32x32x16_bf16 v[192:207], v[88:91], v[96:99], v[192:207]
ds_read_b64_tr_b16 v[40:41], v16 offset:0
ds_read_b64_tr_b16 v[42:43], v16 offset:1024
ds_read_b128 v[48:51], v20 offset:0
v_mfma_f32_32x32x16_bf16 v[208:223], v[88:91], v[100:103], v[208:223]
ds_read_b128 v[52:55], v20 offset:512
ds_read_b64_tr_b16 v[44:45], v17 offset:0
ds_read_b64_tr_b16 v[46:47], v17 offset:1024
v_mfma_f32_32x32x16_bf16 v[224:239], v[92:95], v[96:99], v[224:239]
ds_read_b64_tr_b16 v[56:57], v16 offset:4096
ds_read_b64_tr_b16 v[58:59], v16 offset:5120
ds_read_b128 v[64:67], v20 offset:4096
s_cmp_lg_u32 s84, 0
s_cbranch_scc1 Lf_11
s_waitcnt vmcnt(0)
v_mov_b32 v36, 0
v_mov_b32 v3, 1
s_mov_b64 exec, 1
buffer_store_dword v3, v36, s[60:63], s76 offen sc1
s_mov_b64 exec, -1
s_mov_b32 s84, 1
Lf_11:
v_mfma_f32_32x32x16_bf16 v[240:255], v[92:95], v[100:103], v[240:255]
ds_read_b128 v[68:71], v20 offset:4608
ds_read_b64_tr_b16 v[60:61], v17 offset:4096
ds_read_b64_tr_b16 v[62:63], v17 offset:5120
s_mov_b32 s92, s28
s_mov_b32 s93, s29
s_mov_b32 s94, 0xe00000
s_mov_b32 s95, 0x20000
s_waitcnt lgkmcnt(6)
v_mfma_f32_32x32x16_bf16 v[192:207], v[40:43], v[48:51], v[192:207]
ds_read_b64_tr_b16 v[72:73], v16 offset:8192
ds_read_b64_tr_b16 v[74:75], v16 offset:9216
s_lshl_b32 s85, s2, 2
s_add_u32 s85, s85, s3
s_lshl_b32 s85, s85, 10
v_mfma_f32_32x32x16_bf16 v[208:223], v[40:43], v[52:55], v[208:223]
ds_read_b128 v[80:83], v20 offset:8192
ds_read_b128 v[84:87], v20 offset:8704
v_mfma_f32_32x32x16_bf16 v[224:239], v[44:47], v[48:51], v[224:239]
ds_read_b64_tr_b16 v[76:77], v17 offset:8192
ds_read_b64_tr_b16 v[78:79], v17 offset:9216
v_mfma_f32_32x32x16_bf16 v[240:255], v[44:47], v[52:55], v[240:255]
s_waitcnt lgkmcnt(6)
v_mfma_f32_32x32x16_bf16 v[192:207], v[56:59], v[64:67], v[192:207]
ds_read_b64_tr_b16 v[88:89], v16 offset:12288
ds_read_b64_tr_b16 v[90:91], v16 offset:13312
v_mfma_f32_32x32x16_bf16 v[208:223], v[56:59], v[68:71], v[208:223]
ds_read_b128 v[96:99], v20 offset:12288
ds_read_b128 v[100:103], v20 offset:12800
v_mfma_f32_32x32x16_bf16 v[224:239], v[60:63], v[64:67], v[224:239]
ds_read_b64_tr_b16 v[92:93], v17 offset:12288
ds_read_b64_tr_b16 v[94:95], v17 offset:13312
v_mfma_f32_32x32x16_bf16 v[240:255], v[60:63], v[68:71], v[240:255]
s_add_u32 s53, s53, 32768
s_cmp_ge_u32 s53, 131072
s_cselect_b32 s53, 0, s53
s_waitcnt lgkmcnt(6)
v_mfma_f32_32x32x16_bf16 v[192:207], v[72:75], v[80:83], v[192:207]
v_add_u32 v16, s53, v26
v_mfma_f32_32x32x16_bf16 v[208:223], v[72:75], v[84:87], v[208:223]
v_xor_b32 v17, 64, v16
v_mfma_f32_32x32x16_bf16 v[224:239], v[76:79], v[80:83], v[224:239]
v_add_u32 v20, s53, v27
v_mfma_f32_32x32x16_bf16 v[240:255], v[76:79], v[84:87], v[240:255]
s_waitcnt lgkmcnt(0)
s_barrier
v_mfma_f32_32x32x16_bf16 v[192:207], v[88:91], v[96:99], v[192:207]
ds_read_b64_tr_b16 v[40:41], v16 offset:0
ds_read_b64_tr_b16 v[42:43], v16 offset:1024
ds_read_b128 v[48:51], v20 offset:0
v_mfma_f32_32x32x16_bf16 v[208:223], v[88:91], v[100:103], v[208:223]
ds_read_b128 v[52:55], v20 offset:512
ds_read_b64_tr_b16 v[44:45], v17 offset:0
ds_read_b64_tr_b16 v[46:47], v17 offset:1024
v_mfma_f32_32x32x16_bf16 v[224:239], v[92:95], v[96:99], v[224:239]
ds_read_b64_tr_b16 v[56:57], v16 offset:4096
ds_read_b64_tr_b16 v[58:59], v16 offset:5120
ds_read_b128 v[64:67], v20 offset:4096
v_mfma_f32_32x32x16_bf16 v[240:255], v[92:95], v[100:103], v[240:255]
ds_read_b128 v[68:71], v20 offset:4608
ds_read_b64_tr_b16 v[60:61], v17 offset:4096
ds_read_b64_tr_b16 v[62:63], v17 offset:5120
s_mov_b32 s52, 5
.p2align 5
Lg_12:
s_waitcnt lgkmcnt(6)
v_mfma_f32_32x32x16_bf16 v[192:207], v[40:43], v[48:51], v[192:207]
ds_read_b64_tr_b16 v[72:73], v16 offset:8192
ds_read_b64_tr_b16 v[74:75], v16 offset:9216
v_mfma_f32_32x32x16_bf16 v[208:223], v[40:43], v[52:55], v[208:223]
ds_read_b128 v[80:83], v20 offset:8192
ds_read_b128 v[84:87], v20 offset:8704
v_mfma_f32_32x32x16_bf16 v[224:239], v[44:47], v[48:51], v[224:239]
ds_read_b64_tr_b16 v[76:77], v17 offset:8192
ds_read_b64_tr_b16 v[78:79], v17 offset:9216
v_mfma_f32_32x32x16_bf16 v[240:255], v[44:47], v[52:55], v[240:255]
s_waitcnt lgkmcnt(6)
v_mfma_f32_32x32x16_bf16 v[192:207], v[56:59], v[64:67], v[192:207]
ds_read_b64_tr_b16 v[88:89], v16 offset:12288
ds_read_b64_tr_b16 v[90:91], v16 offset:13312
v_mfma_f32_32x32x16_bf16 v[208:223], v[56:59], v[68:71], v[208:223]
ds_read_b128 v[96:99], v20 offset:12288
ds_read_b128 v[100:103], v20 offset:12800
v_mfma_f32_32x32x16_bf16 v[224:239], v[60:63], v[64:67], v[224:239]
ds_read_b64_tr_b16 v[92:93], v17 offset:12288
ds_read_b64_tr_b16 v[94:95], v17 offset:13312
v_mfma_f32_32x32x16_bf16 v[240:255], v[60:63], v[68:71], v[240:255]
s_add_u32 s53, s53, 32768
s_cmp_ge_u32 s53, 131072
s_cselect_b32 s53, 0, s53
s_waitcnt lgkmcnt(6)
v_mfma_f32_32x32x16_bf16 v[192:207], v[72:75], v[80:83], v[192:207]
v_add_u32 v16, s53, v26
v_mfma_f32_32x32x16_bf16 v[208:223], v[72:75], v[84:87], v[208:223]
v_xor_b32 v17, 64, v16
v_mfma_f32_32x32x16_bf16 v[224:239], v[76:79], v[80:83], v[224:239]
v_add_u32 v20, s53, v27
v_mfma_f32_32x32x16_bf16 v[240:255], v[76:79], v[84:87], v[240:255]
s_waitcnt lgkmcnt(0)
s_barrier
v_mfma_f32_32x32x16_bf16 v[192:207], v[88:91], v[96:99], v[192:207]
ds_read_b64_tr_b16 v[40:41], v16 offset:0
ds_read_b64_tr_b16 v[42:43], v16 offset:1024
ds_read_b128 v[48:51], v20 offset:0
v_mfma_f32_32x32x16_bf16 v[208:223], v[88:91], v[100:103], v[208:223]
ds_read_b128 v[52:55], v20 offset:512
ds_read_b64_tr_b16 v[44:45], v17 offset:0
ds_read_b64_tr_b16 v[46:47], v17 offset:1024
v_mfma_f32_32x32x16_bf16 v[224:239], v[92:95], v[96:99], v[224:239]
ds_read_b64_tr_b16 v[56:57], v16 offset:4096
ds_read_b64_tr_b16 v[58:59], v16 offset:5120
ds_read_b128 v[64:67], v20 offset:4096
v_mfma_f32_32x32x16_bf16 v[240:255], v[92:95], v[100:103], v[240:255]
ds_read_b128 v[68:71], v20 offset:4608
ds_read_b64_tr_b16 v[60:61], v17 offset:4096
ds_read_b64_tr_b16 v[62:63], v17 offset:5120
s_sub_u32 s52, s52, 1
s_cmp_lg_u32 s52, 0
s_cbranch_scc1 Lg_12
s_waitcnt lgkmcnt(6)
v_mfma_f32_32x32x16_bf16 v[192:207], v[40:43], v[48:51], v[192:207]
ds_read_b64_tr_b16 v[72:73], v16 offset:8192
ds_read_b64_tr_b16 v[74:75], v16 offset:9216
v_mfma_f32_32x32x16_bf16 v[208:223], v[40:43], v[52:55], v[208:223]
ds_read_b128 v[80:83], v20 offset:8192
ds_read_b128 v[84:87], v20 offset:8704
v_mfma_f32_32x32x16_bf16 v[224:239], v[44:47], v[48:51], v[224:239]
ds_read_b64_tr_b16 v[76:77], v17 offset:8192
ds_read_b64_tr_b16 v[78:79], v17 offset:9216
v_mfma_f32_32x32x16_bf16 v[240:255], v[44:47], v[52:55], v[240:255]
s_waitcnt lgkmcnt(6)
v_mfma_f32_32x32x16_bf16 v[192:207], v[56:59], v[64:67], v[192:207]
ds_read_b64_tr_b16 v[88:89], v16 offset:12288
ds_read_b64_tr_b16 v[90:91], v16 offset:13312
v_mfma_f32_32x32x16_bf16 v[208:223], v[56:59], v[68:71], v[208:223]
ds_read_b128 v[96:99], v20 offset:12288
ds_read_b128 v[100:103], v20 offset:12800
v_mfma_f32_32x32x16_bf16 v[224:239], v[60:63], v[64:67], v[224:239]
ds_read_b64_tr_b16 v[92:93], v17 offset:12288
ds_read_b64_tr_b16 v[94:95], v17 offset:13312
v_mfma_f32_32x32x16_bf16 v[240:255], v[60:63], v[68:71], v[240:255]
s_add_u32 s53, s53, 32768
s_cmp_ge_u32 s53, 131072
s_cselect_b32 s53, 0, s53
s_waitcnt lgkmcnt(6)
v_mfma_f32_32x32x16_bf16 v[192:207], v[72:75], v[80:83], v[192:207]
v_add_u32 v16, s53, v24
v_xor_b32 v17, 0x40, v16
v_mfma_f32_32x32x16_bf16 v[208:223], v[72:75], v[84:87], v[208:223]
v_add_u32 v20, s53, v28
v_xor_b32 v21, 0x40, v20
v_mfma_f32_32x32x16_bf16 v[224:239], v[76:79], v[80:83], v[224:239]
v_xor_b32 v22, 0x80, v20
v_xor_b32 v23, 0xc0, v20
v_mfma_f32_32x32x16_bf16 v[240:255], v[76:79], v[84:87], v[240:255]
s_waitcnt lgkmcnt(0)
s_barrier
v_mfma_f32_32x32x16_bf16 v[192:207], v[88:91], v[96:99], v[192:207]
ds_read_b64_tr_b16 v[40:41], v20 offset:0
ds_read_b64_tr_b16 v[42:43], v21 offset:0
ds_read_b64_tr_b16 v[44:45], v22 offset:2048
v_mfma_f32_32x32x16_bf16 v[208:223], v[88:91], v[100:103], v[208:223]
ds_read_b64_tr_b16 v[46:47], v23 offset:2048
ds_read_b128 v[72:75], v16 offset:0
ds_read_b64_tr_b16 v[48:49], v20 offset:4096
v_mfma_f32_32x32x16_bf16 v[224:239], v[92:95], v[96:99], v[224:239]
ds_read_b64_tr_b16 v[50:51], v21 offset:4096
ds_read_b64_tr_b16 v[52:53], v22 offset:6144
ds_read_b64_tr_b16 v[54:55], v23 offset:6144
v_mfma_f32_32x32x16_bf16 v[240:255], v[92:95], v[100:103], v[240:255]
ds_read_b128 v[76:79], v16 offset:1024
ds_read_b128 v[80:83], v16 offset:2048
s_waitcnt lgkmcnt(6)
v_mfma_f32_16x16x32_bf16 v[128:131], v[72:75], v[40:43], 0
ds_read_b128 v[84:87], v16 offset:3072
s_lshl_b32 s51, s3, 12
s_add_u32 s51, s51, 0x8000
v_add_u32 v3, s51, v6
v_mfma_f32_16x16x32_bf16 v[132:135], v[72:75], v[44:47], 0
v_cvt_pk_bf16_f32 v88, v192, v193
v_cvt_pk_bf16_f32 v89, v194, v195
s_waitcnt lgkmcnt(5)
v_mfma_f32_16x16x32_bf16 v[136:139], v[72:75], v[48:51], 0
ds_read_b64_tr_b16 v[56:57], v20 offset:512
v_cvt_pk_bf16_f32 v90, v196, v197
v_cvt_pk_bf16_f32 v91, v198, v199
s_waitcnt lgkmcnt(4)
v_mfma_f32_16x16x32_bf16 v[140:143], v[72:75], v[52:55], 0
v_cvt_pk_bf16_f32 v104, v200, v201
v_cvt_pk_bf16_f32 v105, v202, v203
s_waitcnt lgkmcnt(3)
v_mfma_f32_16x16x32_bf16 v[156:159], v[76:79], v[52:55], 0
ds_read_b128 v[72:75], v16 offset:16384
v_cvt_pk_bf16_f32 v106, v204, v205
v_cvt_pk_bf16_f32 v107, v206, v207
v_mfma_f32_16x16x32_bf16 v[152:155], v[76:79], v[48:51], 0
ds_read_b64_tr_b16 v[58:59], v21 offset:512
v_cvt_pk_bf16_f32 v92, v208, v209
v_cvt_pk_bf16_f32 v93, v210, v211
v_mfma_f32_16x16x32_bf16 v[148:151], v[76:79], v[44:47], 0
v_cvt_pk_bf16_f32 v94, v212, v213
v_cvt_pk_bf16_f32 v95, v214, v215
v_mfma_f32_16x16x32_bf16 v[144:147], v[76:79], v[40:43], 0
ds_read_b64_tr_b16 v[60:61], v22 offset:2560
v_cvt_pk_bf16_f32 v108, v216, v217
v_cvt_pk_bf16_f32 v109, v218, v219
s_waitcnt lgkmcnt(5)
v_mfma_f32_16x16x32_bf16 v[160:163], v[80:83], v[40:43], 0
ds_read_b128 v[76:79], v16 offset:17408
v_cvt_pk_bf16_f32 v110, v220, v221
v_cvt_pk_bf16_f32 v111, v222, v223
v_mfma_f32_16x16x32_bf16 v[164:167], v[80:83], v[44:47], 0
v_cvt_pk_bf16_f32 v96, v224, v225
v_cvt_pk_bf16_f32 v97, v226, v227
v_mfma_f32_16x16x32_bf16 v[168:171], v[80:83], v[48:51], 0
ds_read_b64_tr_b16 v[62:63], v23 offset:2560
v_cvt_pk_bf16_f32 v98, v228, v229
v_cvt_pk_bf16_f32 v99, v230, v231
v_mfma_f32_16x16x32_bf16 v[172:175], v[80:83], v[52:55], 0
v_cvt_pk_bf16_f32 v112, v232, v233
v_cvt_pk_bf16_f32 v113, v234, v235
s_waitcnt lgkmcnt(6)
v_mfma_f32_16x16x32_bf16 v[188:191], v[84:87], v[52:55], 0
ds_read_b128 v[80:83], v16 offset:18432
v_cvt_pk_bf16_f32 v114, v236, v237
v_cvt_pk_bf16_f32 v115, v238, v239
v_mfma_f32_16x16x32_bf16 v[184:187], v[84:87], v[48:51], 0
ds_read_b64_tr_b16 v[64:65], v20 offset:4608
v_cvt_pk_bf16_f32 v100, v240, v241
v_cvt_pk_bf16_f32 v101, v242, v243
v_mfma_f32_16x16x32_bf16 v[180:183], v[84:87], v[44:47], 0
v_cvt_pk_bf16_f32 v102, v244, v245
v_cvt_pk_bf16_f32 v103, v246, v247
v_mfma_f32_16x16x32_bf16 v[176:179], v[84:87], v[40:43], 0
ds_read_b64_tr_b16 v[66:67], v21 offset:4608
v_cvt_pk_bf16_f32 v116, v248, v249
v_cvt_pk_bf16_f32 v117, v250, v251
s_waitcnt lgkmcnt(7)
v_mfma_f32_16x16x32_bf16 v[192:195], v[72:75], v[40:43], 0
ds_read_b128 v[84:87], v16 offset:19456
v_cvt_pk_bf16_f32 v118, v252, v253
v_cvt_pk_bf16_f32 v119, v254, v255
v_mfma_f32_16x16x32_bf16 v[196:199], v[72:75], v[44:47], 0
ds_write_b128 v3, v[104:107] offset:0
ds_write_b128 v3, v[108:111] offset:1024
v_mfma_f32_16x16x32_bf16 v[200:203], v[72:75], v[48:51], 0
ds_read_b64_tr_b16 v[68:69], v22 offset:6656
ds_write_b128 v3, v[112:115] offset:2048
v_mfma_f32_16x16x32_bf16 v[204:207], v[72:75], v[52:55], 0
ds_write_b128 v3, v[116:119] offset:3072
s_waitcnt lgkmcnt(6)
v_mfma_f32_16x16x32_bf16 v[220:223], v[76:79], v[52:55], 0
ds_read_b128 v[72:75], v17 offset:0
s_mov_b32 s82, 0xbdd2d3e8
v_mov_b32 v34, 0xc0135761
v_mov_b32 v35, 0xffff0000
v_mfma_f32_16x16x32_bf16 v[216:219], v[76:79], v[48:51], 0
ds_read_b64_tr_b16 v[70:71], v23 offset:6656
v_and_b32 v2, 31, v1
v_lshrrev_b32 v3, 5, v1
v_lshlrev_b32 v3, 10, v3
v_mfma_f32_16x16x32_bf16 v[212:215], v[76:79], v[44:47], 0
v_add_u32 v2, v2, v3
v_lshlrev_b32 v2, 4, v2
v_mfma_f32_16x16x32_bf16 v[208:211], v[76:79], v[40:43], 0
s_lshl_b32 s51, s44, 1
s_add_u32 s51, s51, s22
s_lshl_b32 s51, s51, 13
s_lshl_b32 s50, s43, 1
s_add_u32 s50, s50, s23
s_lshl_b32 s50, s50, 6
s_add_u32 s51, s51, s50
s_lshl_b32 s81, s51, 4
s_waitcnt lgkmcnt(6)
v_mfma_f32_16x16x32_bf16 v[224:227], v[80:83], v[40:43], 0
ds_read_b128 v[76:79], v17 offset:1024
v_mfma_f32_16x16x32_bf16 v[228:231], v[80:83], v[44:47], 0
v_mfma_f32_16x16x32_bf16 v[232:235], v[80:83], v[48:51], 0
ds_read_b128 v[8:11], v17 offset:17408
v_mfma_f32_16x16x32_bf16 v[236:239], v[80:83], v[52:55], 0
s_waitcnt lgkmcnt(5)
v_mfma_f32_16x16x32_bf16 v[252:255], v[84:87], v[52:55], 0
ds_read_b128 v[80:83], v17 offset:2048
v_mfma_f32_16x16x32_bf16 v[248:251], v[84:87], v[48:51], 0
v_mfma_f32_16x16x32_bf16 v[244:247], v[84:87], v[44:47], 0
ds_read_b128 v[12:15], v17 offset:18432
v_mfma_f32_16x16x32_bf16 v[240:243], v[84:87], v[40:43], 0
s_waitcnt lgkmcnt(5)
v_mfma_f32_16x16x32_bf16 v[128:131], v[72:75], v[56:59], v[128:131]
ds_read_b128 v[84:87], v17 offset:3072
v_mfma_f32_16x16x32_bf16 v[132:135], v[72:75], v[60:63], v[132:135]
v_mfma_f32_16x16x32_bf16 v[136:139], v[72:75], v[64:67], v[136:139]
ds_read_b128 v[30:33], v17 offset:19456
s_waitcnt lgkmcnt(6)
v_mfma_f32_16x16x32_bf16 v[140:143], v[72:75], v[68:71], v[140:143]
s_waitcnt lgkmcnt(5)
v_mfma_f32_16x16x32_bf16 v[156:159], v[76:79], v[68:71], v[156:159]
ds_read_b128 v[72:75], v17 offset:16384
v_mfma_f32_16x16x32_bf16 v[152:155], v[76:79], v[64:67], v[152:155]
v_mfma_f32_16x16x32_bf16 v[148:151], v[76:79], v[60:63], v[148:151]
s_add_u32 s53, s53, 49152
s_cmp_ge_u32 s53, 147456
s_cselect_b32 s53, 0, s53
v_mfma_f32_16x16x32_bf16 v[144:147], v[76:79], v[56:59], v[144:147]
v_add_u32 v16, s53, v24
s_waitcnt lgkmcnt(4)
v_mfma_f32_16x16x32_bf16 v[160:163], v[80:83], v[56:59], v[160:163]
v_xor_b32 v17, 0x40, v16
v_mfma_f32_16x16x32_bf16 v[164:167], v[80:83], v[60:63], v[164:167]
v_add_u32 v20, 0x1c000, v28
v_mfma_f32_16x16x32_bf16 v[168:171], v[80:83], v[64:67], v[168:171]
v_xor_b32 v21, 0x40, v20
v_mfma_f32_16x16x32_bf16 v[172:175], v[80:83], v[68:71], v[172:175]
v_xor_b32 v22, 0x80, v20
v_lshlrev_b32 v104, 16, v120
v_and_b32 v105, v35, v120
v_lshlrev_b32 v106, 16, v121
s_waitcnt lgkmcnt(2)
v_mfma_f32_16x16x32_bf16 v[188:191], v[84:87], v[68:71], v[188:191]
v_xor_b32 v23, 0xc0, v20
v_and_b32 v107, v35, v121
v_lshlrev_b32 v108, 16, v122
v_and_b32 v109, v35, v122
v_mfma_f32_16x16x32_bf16 v[184:187], v[84:87], v[64:67], v[184:187]
v_lshlrev_b32 v110, 16, v123
v_and_b32 v111, v35, v123
v_lshlrev_b32 v112, 16, v88
v_and_b32 v113, v35, v88
v_mfma_f32_16x16x32_bf16 v[180:183], v[84:87], v[60:63], v[180:183]
v_lshlrev_b32 v116, 16, v89
v_and_b32 v117, v35, v89
v_add_f32 v112, v112, v104
v_add_f32 v113, v113, v105
v_mfma_f32_16x16x32_bf16 v[176:179], v[84:87], v[56:59], v[176:179]
v_add_f32 v116, v116, v106
v_add_f32 v117, v117, v107
v_cvt_pk_bf16_f32 v112, 0, v112
v_cvt_pk_bf16_f32 v113, 0, v113
s_waitcnt lgkmcnt(0)
s_barrier
v_mfma_f32_16x16x32_bf16 v[192:195], v[72:75], v[56:59], v[192:195]
ds_read_b64_tr_b16 v[40:41], v20 offset:0
v_cvt_pk_bf16_f32 v116, 0, v116
v_cvt_pk_bf16_f32 v117, 0, v117
v_mul_f32 v114, v112, v112
v_mfma_f32_16x16x32_bf16 v[196:199], v[72:75], v[60:63], v[196:199]
ds_read_b64_tr_b16 v[42:43], v21 offset:0
v_mul_f32 v115, v113, v113
v_mul_f32 v118, v116, v116
v_mul_f32 v119, v117, v117
v_mfma_f32_16x16x32_bf16 v[200:203], v[72:75], v[64:67], v[200:203]
ds_read_b64_tr_b16 v[44:45], v22 offset:2048
v_fma_f32 v114, v114, s82, v34
v_fma_f32 v115, v115, s82, v34
v_fma_f32 v118, v118, s82, v34
v_mfma_f32_16x16x32_bf16 v[204:207], v[72:75], v[68:71], v[204:207]
ds_read_b64_tr_b16 v[46:47], v23 offset:2048
v_fma_f32 v119, v119, s82, v34
v_mul_f32 v114, v114, v112
v_mul_f32 v115, v115, v113
v_mfma_f32_16x16x32_bf16 v[220:223], v[8:11], v[68:71], v[220:223]
ds_read_b128 v[72:75], v16 offset:0
v_mul_f32 v118, v118, v116
v_mul_f32 v119, v119, v117
v_mfma_f32_16x16x32_bf16 v[216:219], v[8:11], v[64:67], v[216:219]
ds_read_b64_tr_b16 v[48:49], v20 offset:4096
v_exp_f32 v114, v114
v_mfma_f32_16x16x32_bf16 v[212:215], v[8:11], v[60:63], v[212:215]
ds_read_b64_tr_b16 v[50:51], v21 offset:4096
v_exp_f32 v115, v115
v_mfma_f32_16x16x32_bf16 v[208:211], v[8:11], v[56:59], v[208:211]
ds_read_b64_tr_b16 v[52:53], v22 offset:6144
v_exp_f32 v118, v118
v_mfma_f32_16x16x32_bf16 v[224:227], v[12:15], v[56:59], v[224:227]
ds_read_b64_tr_b16 v[54:55], v23 offset:6144
v_exp_f32 v119, v119
v_add_f32 v114, 1.0, v114
v_mfma_f32_16x16x32_bf16 v[228:231], v[12:15], v[60:63], v[228:231]
ds_read_b128 v[76:79], v16 offset:1024
v_add_f32 v115, 1.0, v115
v_add_f32 v118, 1.0, v118
v_add_f32 v119, 1.0, v119
v_mfma_f32_16x16x32_bf16 v[232:235], v[12:15], v[64:67], v[232:235]
ds_read_b128 v[80:83], v16 offset:2048
v_rcp_f32 v114, v114
v_mfma_f32_16x16x32_bf16 v[236:239], v[12:15], v[68:71], v[236:239]
v_rcp_f32 v115, v115
v_rcp_f32 v118, v118
v_mfma_f32_16x16x32_bf16 v[252:255], v[30:33], v[68:71], v[252:255]
v_rcp_f32 v119, v119
v_mul_f32 v112, v112, v114
v_mul_f32 v113, v113, v115
v_mfma_f32_16x16x32_bf16 v[248:251], v[30:33], v[64:67], v[248:251]
v_mul_f32 v116, v116, v118
v_mul_f32 v117, v117, v119
v_cvt_pk_bf16_f32 v88, v112, v113
v_cvt_pk_bf16_f32 v89, v116, v117
v_mfma_f32_16x16x32_bf16 v[244:247], v[30:33], v[60:63], v[244:247]
v_lshlrev_b32 v112, 16, v90
v_and_b32 v113, v35, v90
v_lshlrev_b32 v116, 16, v91
v_and_b32 v117, v35, v91
v_mfma_f32_16x16x32_bf16 v[240:243], v[30:33], v[56:59], v[240:243]
v_add_f32 v112, v112, v108
v_add_f32 v113, v113, v109
v_add_f32 v116, v116, v110
v_add_f32 v117, v117, v111
s_waitcnt lgkmcnt(6)
v_mfma_f32_16x16x32_bf16 v[128:131], v[72:75], v[40:43], v[128:131]
ds_read_b128 v[84:87], v16 offset:3072
v_cvt_pk_bf16_f32 v112, 0, v112
v_cvt_pk_bf16_f32 v113, 0, v113
v_cvt_pk_bf16_f32 v116, 0, v116
v_mfma_f32_16x16x32_bf16 v[132:135], v[72:75], v[44:47], v[132:135]
v_cvt_pk_bf16_f32 v117, 0, v117
v_mul_f32 v114, v112, v112
v_mul_f32 v115, v113, v113
v_mul_f32 v118, v116, v116
s_waitcnt lgkmcnt(5)
v_mfma_f32_16x16x32_bf16 v[136:139], v[72:75], v[48:51], v[136:139]
ds_read_b64_tr_b16 v[56:57], v20 offset:512
v_mul_f32 v119, v117, v117
v_fma_f32 v114, v114, s82, v34
v_fma_f32 v115, v115, s82, v34
s_waitcnt lgkmcnt(4)
v_mfma_f32_16x16x32_bf16 v[140:143], v[72:75], v[52:55], v[140:143]
v_fma_f32 v118, v118, s82, v34
v_fma_f32 v119, v119, s82, v34
v_mul_f32 v114, v114, v112
v_mul_f32 v115, v115, v113
s_waitcnt lgkmcnt(3)
v_mfma_f32_16x16x32_bf16 v[156:159], v[76:79], v[52:55], v[156:159]
ds_read_b128 v[72:75], v16 offset:16384
v_mul_f32 v118, v118, v116
v_mul_f32 v119, v119, v117
v_mfma_f32_16x16x32_bf16 v[152:155], v[76:79], v[48:51], v[152:155]
ds_read_b64_tr_b16 v[58:59], v21 offset:512
v_exp_f32 v114, v114
v_mfma_f32_16x16x32_bf16 v[148:151], v[76:79], v[44:47], v[148:151]
v_exp_f32 v115, v115
v_exp_f32 v118, v118
v_mfma_f32_16x16x32_bf16 v[144:147], v[76:79], v[40:43], v[144:147]
ds_read_b64_tr_b16 v[60:61], v22 offset:2560
v_exp_f32 v119, v119
v_add_f32 v114, 1.0, v114
s_waitcnt lgkmcnt(5)
v_mfma_f32_16x16x32_bf16 v[160:163], v[80:83], v[40:43], v[160:163]
ds_read_b128 v[76:79], v16 offset:17408
v_add_f32 v115, 1.0, v115
v_add_f32 v118, 1.0, v118
v_add_f32 v119, 1.0, v119
v_mfma_f32_16x16x32_bf16 v[164:167], v[80:83], v[44:47], v[164:167]
v_rcp_f32 v114, v114
v_rcp_f32 v115, v115
v_mfma_f32_16x16x32_bf16 v[168:171], v[80:83], v[48:51], v[168:171]
ds_read_b64_tr_b16 v[62:63], v23 offset:2560
v_rcp_f32 v118, v118
v_mfma_f32_16x16x32_bf16 v[172:175], v[80:83], v[52:55], v[172:175]
v_rcp_f32 v119, v119
v_mul_f32 v112, v112, v114
v_mul_f32 v113, v113, v115
s_waitcnt lgkmcnt(6)
v_mfma_f32_16x16x32_bf16 v[188:191], v[84:87], v[52:55], v[188:191]
ds_read_b128 v[80:83], v16 offset:18432
v_mul_f32 v116, v116, v118
v_mul_f32 v117, v117, v119
v_cvt_pk_bf16_f32 v90, v112, v113
v_mfma_f32_16x16x32_bf16 v[184:187], v[84:87], v[48:51], v[184:187]
ds_read_b64_tr_b16 v[64:65], v20 offset:4608
v_cvt_pk_bf16_f32 v91, v116, v117
v_mfma_f32_16x16x32_bf16 v[180:183], v[84:87], v[44:47], v[180:183]
s_add_u32 s51, s81, 0x0
buffer_store_dwordx4 v[88:91], v2, s[68:71], s51 offen sc1
v_lshlrev_b32 v112, 16, v92
v_mfma_f32_16x16x32_bf16 v[176:179], v[84:87], v[40:43], v[176:179]
ds_read_b64_tr_b16 v[66:67], v21 offset:4608
v_and_b32 v113, v35, v92
v_lshlrev_b32 v116, 16, v93
v_and_b32 v117, v35, v93
s_waitcnt lgkmcnt(7)
v_mfma_f32_16x16x32_bf16 v[192:195], v[72:75], v[40:43], v[192:195]
ds_read_b128 v[84:87], v16 offset:19456
v_add_f32 v112, v112, v104
v_add_f32 v113, v113, v105
v_add_f32 v116, v116, v106
v_mfma_f32_16x16x32_bf16 v[196:199], v[72:75], v[44:47], v[196:199]
v_add_f32 v117, v117, v107
v_cvt_pk_bf16_f32 v112, 0, v112
v_cvt_pk_bf16_f32 v113, 0, v113
v_cvt_pk_bf16_f32 v116, 0, v116
v_mfma_f32_16x16x32_bf16 v[200:203], v[72:75], v[48:51], v[200:203]
ds_read_b64_tr_b16 v[68:69], v22 offset:6656
v_cvt_pk_bf16_f32 v117, 0, v117
v_mul_f32 v114, v112, v112
v_mul_f32 v115, v113, v113
v_mfma_f32_16x16x32_bf16 v[204:207], v[72:75], v[52:55], v[204:207]
v_mul_f32 v118, v116, v116
v_mul_f32 v119, v117, v117
v_fma_f32 v114, v114, s82, v34
v_fma_f32 v115, v115, s82, v34
s_waitcnt lgkmcnt(6)
v_mfma_f32_16x16x32_bf16 v[220:223], v[76:79], v[52:55], v[220:223]
ds_read_b128 v[72:75], v17 offset:0
v_fma_f32 v118, v118, s82, v34
v_fma_f32 v119, v119, s82, v34
v_mul_f32 v114, v114, v112
v_mfma_f32_16x16x32_bf16 v[216:219], v[76:79], v[48:51], v[216:219]
ds_read_b64_tr_b16 v[70:71], v23 offset:6656
v_mul_f32 v115, v115, v113
v_mul_f32 v118, v118, v116
v_mul_f32 v119, v119, v117
v_mfma_f32_16x16x32_bf16 v[212:215], v[76:79], v[44:47], v[212:215]
v_exp_f32 v114, v114
v_exp_f32 v115, v115
v_mfma_f32_16x16x32_bf16 v[208:211], v[76:79], v[40:43], v[208:211]
v_exp_f32 v118, v118
v_exp_f32 v119, v119
s_waitcnt lgkmcnt(6)
v_mfma_f32_16x16x32_bf16 v[224:227], v[80:83], v[40:43], v[224:227]
ds_read_b128 v[76:79], v17 offset:1024
v_add_f32 v114, 1.0, v114
v_add_f32 v115, 1.0, v115
v_add_f32 v118, 1.0, v118
v_mfma_f32_16x16x32_bf16 v[228:231], v[80:83], v[44:47], v[228:231]
v_add_f32 v119, 1.0, v119
v_rcp_f32 v114, v114
v_mfma_f32_16x16x32_bf16 v[232:235], v[80:83], v[48:51], v[232:235]
ds_read_b128 v[8:11], v17 offset:17408
v_rcp_f32 v115, v115
v_mfma_f32_16x16x32_bf16 v[236:239], v[80:83], v[52:55], v[236:239]
v_rcp_f32 v118, v118
v_rcp_f32 v119, v119
s_waitcnt lgkmcnt(5)
v_mfma_f32_16x16x32_bf16 v[252:255], v[84:87], v[52:55], v[252:255]
ds_read_b128 v[80:83], v17 offset:2048
v_mul_f32 v112, v112, v114
v_mul_f32 v113, v113, v115
v_mul_f32 v116, v116, v118
v_mfma_f32_16x16x32_bf16 v[248:251], v[84:87], v[48:51], v[248:251]
v_mul_f32 v117, v117, v119
v_cvt_pk_bf16_f32 v92, v112, v113
v_cvt_pk_bf16_f32 v93, v116, v117
v_lshlrev_b32 v112, 16, v94
v_mfma_f32_16x16x32_bf16 v[244:247], v[84:87], v[44:47], v[244:247]
ds_read_b128 v[12:15], v17 offset:18432
v_and_b32 v113, v35, v94
v_lshlrev_b32 v116, 16, v95
v_and_b32 v117, v35, v95
v_mfma_f32_16x16x32_bf16 v[240:243], v[84:87], v[40:43], v[240:243]
v_add_f32 v112, v112, v108
v_add_f32 v113, v113, v109
v_add_f32 v116, v116, v110
v_add_f32 v117, v117, v111
s_waitcnt lgkmcnt(5)
v_mfma_f32_16x16x32_bf16 v[128:131], v[72:75], v[56:59], v[128:131]
ds_read_b128 v[84:87], v17 offset:3072
v_cvt_pk_bf16_f32 v112, 0, v112
v_cvt_pk_bf16_f32 v113, 0, v113
v_cvt_pk_bf16_f32 v116, 0, v116
v_mfma_f32_16x16x32_bf16 v[132:135], v[72:75], v[60:63], v[132:135]
v_cvt_pk_bf16_f32 v117, 0, v117
v_mul_f32 v114, v112, v112
v_mul_f32 v115, v113, v113
v_mul_f32 v118, v116, v116
v_mfma_f32_16x16x32_bf16 v[136:139], v[72:75], v[64:67], v[136:139]
ds_read_b128 v[30:33], v17 offset:19456
v_mul_f32 v119, v117, v117
v_fma_f32 v114, v114, s82, v34
v_fma_f32 v115, v115, s82, v34
s_waitcnt lgkmcnt(6)
v_mfma_f32_16x16x32_bf16 v[140:143], v[72:75], v[68:71], v[140:143]
v_fma_f32 v118, v118, s82, v34
v_fma_f32 v119, v119, s82, v34
v_mul_f32 v114, v114, v112
v_mul_f32 v115, v115, v113
s_waitcnt lgkmcnt(5)
v_mfma_f32_16x16x32_bf16 v[156:159], v[76:79], v[68:71], v[156:159]
ds_read_b128 v[72:75], v17 offset:16384
v_mul_f32 v118, v118, v116
v_mul_f32 v119, v119, v117
v_mfma_f32_16x16x32_bf16 v[152:155], v[76:79], v[64:67], v[152:155]
v_exp_f32 v114, v114
v_exp_f32 v115, v115
v_mfma_f32_16x16x32_bf16 v[148:151], v[76:79], v[60:63], v[148:151]
s_add_u32 s53, s53, 49152
s_cmp_ge_u32 s53, 147456
s_cselect_b32 s53, 0, s53
v_mfma_f32_16x16x32_bf16 v[144:147], v[76:79], v[56:59], v[144:147]
v_add_u32 v16, s53, v24
v_exp_f32 v118, v118
s_waitcnt lgkmcnt(4)
v_mfma_f32_16x16x32_bf16 v[160:163], v[80:83], v[56:59], v[160:163]
v_xor_b32 v17, 0x40, v16
v_exp_f32 v119, v119
v_add_f32 v114, 1.0, v114
v_mfma_f32_16x16x32_bf16 v[164:167], v[80:83], v[60:63], v[164:167]
v_add_u32 v20, s53, v28
v_add_f32 v115, 1.0, v115
v_add_f32 v118, 1.0, v118
v_add_f32 v119, 1.0, v119
v_mfma_f32_16x16x32_bf16 v[168:171], v[80:83], v[64:67], v[168:171]
v_xor_b32 v21, 0x40, v20
v_rcp_f32 v114, v114
v_mfma_f32_16x16x32_bf16 v[172:175], v[80:83], v[68:71], v[172:175]
v_xor_b32 v22, 0x80, v20
v_rcp_f32 v115, v115
s_waitcnt lgkmcnt(2)
v_mfma_f32_16x16x32_bf16 v[188:191], v[84:87], v[68:71], v[188:191]
v_xor_b32 v23, 0xc0, v20
v_rcp_f32 v118, v118
v_mfma_f32_16x16x32_bf16 v[184:187], v[84:87], v[64:67], v[184:187]
v_rcp_f32 v119, v119
v_mul_f32 v112, v112, v114
v_mul_f32 v113, v113, v115
v_mfma_f32_16x16x32_bf16 v[180:183], v[84:87], v[60:63], v[180:183]
v_mul_f32 v116, v116, v118
v_mul_f32 v117, v117, v119
v_cvt_pk_bf16_f32 v94, v112, v113
v_cvt_pk_bf16_f32 v95, v116, v117
v_mfma_f32_16x16x32_bf16 v[176:179], v[84:87], v[56:59], v[176:179]
s_add_u32 s51, s81, 0x200
buffer_store_dwordx4 v[92:95], v2, s[68:71], s51 offen sc1
v_lshlrev_b32 v104, 16, v124
s_waitcnt lgkmcnt(0)
s_barrier
v_mfma_f32_16x16x32_bf16 v[192:195], v[72:75], v[56:59], v[192:195]
ds_read_b64_tr_b16 v[40:41], v20 offset:0
v_and_b32 v105, v35, v124
v_lshlrev_b32 v106, 16, v125
v_mfma_f32_16x16x32_bf16 v[196:199], v[72:75], v[60:63], v[196:199]
ds_read_b64_tr_b16 v[42:43], v21 offset:0
v_and_b32 v107, v35, v125
v_lshlrev_b32 v108, 16, v126
v_mfma_f32_16x16x32_bf16 v[200:203], v[72:75], v[64:67], v[200:203]
ds_read_b64_tr_b16 v[44:45], v22 offset:2048
v_and_b32 v109, v35, v126
v_lshlrev_b32 v110, 16, v127
v_mfma_f32_16x16x32_bf16 v[204:207], v[72:75], v[68:71], v[204:207]
ds_read_b64_tr_b16 v[46:47], v23 offset:2048
v_and_b32 v111, v35, v127
v_lshlrev_b32 v112, 16, v96
v_mfma_f32_16x16x32_bf16 v[220:223], v[8:11], v[68:71], v[220:223]
ds_read_b128 v[72:75], v16 offset:0
v_and_b32 v113, v35, v96
v_lshlrev_b32 v116, 16, v97
v_mfma_f32_16x16x32_bf16 v[216:219], v[8:11], v[64:67], v[216:219]
ds_read_b64_tr_b16 v[48:49], v20 offset:4096
v_and_b32 v117, v35, v97
v_add_f32 v112, v112, v104
v_mfma_f32_16x16x32_bf16 v[212:215], v[8:11], v[60:63], v[212:215]
ds_read_b64_tr_b16 v[50:51], v21 offset:4096
v_add_f32 v113, v113, v105
v_add_f32 v116, v116, v106
v_mfma_f32_16x16x32_bf16 v[208:211], v[8:11], v[56:59], v[208:211]
ds_read_b64_tr_b16 v[52:53], v22 offset:6144
v_add_f32 v117, v117, v107
v_cvt_pk_bf16_f32 v112, 0, v112
v_mfma_f32_16x16x32_bf16 v[224:227], v[12:15], v[56:59], v[224:227]
ds_read_b64_tr_b16 v[54:55], v23 offset:6144
v_cvt_pk_bf16_f32 v113, 0, v113
v_cvt_pk_bf16_f32 v116, 0, v116
v_mfma_f32_16x16x32_bf16 v[228:231], v[12:15], v[60:63], v[228:231]
ds_read_b128 v[76:79], v16 offset:1024
v_cvt_pk_bf16_f32 v117, 0, v117
v_mul_f32 v114, v112, v112
v_mfma_f32_16x16x32_bf16 v[232:235], v[12:15], v[64:67], v[232:235]
ds_read_b128 v[80:83], v16 offset:2048
v_mul_f32 v115, v113, v113
v_mul_f32 v118, v116, v116
v_mfma_f32_16x16x32_bf16 v[236:239], v[12:15], v[68:71], v[236:239]
v_mul_f32 v119, v117, v117
v_fma_f32 v114, v114, s82, v34
v_fma_f32 v115, v115, s82, v34
v_mfma_f32_16x16x32_bf16 v[252:255], v[30:33], v[68:71], v[252:255]
v_fma_f32 v118, v118, s82, v34
v_fma_f32 v119, v119, s82, v34
v_mul_f32 v114, v114, v112
v_mfma_f32_16x16x32_bf16 v[248:251], v[30:33], v[64:67], v[248:251]
v_mul_f32 v115, v115, v113
v_mul_f32 v118, v118, v116
v_mul_f32 v119, v119, v117
v_mfma_f32_16x16x32_bf16 v[244:247], v[30:33], v[60:63], v[244:247]
v_exp_f32 v114, v114
v_mfma_f32_16x16x32_bf16 v[240:243], v[30:33], v[56:59], v[240:243]
v_exp_f32 v115, v115
s_waitcnt lgkmcnt(6)
v_mfma_f32_16x16x32_bf16 v[128:131], v[72:75], v[40:43], v[128:131]
ds_read_b128 v[84:87], v16 offset:3072
v_exp_f32 v118, v118
v_mfma_f32_16x16x32_bf16 v[132:135], v[72:75], v[44:47], v[132:135]
v_exp_f32 v119, v119
v_add_f32 v114, 1.0, v114
s_waitcnt lgkmcnt(5)
v_mfma_f32_16x16x32_bf16 v[136:139], v[72:75], v[48:51], v[136:139]
ds_read_b64_tr_b16 v[56:57], v20 offset:512
v_add_f32 v115, 1.0, v115
v_add_f32 v118, 1.0, v118
s_waitcnt lgkmcnt(4)
v_mfma_f32_16x16x32_bf16 v[140:143], v[72:75], v[52:55], v[140:143]
v_add_f32 v119, 1.0, v119
v_rcp_f32 v114, v114
s_waitcnt lgkmcnt(3)
v_mfma_f32_16x16x32_bf16 v[156:159], v[76:79], v[52:55], v[156:159]
ds_read_b128 v[72:75], v16 offset:16384
v_rcp_f32 v115, v115
v_mfma_f32_16x16x32_bf16 v[152:155], v[76:79], v[48:51], v[152:155]
ds_read_b64_tr_b16 v[58:59], v21 offset:512
v_rcp_f32 v118, v118
v_mfma_f32_16x16x32_bf16 v[148:151], v[76:79], v[44:47], v[148:151]
v_rcp_f32 v119, v119
v_mul_f32 v112, v112, v114
v_mfma_f32_16x16x32_bf16 v[144:147], v[76:79], v[40:43], v[144:147]
ds_read_b64_tr_b16 v[60:61], v22 offset:2560
v_mul_f32 v113, v113, v115
v_mul_f32 v116, v116, v118
s_waitcnt lgkmcnt(5)
v_mfma_f32_16x16x32_bf16 v[160:163], v[80:83], v[40:43], v[160:163]
ds_read_b128 v[76:79], v16 offset:17408
v_mul_f32 v117, v117, v119
v_cvt_pk_bf16_f32 v96, v112, v113
v_mfma_f32_16x16x32_bf16 v[164:167], v[80:83], v[44:47], v[164:167]
v_cvt_pk_bf16_f32 v97, v116, v117
v_lshlrev_b32 v112, 16, v98
v_and_b32 v113, v35, v98
v_mfma_f32_16x16x32_bf16 v[168:171], v[80:83], v[48:51], v[168:171]
ds_read_b64_tr_b16 v[62:63], v23 offset:2560
v_lshlrev_b32 v116, 16, v99
v_and_b32 v117, v35, v99
v_mfma_f32_16x16x32_bf16 v[172:175], v[80:83], v[52:55], v[172:175]
v_add_f32 v112, v112, v108
v_add_f32 v113, v113, v109
v_add_f32 v116, v116, v110
s_waitcnt lgkmcnt(6)
v_mfma_f32_16x16x32_bf16 v[188:191], v[84:87], v[52:55], v[188:191]
ds_read_b128 v[80:83], v16 offset:18432
v_add_f32 v117, v117, v111
v_cvt_pk_bf16_f32 v112, 0, v112
v_mfma_f32_16x16x32_bf16 v[184:187], v[84:87], v[48:51], v[184:187]
ds_read_b64_tr_b16 v[64:65], v20 offset:4608
v_cvt_pk_bf16_f32 v113, 0, v113
v_cvt_pk_bf16_f32 v116, 0, v116
v_mfma_f32_16x16x32_bf16 v[180:183], v[84:87], v[44:47], v[180:183]
v_cvt_pk_bf16_f32 v117, 0, v117
v_mul_f32 v114, v112, v112
v_mul_f32 v115, v113, v113
v_mfma_f32_16x16x32_bf16 v[176:179], v[84:87], v[40:43], v[176:179]
ds_read_b64_tr_b16 v[66:67], v21 offset:4608
v_mul_f32 v118, v116, v116
v_mul_f32 v119, v117, v117
s_waitcnt lgkmcnt(7)
v_mfma_f32_16x16x32_bf16 v[192:195], v[72:75], v[40:43], v[192:195]
ds_read_b128 v[84:87], v16 offset:19456
v_fma_f32 v114, v114, s82, v34
v_fma_f32 v115, v115, s82, v34
v_mfma_f32_16x16x32_bf16 v[196:199], v[72:75], v[44:47], v[196:199]
v_fma_f32 v118, v118, s82, v34
v_fma_f32 v119, v119, s82, v34
v_mul_f32 v114, v114, v112
v_mfma_f32_16x16x32_bf16 v[200:203], v[72:75], v[48:51], v[200:203]
ds_read_b64_tr_b16 v[68:69], v22 offset:6656
v_mul_f32 v115, v115, v113
v_mul_f32 v118, v118, v116
v_mfma_f32_16x16x32_bf16 v[204:207], v[72:75], v[52:55], v[204:207]
v_mul_f32 v119, v119, v117
v_exp_f32 v114, v114
s_waitcnt lgkmcnt(6)
v_mfma_f32_16x16x32_bf16 v[220:223], v[76:79], v[52:55], v[220:223]
ds_read_b128 v[72:75], v17 offset:0
v_exp_f32 v115, v115
v_mfma_f32_16x16x32_bf16 v[216:219], v[76:79], v[48:51], v[216:219]
ds_read_b64_tr_b16 v[70:71], v23 offset:6656
v_exp_f32 v118, v118
v_mfma_f32_16x16x32_bf16 v[212:215], v[76:79], v[44:47], v[212:215]
v_exp_f32 v119, v119
v_add_f32 v114, 1.0, v114
v_mfma_f32_16x16x32_bf16 v[208:211], v[76:79], v[40:43], v[208:211]
v_add_f32 v115, 1.0, v115
v_add_f32 v118, 1.0, v118
v_add_f32 v119, 1.0, v119
s_waitcnt lgkmcnt(6)
v_mfma_f32_16x16x32_bf16 v[224:227], v[80:83], v[40:43], v[224:227]
ds_read_b128 v[76:79], v17 offset:1024
v_rcp_f32 v114, v114
v_mfma_f32_16x16x32_bf16 v[228:231], v[80:83], v[44:47], v[228:231]
v_rcp_f32 v115, v115
v_mfma_f32_16x16x32_bf16 v[232:235], v[80:83], v[48:51], v[232:235]
ds_read_b128 v[8:11], v17 offset:17408
v_rcp_f32 v118, v118
v_mfma_f32_16x16x32_bf16 v[236:239], v[80:83], v[52:55], v[236:239]
v_rcp_f32 v119, v119
v_mul_f32 v112, v112, v114
s_waitcnt lgkmcnt(5)
v_mfma_f32_16x16x32_bf16 v[252:255], v[84:87], v[52:55], v[252:255]
ds_read_b128 v[80:83], v17 offset:2048
v_mul_f32 v113, v113, v115
v_mul_f32 v116, v116, v118
v_mfma_f32_16x16x32_bf16 v[248:251], v[84:87], v[48:51], v[248:251]
v_mul_f32 v117, v117, v119
v_cvt_pk_bf16_f32 v98, v112, v113
v_cvt_pk_bf16_f32 v99, v116, v117
v_mfma_f32_16x16x32_bf16 v[244:247], v[84:87], v[44:47], v[244:247]
ds_read_b128 v[12:15], v17 offset:18432
v_mfma_f32_16x16x32_bf16 v[240:243], v[84:87], v[40:43], v[240:243]
s_waitcnt lgkmcnt(5)
v_mfma_f32_16x16x32_bf16 v[128:131], v[72:75], v[56:59], v[128:131]
ds_read_b128 v[84:87], v17 offset:3072
v_mfma_f32_16x16x32_bf16 v[132:135], v[72:75], v[60:63], v[132:135]
v_mfma_f32_16x16x32_bf16 v[136:139], v[72:75], v[64:67], v[136:139]
ds_read_b128 v[30:33], v17 offset:19456
s_waitcnt lgkmcnt(6)
v_mfma_f32_16x16x32_bf16 v[140:143], v[72:75], v[68:71], v[140:143]
s_waitcnt lgkmcnt(5)
v_mfma_f32_16x16x32_bf16 v[156:159], v[76:79], v[68:71], v[156:159]
ds_read_b128 v[72:75], v17 offset:16384
v_mfma_f32_16x16x32_bf16 v[152:155], v[76:79], v[64:67], v[152:155]
v_mfma_f32_16x16x32_bf16 v[148:151], v[76:79], v[60:63], v[148:151]
s_add_u32 s53, s53, 49152
s_cmp_ge_u32 s53, 147456
s_cselect_b32 s53, 0, s53
v_mfma_f32_16x16x32_bf16 v[144:147], v[76:79], v[56:59], v[144:147]
v_add_u32 v16, s53, v24
s_waitcnt lgkmcnt(4)
v_mfma_f32_16x16x32_bf16 v[160:163], v[80:83], v[56:59], v[160:163]
v_xor_b32 v17, 0x40, v16
v_mfma_f32_16x16x32_bf16 v[164:167], v[80:83], v[60:63], v[164:167]
v_add_u32 v20, s53, v28
v_mfma_f32_16x16x32_bf16 v[168:171], v[80:83], v[64:67], v[168:171]
v_xor_b32 v21, 0x40, v20
v_mfma_f32_16x16x32_bf16 v[172:175], v[80:83], v[68:71], v[172:175]
v_xor_b32 v22, 0x80, v20
s_waitcnt lgkmcnt(2)
v_mfma_f32_16x16x32_bf16 v[188:191], v[84:87], v[68:71], v[188:191]
v_xor_b32 v23, 0xc0, v20
v_mfma_f32_16x16x32_bf16 v[184:187], v[84:87], v[64:67], v[184:187]
v_mfma_f32_16x16x32_bf16 v[180:183], v[84:87], v[60:63], v[180:183]
v_mfma_f32_16x16x32_bf16 v[176:179], v[84:87], v[56:59], v[176:179]
s_waitcnt vmcnt(0)
s_waitcnt lgkmcnt(0)
s_barrier
v_mfma_f32_16x16x32_bf16 v[192:195], v[72:75], v[56:59], v[192:195]
ds_read_b64_tr_b16 v[40:41], v20 offset:0
s_cmp_lg_u32 s3, 0
s_cbranch_scc1 Lw_13
v_mov_b32 v36, 0
v_mov_b32 v3, 1
s_mov_b64 exec, 1
buffer_store_dword v3, v36, s[60:63], s77 offen offset:0 sc1
s_mov_b64 exec, -1
Lw_13:
v_mfma_f32_16x16x32_bf16 v[196:199], v[72:75], v[60:63], v[196:199]
ds_read_b64_tr_b16 v[42:43], v21 offset:0
v_mfma_f32_16x16x32_bf16 v[200:203], v[72:75], v[64:67], v[200:203]
ds_read_b64_tr_b16 v[44:45], v22 offset:2048
v_mfma_f32_16x16x32_bf16 v[204:207], v[72:75], v[68:71], v[204:207]
ds_read_b64_tr_b16 v[46:47], v23 offset:2048
v_mfma_f32_16x16x32_bf16 v[220:223], v[8:11], v[68:71], v[220:223]
ds_read_b128 v[72:75], v16 offset:0
v_mfma_f32_16x16x32_bf16 v[216:219], v[8:11], v[64:67], v[216:219]
ds_read_b64_tr_b16 v[48:49], v20 offset:4096
v_mfma_f32_16x16x32_bf16 v[212:215], v[8:11], v[60:63], v[212:215]
ds_read_b64_tr_b16 v[50:51], v21 offset:4096
v_mfma_f32_16x16x32_bf16 v[208:211], v[8:11], v[56:59], v[208:211]
ds_read_b64_tr_b16 v[52:53], v22 offset:6144
v_mfma_f32_16x16x32_bf16 v[224:227], v[12:15], v[56:59], v[224:227]
ds_read_b64_tr_b16 v[54:55], v23 offset:6144
v_mfma_f32_16x16x32_bf16 v[228:231], v[12:15], v[60:63], v[228:231]
ds_read_b128 v[76:79], v16 offset:1024
v_mfma_f32_16x16x32_bf16 v[232:235], v[12:15], v[64:67], v[232:235]
ds_read_b128 v[80:83], v16 offset:2048
v_mfma_f32_16x16x32_bf16 v[236:239], v[12:15], v[68:71], v[236:239]
s_add_u32 s51, s81, 0x10000
buffer_store_dwordx4 v[96:99], v2, s[68:71], s51 offen sc1
v_mfma_f32_16x16x32_bf16 v[252:255], v[30:33], v[68:71], v[252:255]
v_lshlrev_b32 v112, 16, v100
v_and_b32 v113, v35, v100
v_lshlrev_b32 v116, 16, v101
v_mfma_f32_16x16x32_bf16 v[248:251], v[30:33], v[64:67], v[248:251]
v_and_b32 v117, v35, v101
v_add_f32 v112, v112, v104
v_add_f32 v113, v113, v105
v_mfma_f32_16x16x32_bf16 v[244:247], v[30:33], v[60:63], v[244:247]
v_add_f32 v116, v116, v106
v_add_f32 v117, v117, v107
v_cvt_pk_bf16_f32 v112, 0, v112
v_mfma_f32_16x16x32_bf16 v[240:243], v[30:33], v[56:59], v[240:243]
v_cvt_pk_bf16_f32 v113, 0, v113
v_cvt_pk_bf16_f32 v116, 0, v116
v_cvt_pk_bf16_f32 v117, 0, v117
s_waitcnt lgkmcnt(6)
v_mfma_f32_16x16x32_bf16 v[128:131], v[72:75], v[40:43], v[128:131]
ds_read_b128 v[84:87], v16 offset:3072
v_mul_f32 v114, v112, v112
v_mul_f32 v115, v113, v113
v_mfma_f32_16x16x32_bf16 v[132:135], v[72:75], v[44:47], v[132:135]
v_mul_f32 v118, v116, v116
v_mul_f32 v119, v117, v117
v_fma_f32 v114, v114, s82, v34
s_waitcnt lgkmcnt(5)
v_mfma_f32_16x16x32_bf16 v[136:139], v[72:75], v[48:51], v[136:139]
ds_read_b64_tr_b16 v[56:57], v20 offset:512
v_fma_f32 v115, v115, s82, v34
v_fma_f32 v118, v118, s82, v34
s_waitcnt lgkmcnt(4)
v_mfma_f32_16x16x32_bf16 v[140:143], v[72:75], v[52:55], v[140:143]
v_fma_f32 v119, v119, s82, v34
v_mul_f32 v114, v114, v112
v_mul_f32 v115, v115, v113
s_waitcnt lgkmcnt(3)
v_mfma_f32_16x16x32_bf16 v[156:159], v[76:79], v[52:55], v[156:159]
ds_read_b128 v[72:75], v16 offset:16384
v_mul_f32 v118, v118, v116
v_mul_f32 v119, v119, v117
v_mfma_f32_16x16x32_bf16 v[152:155], v[76:79], v[48:51], v[152:155]
ds_read_b64_tr_b16 v[58:59], v21 offset:512
v_exp_f32 v114, v114
v_mfma_f32_16x16x32_bf16 v[148:151], v[76:79], v[44:47], v[148:151]
v_exp_f32 v115, v115
v_mfma_f32_16x16x32_bf16 v[144:147], v[76:79], v[40:43], v[144:147]
ds_read_b64_tr_b16 v[60:61], v22 offset:2560
v_exp_f32 v118, v118
s_waitcnt lgkmcnt(5)
v_mfma_f32_16x16x32_bf16 v[160:163], v[80:83], v[40:43], v[160:163]
ds_read_b128 v[76:79], v16 offset:17408
v_exp_f32 v119, v119
v_mfma_f32_16x16x32_bf16 v[164:167], v[80:83], v[44:47], v[164:167]
v_add_f32 v114, 1.0, v114
v_add_f32 v115, 1.0, v115
v_add_f32 v118, 1.0, v118
v_mfma_f32_16x16x32_bf16 v[168:171], v[80:83], v[48:51], v[168:171]
ds_read_b64_tr_b16 v[62:63], v23 offset:2560
v_add_f32 v119, 1.0, v119
v_mfma_f32_16x16x32_bf16 v[172:175], v[80:83], v[52:55], v[172:175]
v_rcp_f32 v114, v114
s_waitcnt lgkmcnt(6)
v_mfma_f32_16x16x32_bf16 v[188:191], v[84:87], v[52:55], v[188:191]
ds_read_b128 v[80:83], v16 offset:18432
v_rcp_f32 v115, v115
v_mfma_f32_16x16x32_bf16 v[184:187], v[84:87], v[48:51], v[184:187]
ds_read_b64_tr_b16 v[64:65], v20 offset:4608
v_rcp_f32 v118, v118
v_mfma_f32_16x16x32_bf16 v[180:183], v[84:87], v[44:47], v[180:183]
v_rcp_f32 v119, v119
v_mul_f32 v112, v112, v114
v_mfma_f32_16x16x32_bf16 v[176:179], v[84:87], v[40:43], v[176:179]
ds_read_b64_tr_b16 v[66:67], v21 offset:4608
v_mul_f32 v113, v113, v115
v_mul_f32 v116, v116, v118
s_waitcnt lgkmcnt(7)
v_mfma_f32_16x16x32_bf16 v[192:195], v[72:75], v[40:43], v[192:195]
ds_read_b128 v[84:87], v16 offset:19456
v_mul_f32 v117, v117, v119
v_cvt_pk_bf16_f32 v100, v112, v113
v_mfma_f32_16x16x32_bf16 v[196:199], v[72:75], v[44:47], v[196:199]
v_cvt_pk_bf16_f32 v101, v116, v117
v_lshlrev_b32 v112, 16, v102
v_and_b32 v113, v35, v102
v_mfma_f32_16x16x32_bf16 v[200:203], v[72:75], v[48:51], v[200:203]
ds_read_b64_tr_b16 v[68:69], v22 offset:6656
v_lshlrev_b32 v116, 16, v103
v_and_b32 v117, v35, v103
v_mfma_f32_16x16x32_bf16 v[204:207], v[72:75], v[52:55], v[204:207]
v_add_f32 v112, v112, v108
v_add_f32 v113, v113, v109
v_add_f32 v116, v116, v110
s_waitcnt lgkmcnt(6)
v_mfma_f32_16x16x32_bf16 v[220:223], v[76:79], v[52:55], v[220:223]
ds_read_b128 v[72:75], v17 offset:0
v_add_f32 v117, v117, v111
v_cvt_pk_bf16_f32 v112, 0, v112
v_mfma_f32_16x16x32_bf16 v[216:219], v[76:79], v[48:51], v[216:219]
ds_read_b64_tr_b16 v[70:71], v23 offset:6656
v_cvt_pk_bf16_f32 v113, 0, v113
v_cvt_pk_bf16_f32 v116, 0, v116
v_mfma_f32_16x16x32_bf16 v[212:215], v[76:79], v[44:47], v[212:215]
v_cvt_pk_bf16_f32 v117, 0, v117
v_mul_f32 v114, v112, v112
v_mul_f32 v115, v113, v113
v_mfma_f32_16x16x32_bf16 v[208:211], v[76:79], v[40:43], v[208:211]
v_mul_f32 v118, v116, v116
v_mul_f32 v119, v117, v117
v_fma_f32 v114, v114, s82, v34
s_waitcnt lgkmcnt(6)
v_mfma_f32_16x16x32_bf16 v[224:227], v[80:83], v[40:43], v[224:227]
ds_read_b128 v[76:79], v17 offset:1024
v_fma_f32 v115, v115, s82, v34
v_fma_f32 v118, v118, s82, v34
v_mfma_f32_16x16x32_bf16 v[228:231], v[80:83], v[44:47], v[228:231]
v_fma_f32 v119, v119, s82, v34
v_mul_f32 v114, v114, v112
v_mul_f32 v115, v115, v113
v_mfma_f32_16x16x32_bf16 v[232:235], v[80:83], v[48:51], v[232:235]
ds_read_b128 v[8:11], v17 offset:17408
v_mul_f32 v118, v118, v116
v_mul_f32 v119, v119, v117
v_mfma_f32_16x16x32_bf16 v[236:239], v[80:83], v[52:55], v[236:239]
v_exp_f32 v114, v114
s_waitcnt lgkmcnt(5)
v_mfma_f32_16x16x32_bf16 v[252:255], v[84:87], v[52:55], v[252:255]
ds_read_b128 v[80:83], v17 offset:2048
v_exp_f32 v115, v115
v_mfma_f32_16x16x32_bf16 v[248:251], v[84:87], v[48:51], v[248:251]
v_exp_f32 v118, v118
v_mfma_f32_16x16x32_bf16 v[244:247], v[84:87], v[44:47], v[244:247]
ds_read_b128 v[12:15], v17 offset:18432
v_exp_f32 v119, v119
v_mfma_f32_16x16x32_bf16 v[240:243], v[84:87], v[40:43], v[240:243]
v_add_f32 v114, 1.0, v114
v_add_f32 v115, 1.0, v115
v_add_f32 v118, 1.0, v118
s_waitcnt lgkmcnt(5)
v_mfma_f32_16x16x32_bf16 v[128:131], v[72:75], v[56:59], v[128:131]
ds_read_b128 v[84:87], v17 offset:3072
v_add_f32 v119, 1.0, v119
v_mfma_f32_16x16x32_bf16 v[132:135], v[72:75], v[60:63], v[132:135]
v_rcp_f32 v114, v114
v_mfma_f32_16x16x32_bf16 v[136:139], v[72:75], v[64:67], v[136:139]
ds_read_b128 v[30:33], v17 offset:19456
v_rcp_f32 v115, v115
s_waitcnt lgkmcnt(6)
v_mfma_f32_16x16x32_bf16 v[140:143], v[72:75], v[68:71], v[140:143]
v_rcp_f32 v118, v118
s_waitcnt lgkmcnt(5)
v_mfma_f32_16x16x32_bf16 v[156:159], v[76:79], v[68:71], v[156:159]
ds_read_b128 v[72:75], v17 offset:16384
v_rcp_f32 v119, v119
v_mfma_f32_16x16x32_bf16 v[152:155], v[76:79], v[64:67], v[152:155]
v_mul_f32 v112, v112, v114
v_mul_f32 v113, v113, v115
v_mul_f32 v116, v116, v118
v_mfma_f32_16x16x32_bf16 v[148:151], v[76:79], v[60:63], v[148:151]
s_add_u32 s53, s53, 49152
s_cmp_ge_u32 s53, 147456
s_cselect_b32 s53, 0, s53
v_mfma_f32_16x16x32_bf16 v[144:147], v[76:79], v[56:59], v[144:147]
v_add_u32 v16, s53, v24
v_mul_f32 v117, v117, v119
v_cvt_pk_bf16_f32 v102, v112, v113
s_waitcnt lgkmcnt(4)
v_mfma_f32_16x16x32_bf16 v[160:163], v[80:83], v[56:59], v[160:163]
v_xor_b32 v17, 0x40, v16
v_cvt_pk_bf16_f32 v103, v116, v117
v_mfma_f32_16x16x32_bf16 v[164:167], v[80:83], v[60:63], v[164:167]
v_add_u32 v20, s53, v28
v_mfma_f32_16x16x32_bf16 v[168:171], v[80:83], v[64:67], v[168:171]
v_xor_b32 v21, 0x40, v20
v_mfma_f32_16x16x32_bf16 v[172:175], v[80:83], v[68:71], v[172:175]
v_xor_b32 v22, 0x80, v20
s_waitcnt lgkmcnt(2)
v_mfma_f32_16x16x32_bf16 v[188:191], v[84:87], v[68:71], v[188:191]
v_xor_b32 v23, 0xc0, v20
v_mfma_f32_16x16x32_bf16 v[184:187], v[84:87], v[64:67], v[184:187]
s_add_u32 s51, s81, 0x10200
buffer_store_dwordx4 v[100:103], v2, s[68:71], s51 offen sc1
v_mfma_f32_16x16x32_bf16 v[180:183], v[84:87], v[60:63], v[180:183]
v_mfma_f32_16x16x32_bf16 v[176:179], v[84:87], v[56:59], v[176:179]
s_waitcnt lgkmcnt(0)
s_barrier
v_mfma_f32_16x16x32_bf16 v[192:195], v[72:75], v[56:59], v[192:195]
ds_read_b64_tr_b16 v[40:41], v20 offset:0
v_mfma_f32_16x16x32_bf16 v[196:199], v[72:75], v[60:63], v[196:199]
ds_read_b64_tr_b16 v[42:43], v21 offset:0
v_mfma_f32_16x16x32_bf16 v[200:203], v[72:75], v[64:67], v[200:203]
ds_read_b64_tr_b16 v[44:45], v22 offset:2048
v_mfma_f32_16x16x32_bf16 v[204:207], v[72:75], v[68:71], v[204:207]
ds_read_b64_tr_b16 v[46:47], v23 offset:2048
v_mfma_f32_16x16x32_bf16 v[220:223], v[8:11], v[68:71], v[220:223]
ds_read_b128 v[72:75], v16 offset:0
v_mfma_f32_16x16x32_bf16 v[216:219], v[8:11], v[64:67], v[216:219]
ds_read_b64_tr_b16 v[48:49], v20 offset:4096
v_mfma_f32_16x16x32_bf16 v[212:215], v[8:11], v[60:63], v[212:215]
ds_read_b64_tr_b16 v[50:51], v21 offset:4096
v_mfma_f32_16x16x32_bf16 v[208:211], v[8:11], v[56:59], v[208:211]
ds_read_b64_tr_b16 v[52:53], v22 offset:6144
v_mfma_f32_16x16x32_bf16 v[224:227], v[12:15], v[56:59], v[224:227]
ds_read_b64_tr_b16 v[54:55], v23 offset:6144
v_mfma_f32_16x16x32_bf16 v[228:231], v[12:15], v[60:63], v[228:231]
ds_read_b128 v[76:79], v16 offset:1024
v_mfma_f32_16x16x32_bf16 v[232:235], v[12:15], v[64:67], v[232:235]
ds_read_b128 v[80:83], v16 offset:2048
v_mfma_f32_16x16x32_bf16 v[236:239], v[12:15], v[68:71], v[236:239]
v_mfma_f32_16x16x32_bf16 v[252:255], v[30:33], v[68:71], v[252:255]
v_mfma_f32_16x16x32_bf16 v[248:251], v[30:33], v[64:67], v[248:251]
v_mfma_f32_16x16x32_bf16 v[244:247], v[30:33], v[60:63], v[244:247]
v_mfma_f32_16x16x32_bf16 v[240:243], v[30:33], v[56:59], v[240:243]
s_waitcnt lgkmcnt(6)
v_mfma_f32_16x16x32_bf16 v[128:131], v[72:75], v[40:43], v[128:131]
ds_read_b128 v[84:87], v16 offset:3072
v_mfma_f32_16x16x32_bf16 v[132:135], v[72:75], v[44:47], v[132:135]
s_waitcnt lgkmcnt(5)
v_mfma_f32_16x16x32_bf16 v[136:139], v[72:75], v[48:51], v[136:139]
ds_read_b64_tr_b16 v[56:57], v20 offset:512
s_waitcnt lgkmcnt(4)
v_mfma_f32_16x16x32_bf16 v[140:143], v[72:75], v[52:55], v[140:143]
s_waitcnt lgkmcnt(3)
v_mfma_f32_16x16x32_bf16 v[156:159], v[76:79], v[52:55], v[156:159]
ds_read_b128 v[72:75], v16 offset:16384
v_mfma_f32_16x16x32_bf16 v[152:155], v[76:79], v[48:51], v[152:155]
ds_read_b64_tr_b16 v[58:59], v21 offset:512
v_mfma_f32_16x16x32_bf16 v[148:151], v[76:79], v[44:47], v[148:151]
v_mfma_f32_16x16x32_bf16 v[144:147], v[76:79], v[40:43], v[144:147]
ds_read_b64_tr_b16 v[60:61], v22 offset:2560
s_waitcnt lgkmcnt(5)
v_mfma_f32_16x16x32_bf16 v[160:163], v[80:83], v[40:43], v[160:163]
ds_read_b128 v[76:79], v16 offset:17408
v_mfma_f32_16x16x32_bf16 v[164:167], v[80:83], v[44:47], v[164:167]
v_mfma_f32_16x16x32_bf16 v[168:171], v[80:83], v[48:51], v[168:171]
ds_read_b64_tr_b16 v[62:63], v23 offset:2560
v_mfma_f32_16x16x32_bf16 v[172:175], v[80:83], v[52:55], v[172:175]
s_waitcnt lgkmcnt(6)
v_mfma_f32_16x16x32_bf16 v[188:191], v[84:87], v[52:55], v[188:191]
ds_read_b128 v[80:83], v16 offset:18432
v_mfma_f32_16x16x32_bf16 v[184:187], v[84:87], v[48:51], v[184:187]
ds_read_b64_tr_b16 v[64:65], v20 offset:4608
v_mfma_f32_16x16x32_bf16 v[180:183], v[84:87], v[44:47], v[180:183]
v_mfma_f32_16x16x32_bf16 v[176:179], v[84:87], v[40:43], v[176:179]
ds_read_b64_tr_b16 v[66:67], v21 offset:4608
s_waitcnt lgkmcnt(7)
v_mfma_f32_16x16x32_bf16 v[192:195], v[72:75], v[40:43], v[192:195]
ds_read_b128 v[84:87], v16 offset:19456
v_mfma_f32_16x16x32_bf16 v[196:199], v[72:75], v[44:47], v[196:199]
v_mfma_f32_16x16x32_bf16 v[200:203], v[72:75], v[48:51], v[200:203]
ds_read_b64_tr_b16 v[68:69], v22 offset:6656
v_mfma_f32_16x16x32_bf16 v[204:207], v[72:75], v[52:55], v[204:207]
s_waitcnt lgkmcnt(6)
v_mfma_f32_16x16x32_bf16 v[220:223], v[76:79], v[52:55], v[220:223]
ds_read_b128 v[72:75], v17 offset:0
v_mfma_f32_16x16x32_bf16 v[216:219], v[76:79], v[48:51], v[216:219]
ds_read_b64_tr_b16 v[70:71], v23 offset:6656
v_mfma_f32_16x16x32_bf16 v[212:215], v[76:79], v[44:47], v[212:215]
v_mfma_f32_16x16x32_bf16 v[208:211], v[76:79], v[40:43], v[208:211]
s_waitcnt lgkmcnt(6)
v_mfma_f32_16x16x32_bf16 v[224:227], v[80:83], v[40:43], v[224:227]
ds_read_b128 v[76:79], v17 offset:1024
v_mfma_f32_16x16x32_bf16 v[228:231], v[80:83], v[44:47], v[228:231]
v_mfma_f32_16x16x32_bf16 v[232:235], v[80:83], v[48:51], v[232:235]
ds_read_b128 v[8:11], v17 offset:17408
v_mfma_f32_16x16x32_bf16 v[236:239], v[80:83], v[52:55], v[236:239]
s_waitcnt lgkmcnt(5)
v_mfma_f32_16x16x32_bf16 v[252:255], v[84:87], v[52:55], v[252:255]
ds_read_b128 v[80:83], v17 offset:2048
v_mfma_f32_16x16x32_bf16 v[248:251], v[84:87], v[48:51], v[248:251]
v_mfma_f32_16x16x32_bf16 v[244:247], v[84:87], v[44:47], v[244:247]
ds_read_b128 v[12:15], v17 offset:18432
v_mfma_f32_16x16x32_bf16 v[240:243], v[84:87], v[40:43], v[240:243]
s_waitcnt lgkmcnt(5)
v_mfma_f32_16x16x32_bf16 v[128:131], v[72:75], v[56:59], v[128:131]
ds_read_b128 v[84:87], v17 offset:3072
v_mfma_f32_16x16x32_bf16 v[132:135], v[72:75], v[60:63], v[132:135]
v_mfma_f32_16x16x32_bf16 v[136:139], v[72:75], v[64:67], v[136:139]
ds_read_b128 v[30:33], v17 offset:19456
s_waitcnt lgkmcnt(6)
v_mfma_f32_16x16x32_bf16 v[140:143], v[72:75], v[68:71], v[140:143]
s_waitcnt lgkmcnt(5)
v_mfma_f32_16x16x32_bf16 v[156:159], v[76:79], v[68:71], v[156:159]
ds_read_b128 v[72:75], v17 offset:16384
v_mfma_f32_16x16x32_bf16 v[152:155], v[76:79], v[64:67], v[152:155]
v_mfma_f32_16x16x32_bf16 v[148:151], v[76:79], v[60:63], v[148:151]
s_add_u32 s53, s53, 49152
s_cmp_ge_u32 s53, 147456
s_cselect_b32 s53, 0, s53
v_mfma_f32_16x16x32_bf16 v[144:147], v[76:79], v[56:59], v[144:147]
v_add_u32 v16, s53, v24
s_waitcnt lgkmcnt(4)
v_mfma_f32_16x16x32_bf16 v[160:163], v[80:83], v[56:59], v[160:163]
v_xor_b32 v17, 0x40, v16
v_mfma_f32_16x16x32_bf16 v[164:167], v[80:83], v[60:63], v[164:167]
v_add_u32 v20, s53, v28
v_mfma_f32_16x16x32_bf16 v[168:171], v[80:83], v[64:67], v[168:171]
v_xor_b32 v21, 0x40, v20
v_mfma_f32_16x16x32_bf16 v[172:175], v[80:83], v[68:71], v[172:175]
v_xor_b32 v22, 0x80, v20
s_waitcnt lgkmcnt(2)
v_mfma_f32_16x16x32_bf16 v[188:191], v[84:87], v[68:71], v[188:191]
v_xor_b32 v23, 0xc0, v20
v_mfma_f32_16x16x32_bf16 v[184:187], v[84:87], v[64:67], v[184:187]
v_mfma_f32_16x16x32_bf16 v[180:183], v[84:87], v[60:63], v[180:183]
v_mfma_f32_16x16x32_bf16 v[176:179], v[84:87], v[56:59], v[176:179]
s_waitcnt lgkmcnt(0)
s_barrier
v_mfma_f32_16x16x32_bf16 v[192:195], v[72:75], v[56:59], v[192:195]
ds_read_b64_tr_b16 v[40:41], v20 offset:0
v_mfma_f32_16x16x32_bf16 v[196:199], v[72:75], v[60:63], v[196:199]
ds_read_b64_tr_b16 v[42:43], v21 offset:0
v_mfma_f32_16x16x32_bf16 v[200:203], v[72:75], v[64:67], v[200:203]
ds_read_b64_tr_b16 v[44:45], v22 offset:2048
v_mfma_f32_16x16x32_bf16 v[204:207], v[72:75], v[68:71], v[204:207]
ds_read_b64_tr_b16 v[46:47], v23 offset:2048
v_mfma_f32_16x16x32_bf16 v[220:223], v[8:11], v[68:71], v[220:223]
ds_read_b128 v[72:75], v16 offset:0
v_mfma_f32_16x16x32_bf16 v[216:219], v[8:11], v[64:67], v[216:219]
ds_read_b64_tr_b16 v[48:49], v20 offset:4096
v_mfma_f32_16x16x32_bf16 v[212:215], v[8:11], v[60:63], v[212:215]
ds_read_b64_tr_b16 v[50:51], v21 offset:4096
v_mfma_f32_16x16x32_bf16 v[208:211], v[8:11], v[56:59], v[208:211]
ds_read_b64_tr_b16 v[52:53], v22 offset:6144
v_mfma_f32_16x16x32_bf16 v[224:227], v[12:15], v[56:59], v[224:227]
ds_read_b64_tr_b16 v[54:55], v23 offset:6144
v_mfma_f32_16x16x32_bf16 v[228:231], v[12:15], v[60:63], v[228:231]
ds_read_b128 v[76:79], v16 offset:1024
v_mfma_f32_16x16x32_bf16 v[232:235], v[12:15], v[64:67], v[232:235]
ds_read_b128 v[80:83], v16 offset:2048
v_mfma_f32_16x16x32_bf16 v[236:239], v[12:15], v[68:71], v[236:239]
v_mfma_f32_16x16x32_bf16 v[252:255], v[30:33], v[68:71], v[252:255]
v_mfma_f32_16x16x32_bf16 v[248:251], v[30:33], v[64:67], v[248:251]
v_mfma_f32_16x16x32_bf16 v[244:247], v[30:33], v[60:63], v[244:247]
v_mfma_f32_16x16x32_bf16 v[240:243], v[30:33], v[56:59], v[240:243]
s_waitcnt lgkmcnt(6)
v_mfma_f32_16x16x32_bf16 v[128:131], v[72:75], v[40:43], v[128:131]
ds_read_b128 v[84:87], v16 offset:3072
v_mfma_f32_16x16x32_bf16 v[132:135], v[72:75], v[44:47], v[132:135]
s_waitcnt lgkmcnt(5)
v_mfma_f32_16x16x32_bf16 v[136:139], v[72:75], v[48:51], v[136:139]
ds_read_b64_tr_b16 v[56:57], v20 offset:512
s_waitcnt lgkmcnt(4)
v_mfma_f32_16x16x32_bf16 v[140:143], v[72:75], v[52:55], v[140:143]
s_waitcnt lgkmcnt(3)
v_mfma_f32_16x16x32_bf16 v[156:159], v[76:79], v[52:55], v[156:159]
ds_read_b128 v[72:75], v16 offset:16384
v_mfma_f32_16x16x32_bf16 v[152:155], v[76:79], v[48:51], v[152:155]
ds_read_b64_tr_b16 v[58:59], v21 offset:512
v_mfma_f32_16x16x32_bf16 v[148:151], v[76:79], v[44:47], v[148:151]
v_mfma_f32_16x16x32_bf16 v[144:147], v[76:79], v[40:43], v[144:147]
ds_read_b64_tr_b16 v[60:61], v22 offset:2560
s_waitcnt lgkmcnt(5)
v_mfma_f32_16x16x32_bf16 v[160:163], v[80:83], v[40:43], v[160:163]
ds_read_b128 v[76:79], v16 offset:17408
v_mfma_f32_16x16x32_bf16 v[164:167], v[80:83], v[44:47], v[164:167]
v_mfma_f32_16x16x32_bf16 v[168:171], v[80:83], v[48:51], v[168:171]
ds_read_b64_tr_b16 v[62:63], v23 offset:2560
v_mfma_f32_16x16x32_bf16 v[172:175], v[80:83], v[52:55], v[172:175]
s_waitcnt lgkmcnt(6)
v_mfma_f32_16x16x32_bf16 v[188:191], v[84:87], v[52:55], v[188:191]
ds_read_b128 v[80:83], v16 offset:18432
v_mfma_f32_16x16x32_bf16 v[184:187], v[84:87], v[48:51], v[184:187]
ds_read_b64_tr_b16 v[64:65], v20 offset:4608
v_mfma_f32_16x16x32_bf16 v[180:183], v[84:87], v[44:47], v[180:183]
v_mfma_f32_16x16x32_bf16 v[176:179], v[84:87], v[40:43], v[176:179]
ds_read_b64_tr_b16 v[66:67], v21 offset:4608
s_waitcnt lgkmcnt(7)
v_mfma_f32_16x16x32_bf16 v[192:195], v[72:75], v[40:43], v[192:195]
ds_read_b128 v[84:87], v16 offset:19456
v_mfma_f32_16x16x32_bf16 v[196:199], v[72:75], v[44:47], v[196:199]
v_mfma_f32_16x16x32_bf16 v[200:203], v[72:75], v[48:51], v[200:203]
ds_read_b64_tr_b16 v[68:69], v22 offset:6656
v_mfma_f32_16x16x32_bf16 v[204:207], v[72:75], v[52:55], v[204:207]
s_waitcnt lgkmcnt(6)
v_mfma_f32_16x16x32_bf16 v[220:223], v[76:79], v[52:55], v[220:223]
ds_read_b128 v[72:75], v17 offset:0
v_mfma_f32_16x16x32_bf16 v[216:219], v[76:79], v[48:51], v[216:219]
ds_read_b64_tr_b16 v[70:71], v23 offset:6656
v_mfma_f32_16x16x32_bf16 v[212:215], v[76:79], v[44:47], v[212:215]
v_mfma_f32_16x16x32_bf16 v[208:211], v[76:79], v[40:43], v[208:211]
s_waitcnt lgkmcnt(6)
v_mfma_f32_16x16x32_bf16 v[224:227], v[80:83], v[40:43], v[224:227]
ds_read_b128 v[76:79], v17 offset:1024
v_mfma_f32_16x16x32_bf16 v[228:231], v[80:83], v[44:47], v[228:231]
v_mfma_f32_16x16x32_bf16 v[232:235], v[80:83], v[48:51], v[232:235]
ds_read_b128 v[8:11], v17 offset:17408
v_mfma_f32_16x16x32_bf16 v[236:239], v[80:83], v[52:55], v[236:239]
s_waitcnt lgkmcnt(5)
v_mfma_f32_16x16x32_bf16 v[252:255], v[84:87], v[52:55], v[252:255]
ds_read_b128 v[80:83], v17 offset:2048
v_mfma_f32_16x16x32_bf16 v[248:251], v[84:87], v[48:51], v[248:251]
v_mfma_f32_16x16x32_bf16 v[244:247], v[84:87], v[44:47], v[244:247]
ds_read_b128 v[12:15], v17 offset:18432
v_mfma_f32_16x16x32_bf16 v[240:243], v[84:87], v[40:43], v[240:243]
s_waitcnt lgkmcnt(5)
v_mfma_f32_16x16x32_bf16 v[128:131], v[72:75], v[56:59], v[128:131]
ds_read_b128 v[84:87], v17 offset:3072
v_mfma_f32_16x16x32_bf16 v[132:135], v[72:75], v[60:63], v[132:135]
v_mfma_f32_16x16x32_bf16 v[136:139], v[72:75], v[64:67], v[136:139]
ds_read_b128 v[30:33], v17 offset:19456
s_waitcnt lgkmcnt(6)
v_mfma_f32_16x16x32_bf16 v[140:143], v[72:75], v[68:71], v[140:143]
s_waitcnt lgkmcnt(5)
v_mfma_f32_16x16x32_bf16 v[156:159], v[76:79], v[68:71], v[156:159]
ds_read_b128 v[72:75], v17 offset:16384
v_mfma_f32_16x16x32_bf16 v[152:155], v[76:79], v[64:67], v[152:155]
v_mfma_f32_16x16x32_bf16 v[148:151], v[76:79], v[60:63], v[148:151]
s_add_u32 s53, s53, 49152
s_cmp_ge_u32 s53, 147456
s_cselect_b32 s53, 0, s53
v_mfma_f32_16x16x32_bf16 v[144:147], v[76:79], v[56:59], v[144:147]
v_add_u32 v16, s53, v24
s_waitcnt lgkmcnt(4)
v_mfma_f32_16x16x32_bf16 v[160:163], v[80:83], v[56:59], v[160:163]
v_xor_b32 v17, 0x40, v16
v_mfma_f32_16x16x32_bf16 v[164:167], v[80:83], v[60:63], v[164:167]
v_add_u32 v20, s53, v28
v_mfma_f32_16x16x32_bf16 v[168:171], v[80:83], v[64:67], v[168:171]
v_xor_b32 v21, 0x40, v20
v_mfma_f32_16x16x32_bf16 v[172:175], v[80:83], v[68:71], v[172:175]
v_xor_b32 v22, 0x80, v20
s_waitcnt lgkmcnt(2)
v_mfma_f32_16x16x32_bf16 v[188:191], v[84:87], v[68:71], v[188:191]
v_xor_b32 v23, 0xc0, v20
v_mfma_f32_16x16x32_bf16 v[184:187], v[84:87], v[64:67], v[184:187]
v_mfma_f32_16x16x32_bf16 v[180:183], v[84:87], v[60:63], v[180:183]
v_mfma_f32_16x16x32_bf16 v[176:179], v[84:87], v[56:59], v[176:179]
s_waitcnt lgkmcnt(0)
s_barrier
v_mfma_f32_16x16x32_bf16 v[192:195], v[72:75], v[56:59], v[192:195]
ds_read_b64_tr_b16 v[40:41], v20 offset:0
v_mfma_f32_16x16x32_bf16 v[196:199], v[72:75], v[60:63], v[196:199]
ds_read_b64_tr_b16 v[42:43], v21 offset:0
v_mfma_f32_16x16x32_bf16 v[200:203], v[72:75], v[64:67], v[200:203]
ds_read_b64_tr_b16 v[44:45], v22 offset:2048
v_mfma_f32_16x16x32_bf16 v[204:207], v[72:75], v[68:71], v[204:207]
ds_read_b64_tr_b16 v[46:47], v23 offset:2048
v_mfma_f32_16x16x32_bf16 v[220:223], v[8:11], v[68:71], v[220:223]
ds_read_b128 v[72:75], v16 offset:0
v_mfma_f32_16x16x32_bf16 v[216:219], v[8:11], v[64:67], v[216:219]
ds_read_b64_tr_b16 v[48:49], v20 offset:4096
v_mfma_f32_16x16x32_bf16 v[212:215], v[8:11], v[60:63], v[212:215]
ds_read_b64_tr_b16 v[50:51], v21 offset:4096
v_mfma_f32_16x16x32_bf16 v[208:211], v[8:11], v[56:59], v[208:211]
ds_read_b64_tr_b16 v[52:53], v22 offset:6144
v_mfma_f32_16x16x32_bf16 v[224:227], v[12:15], v[56:59], v[224:227]
ds_read_b64_tr_b16 v[54:55], v23 offset:6144
v_mfma_f32_16x16x32_bf16 v[228:231], v[12:15], v[60:63], v[228:231]
ds_read_b128 v[76:79], v16 offset:1024
v_mfma_f32_16x16x32_bf16 v[232:235], v[12:15], v[64:67], v[232:235]
ds_read_b128 v[80:83], v16 offset:2048
v_mfma_f32_16x16x32_bf16 v[236:239], v[12:15], v[68:71], v[236:239]
v_mfma_f32_16x16x32_bf16 v[252:255], v[30:33], v[68:71], v[252:255]
v_mfma_f32_16x16x32_bf16 v[248:251], v[30:33], v[64:67], v[248:251]
v_mfma_f32_16x16x32_bf16 v[244:247], v[30:33], v[60:63], v[244:247]
v_mfma_f32_16x16x32_bf16 v[240:243], v[30:33], v[56:59], v[240:243]
s_waitcnt lgkmcnt(6)
v_mfma_f32_16x16x32_bf16 v[128:131], v[72:75], v[40:43], v[128:131]
ds_read_b128 v[84:87], v16 offset:3072
v_mfma_f32_16x16x32_bf16 v[132:135], v[72:75], v[44:47], v[132:135]
s_waitcnt lgkmcnt(5)
v_mfma_f32_16x16x32_bf16 v[136:139], v[72:75], v[48:51], v[136:139]
ds_read_b64_tr_b16 v[56:57], v20 offset:512
s_waitcnt lgkmcnt(4)
v_mfma_f32_16x16x32_bf16 v[140:143], v[72:75], v[52:55], v[140:143]
s_waitcnt lgkmcnt(3)
v_mfma_f32_16x16x32_bf16 v[156:159], v[76:79], v[52:55], v[156:159]
ds_read_b128 v[72:75], v16 offset:16384
v_mfma_f32_16x16x32_bf16 v[152:155], v[76:79], v[48:51], v[152:155]
ds_read_b64_tr_b16 v[58:59], v21 offset:512
v_mfma_f32_16x16x32_bf16 v[148:151], v[76:79], v[44:47], v[148:151]
v_mfma_f32_16x16x32_bf16 v[144:147], v[76:79], v[40:43], v[144:147]
ds_read_b64_tr_b16 v[60:61], v22 offset:2560
s_waitcnt lgkmcnt(5)
v_mfma_f32_16x16x32_bf16 v[160:163], v[80:83], v[40:43], v[160:163]
ds_read_b128 v[76:79], v16 offset:17408
v_mfma_f32_16x16x32_bf16 v[164:167], v[80:83], v[44:47], v[164:167]
v_mfma_f32_16x16x32_bf16 v[168:171], v[80:83], v[48:51], v[168:171]
ds_read_b64_tr_b16 v[62:63], v23 offset:2560
v_mfma_f32_16x16x32_bf16 v[172:175], v[80:83], v[52:55], v[172:175]
s_waitcnt lgkmcnt(6)
v_mfma_f32_16x16x32_bf16 v[188:191], v[84:87], v[52:55], v[188:191]
ds_read_b128 v[80:83], v16 offset:18432
v_mfma_f32_16x16x32_bf16 v[184:187], v[84:87], v[48:51], v[184:187]
ds_read_b64_tr_b16 v[64:65], v20 offset:4608
v_mfma_f32_16x16x32_bf16 v[180:183], v[84:87], v[44:47], v[180:183]
v_mfma_f32_16x16x32_bf16 v[176:179], v[84:87], v[40:43], v[176:179]
ds_read_b64_tr_b16 v[66:67], v21 offset:4608
s_waitcnt lgkmcnt(7)
v_mfma_f32_16x16x32_bf16 v[192:195], v[72:75], v[40:43], v[192:195]
ds_read_b128 v[84:87], v16 offset:19456
v_mfma_f32_16x16x32_bf16 v[196:199], v[72:75], v[44:47], v[196:199]
v_mfma_f32_16x16x32_bf16 v[200:203], v[72:75], v[48:51], v[200:203]
ds_read_b64_tr_b16 v[68:69], v22 offset:6656
v_mfma_f32_16x16x32_bf16 v[204:207], v[72:75], v[52:55], v[204:207]
s_waitcnt lgkmcnt(6)
v_mfma_f32_16x16x32_bf16 v[220:223], v[76:79], v[52:55], v[220:223]
ds_read_b128 v[72:75], v17 offset:0
v_mfma_f32_16x16x32_bf16 v[216:219], v[76:79], v[48:51], v[216:219]
ds_read_b64_tr_b16 v[70:71], v23 offset:6656
v_mfma_f32_16x16x32_bf16 v[212:215], v[76:79], v[44:47], v[212:215]
v_mfma_f32_16x16x32_bf16 v[208:211], v[76:79], v[40:43], v[208:211]
s_waitcnt lgkmcnt(6)
v_mfma_f32_16x16x32_bf16 v[224:227], v[80:83], v[40:43], v[224:227]
ds_read_b128 v[76:79], v17 offset:1024
v_mfma_f32_16x16x32_bf16 v[228:231], v[80:83], v[44:47], v[228:231]
v_mfma_f32_16x16x32_bf16 v[232:235], v[80:83], v[48:51], v[232:235]
ds_read_b128 v[8:11], v17 offset:17408
v_mfma_f32_16x16x32_bf16 v[236:239], v[80:83], v[52:55], v[236:239]
s_waitcnt lgkmcnt(5)
v_mfma_f32_16x16x32_bf16 v[252:255], v[84:87], v[52:55], v[252:255]
ds_read_b128 v[80:83], v17 offset:2048
v_mfma_f32_16x16x32_bf16 v[248:251], v[84:87], v[48:51], v[248:251]
v_mfma_f32_16x16x32_bf16 v[244:247], v[84:87], v[44:47], v[244:247]
ds_read_b128 v[12:15], v17 offset:18432
v_mfma_f32_16x16x32_bf16 v[240:243], v[84:87], v[40:43], v[240:243]
s_waitcnt lgkmcnt(5)
v_mfma_f32_16x16x32_bf16 v[128:131], v[72:75], v[56:59], v[128:131]
ds_read_b128 v[84:87], v17 offset:3072
v_mfma_f32_16x16x32_bf16 v[132:135], v[72:75], v[60:63], v[132:135]
v_mfma_f32_16x16x32_bf16 v[136:139], v[72:75], v[64:67], v[136:139]
ds_read_b128 v[30:33], v17 offset:19456
s_waitcnt lgkmcnt(6)
v_mfma_f32_16x16x32_bf16 v[140:143], v[72:75], v[68:71], v[140:143]
s_waitcnt lgkmcnt(5)
v_mfma_f32_16x16x32_bf16 v[156:159], v[76:79], v[68:71], v[156:159]
ds_read_b128 v[72:75], v17 offset:16384
v_mfma_f32_16x16x32_bf16 v[152:155], v[76:79], v[64:67], v[152:155]
v_mfma_f32_16x16x32_bf16 v[148:151], v[76:79], v[60:63], v[148:151]
s_add_u32 s53, s53, 49152
s_cmp_ge_u32 s53, 147456
s_cselect_b32 s53, 0, s53
v_mfma_f32_16x16x32_bf16 v[144:147], v[76:79], v[56:59], v[144:147]
v_add_u32 v16, s53, v24
s_waitcnt lgkmcnt(4)
v_mfma_f32_16x16x32_bf16 v[160:163], v[80:83], v[56:59], v[160:163]
v_xor_b32 v17, 0x40, v16
v_mfma_f32_16x16x32_bf16 v[164:167], v[80:83], v[60:63], v[164:167]
v_add_u32 v20, s53, v28
v_mfma_f32_16x16x32_bf16 v[168:171], v[80:83], v[64:67], v[168:171]
v_xor_b32 v21, 0x40, v20
v_mfma_f32_16x16x32_bf16 v[172:175], v[80:83], v[68:71], v[172:175]
v_xor_b32 v22, 0x80, v20
s_waitcnt lgkmcnt(2)
v_mfma_f32_16x16x32_bf16 v[188:191], v[84:87], v[68:71], v[188:191]
v_xor_b32 v23, 0xc0, v20
v_mfma_f32_16x16x32_bf16 v[184:187], v[84:87], v[64:67], v[184:187]
v_mfma_f32_16x16x32_bf16 v[180:183], v[84:87], v[60:63], v[180:183]
v_mfma_f32_16x16x32_bf16 v[176:179], v[84:87], v[56:59], v[176:179]
s_waitcnt vmcnt(0)
s_waitcnt lgkmcnt(0)
s_barrier
v_mfma_f32_16x16x32_bf16 v[192:195], v[72:75], v[56:59], v[192:195]
ds_read_b64_tr_b16 v[40:41], v20 offset:0
v_mfma_f32_16x16x32_bf16 v[196:199], v[72:75], v[60:63], v[196:199]
ds_read_b64_tr_b16 v[42:43], v21 offset:0
v_mfma_f32_16x16x32_bf16 v[200:203], v[72:75], v[64:67], v[200:203]
ds_read_b64_tr_b16 v[44:45], v22 offset:2048
v_mfma_f32_16x16x32_bf16 v[204:207], v[72:75], v[68:71], v[204:207]
ds_read_b64_tr_b16 v[46:47], v23 offset:2048
v_mfma_f32_16x16x32_bf16 v[220:223], v[8:11], v[68:71], v[220:223]
ds_read_b128 v[72:75], v16 offset:0
v_mfma_f32_16x16x32_bf16 v[216:219], v[8:11], v[64:67], v[216:219]
ds_read_b64_tr_b16 v[48:49], v20 offset:4096
v_mfma_f32_16x16x32_bf16 v[212:215], v[8:11], v[60:63], v[212:215]
ds_read_b64_tr_b16 v[50:51], v21 offset:4096
v_mfma_f32_16x16x32_bf16 v[208:211], v[8:11], v[56:59], v[208:211]
ds_read_b64_tr_b16 v[52:53], v22 offset:6144
v_mfma_f32_16x16x32_bf16 v[224:227], v[12:15], v[56:59], v[224:227]
ds_read_b64_tr_b16 v[54:55], v23 offset:6144
v_mfma_f32_16x16x32_bf16 v[228:231], v[12:15], v[60:63], v[228:231]
ds_read_b128 v[76:79], v16 offset:1024
v_mfma_f32_16x16x32_bf16 v[232:235], v[12:15], v[64:67], v[232:235]
ds_read_b128 v[80:83], v16 offset:2048
v_mfma_f32_16x16x32_bf16 v[236:239], v[12:15], v[68:71], v[236:239]
v_mfma_f32_16x16x32_bf16 v[252:255], v[30:33], v[68:71], v[252:255]
v_mfma_f32_16x16x32_bf16 v[248:251], v[30:33], v[64:67], v[248:251]
v_mfma_f32_16x16x32_bf16 v[244:247], v[30:33], v[60:63], v[244:247]
v_mfma_f32_16x16x32_bf16 v[240:243], v[30:33], v[56:59], v[240:243]
s_waitcnt lgkmcnt(6)
v_mfma_f32_16x16x32_bf16 v[128:131], v[72:75], v[40:43], v[128:131]
ds_read_b128 v[84:87], v16 offset:3072
v_mfma_f32_16x16x32_bf16 v[132:135], v[72:75], v[44:47], v[132:135]
s_waitcnt lgkmcnt(5)
v_mfma_f32_16x16x32_bf16 v[136:139], v[72:75], v[48:51], v[136:139]
ds_read_b64_tr_b16 v[56:57], v20 offset:512
s_waitcnt lgkmcnt(4)
v_mfma_f32_16x16x32_bf16 v[140:143], v[72:75], v[52:55], v[140:143]
s_waitcnt lgkmcnt(3)
v_mfma_f32_16x16x32_bf16 v[156:159], v[76:79], v[52:55], v[156:159]
ds_read_b128 v[72:75], v16 offset:16384
v_mfma_f32_16x16x32_bf16 v[152:155], v[76:79], v[48:51], v[152:155]
ds_read_b64_tr_b16 v[58:59], v21 offset:512
v_mfma_f32_16x16x32_bf16 v[148:151], v[76:79], v[44:47], v[148:151]
v_mfma_f32_16x16x32_bf16 v[144:147], v[76:79], v[40:43], v[144:147]
ds_read_b64_tr_b16 v[60:61], v22 offset:2560
s_waitcnt lgkmcnt(5)
v_mfma_f32_16x16x32_bf16 v[160:163], v[80:83], v[40:43], v[160:163]
ds_read_b128 v[76:79], v16 offset:17408
v_mfma_f32_16x16x32_bf16 v[164:167], v[80:83], v[44:47], v[164:167]
v_mfma_f32_16x16x32_bf16 v[168:171], v[80:83], v[48:51], v[168:171]
ds_read_b64_tr_b16 v[62:63], v23 offset:2560
v_mfma_f32_16x16x32_bf16 v[172:175], v[80:83], v[52:55], v[172:175]
s_waitcnt lgkmcnt(6)
v_mfma_f32_16x16x32_bf16 v[188:191], v[84:87], v[52:55], v[188:191]
ds_read_b128 v[80:83], v16 offset:18432
v_mfma_f32_16x16x32_bf16 v[184:187], v[84:87], v[48:51], v[184:187]
ds_read_b64_tr_b16 v[64:65], v20 offset:4608
v_mfma_f32_16x16x32_bf16 v[180:183], v[84:87], v[44:47], v[180:183]
v_mfma_f32_16x16x32_bf16 v[176:179], v[84:87], v[40:43], v[176:179]
ds_read_b64_tr_b16 v[66:67], v21 offset:4608
s_waitcnt lgkmcnt(7)
v_mfma_f32_16x16x32_bf16 v[192:195], v[72:75], v[40:43], v[192:195]
ds_read_b128 v[84:87], v16 offset:19456
v_mfma_f32_16x16x32_bf16 v[196:199], v[72:75], v[44:47], v[196:199]
v_mfma_f32_16x16x32_bf16 v[200:203], v[72:75], v[48:51], v[200:203]
ds_read_b64_tr_b16 v[68:69], v22 offset:6656
v_mfma_f32_16x16x32_bf16 v[204:207], v[72:75], v[52:55], v[204:207]
s_waitcnt lgkmcnt(6)
v_mfma_f32_16x16x32_bf16 v[220:223], v[76:79], v[52:55], v[220:223]
ds_read_b128 v[72:75], v17 offset:0
v_mfma_f32_16x16x32_bf16 v[216:219], v[76:79], v[48:51], v[216:219]
ds_read_b64_tr_b16 v[70:71], v23 offset:6656
v_mfma_f32_16x16x32_bf16 v[212:215], v[76:79], v[44:47], v[212:215]
v_mfma_f32_16x16x32_bf16 v[208:211], v[76:79], v[40:43], v[208:211]
s_waitcnt lgkmcnt(6)
v_mfma_f32_16x16x32_bf16 v[224:227], v[80:83], v[40:43], v[224:227]
ds_read_b128 v[76:79], v17 offset:1024
v_mfma_f32_16x16x32_bf16 v[228:231], v[80:83], v[44:47], v[228:231]
v_mfma_f32_16x16x32_bf16 v[232:235], v[80:83], v[48:51], v[232:235]
ds_read_b128 v[8:11], v17 offset:17408
v_mfma_f32_16x16x32_bf16 v[236:239], v[80:83], v[52:55], v[236:239]
s_waitcnt lgkmcnt(5)
v_mfma_f32_16x16x32_bf16 v[252:255], v[84:87], v[52:55], v[252:255]
ds_read_b128 v[80:83], v17 offset:2048
v_mfma_f32_16x16x32_bf16 v[248:251], v[84:87], v[48:51], v[248:251]
v_mfma_f32_16x16x32_bf16 v[244:247], v[84:87], v[44:47], v[244:247]
ds_read_b128 v[12:15], v17 offset:18432
v_mfma_f32_16x16x32_bf16 v[240:243], v[84:87], v[40:43], v[240:243]
s_waitcnt lgkmcnt(5)
v_mfma_f32_16x16x32_bf16 v[128:131], v[72:75], v[56:59], v[128:131]
ds_read_b128 v[84:87], v17 offset:3072
v_mfma_f32_16x16x32_bf16 v[132:135], v[72:75], v[60:63], v[132:135]
v_mfma_f32_16x16x32_bf16 v[136:139], v[72:75], v[64:67], v[136:139]
ds_read_b128 v[30:33], v17 offset:19456
s_waitcnt lgkmcnt(6)
v_mfma_f32_16x16x32_bf16 v[140:143], v[72:75], v[68:71], v[140:143]
s_waitcnt lgkmcnt(5)
v_mfma_f32_16x16x32_bf16 v[156:159], v[76:79], v[68:71], v[156:159]
ds_read_b128 v[72:75], v17 offset:16384
v_mfma_f32_16x16x32_bf16 v[152:155], v[76:79], v[64:67], v[152:155]
v_mfma_f32_16x16x32_bf16 v[148:151], v[76:79], v[60:63], v[148:151]
s_add_u32 s53, s53, 49152
s_cmp_ge_u32 s53, 147456
s_cselect_b32 s53, 0, s53
v_mfma_f32_16x16x32_bf16 v[144:147], v[76:79], v[56:59], v[144:147]
v_add_u32 v16, s53, v29
s_waitcnt lgkmcnt(4)
v_mfma_f32_16x16x32_bf16 v[160:163], v[80:83], v[56:59], v[160:163]
v_add_u32 v20, s53, v39
v_mfma_f32_16x16x32_bf16 v[164:167], v[80:83], v[60:63], v[164:167]
v_xor_b32 v21, 0x20, v20
v_mfma_f32_16x16x32_bf16 v[168:171], v[80:83], v[64:67], v[168:171]
v_xor_b32 v22, 0x40, v20
v_mfma_f32_16x16x32_bf16 v[172:175], v[80:83], v[68:71], v[172:175]
v_xor_b32 v23, 0x60, v20
s_waitcnt lgkmcnt(2)
v_mfma_f32_16x16x32_bf16 v[188:191], v[84:87], v[68:71], v[188:191]
v_mfma_f32_16x16x32_bf16 v[184:187], v[84:87], v[64:67], v[184:187]
v_mfma_f32_16x16x32_bf16 v[180:183], v[84:87], v[60:63], v[180:183]
v_mfma_f32_16x16x32_bf16 v[176:179], v[84:87], v[56:59], v[176:179]
s_waitcnt lgkmcnt(0)
s_barrier
v_mfma_f32_16x16x32_bf16 v[192:195], v[72:75], v[56:59], v[192:195]
ds_read_b64_tr_b16 v[40:41], v20 offset:0
v_mfma_f32_16x16x32_bf16 v[196:199], v[72:75], v[60:63], v[196:199]
ds_read_b64_tr_b16 v[42:43], v20 offset:1024
v_mfma_f32_16x16x32_bf16 v[200:203], v[72:75], v[64:67], v[200:203]
ds_read_b64_tr_b16 v[44:45], v21 offset:0
v_mfma_f32_16x16x32_bf16 v[204:207], v[72:75], v[68:71], v[204:207]
ds_read_b64_tr_b16 v[46:47], v21 offset:1024
v_mfma_f32_16x16x32_bf16 v[220:223], v[8:11], v[68:71], v[220:223]
ds_read_b128 v[72:75], v16 offset:0
v_mfma_f32_16x16x32_bf16 v[216:219], v[8:11], v[64:67], v[216:219]
ds_read_b64_tr_b16 v[48:49], v22 offset:0
v_mfma_f32_16x16x32_bf16 v[212:215], v[8:11], v[60:63], v[212:215]
ds_read_b64_tr_b16 v[50:51], v22 offset:1024
v_mfma_f32_16x16x32_bf16 v[208:211], v[8:11], v[56:59], v[208:211]
ds_read_b64_tr_b16 v[52:53], v23 offset:0
v_mfma_f32_16x16x32_bf16 v[224:227], v[12:15], v[56:59], v[224:227]
ds_read_b64_tr_b16 v[54:55], v23 offset:1024
v_mfma_f32_16x16x32_bf16 v[228:231], v[12:15], v[60:63], v[228:231]
ds_read_b128 v[76:79], v16 offset:256
v_mfma_f32_16x16x32_bf16 v[232:235], v[12:15], v[64:67], v[232:235]
ds_read_b128 v[80:83], v16 offset:512
v_mfma_f32_16x16x32_bf16 v[236:239], v[12:15], v[68:71], v[236:239]
v_mfma_f32_16x16x32_bf16 v[252:255], v[30:33], v[68:71], v[252:255]
v_mfma_f32_16x16x32_bf16 v[248:251], v[30:33], v[64:67], v[248:251]
v_mfma_f32_16x16x32_bf16 v[244:247], v[30:33], v[60:63], v[244:247]
v_mfma_f32_16x16x32_bf16 v[240:243], v[30:33], v[56:59], v[240:243]
s_branch Lcj_7
Lcs_6:
s_waitcnt lgkmcnt(4)
v_mfma_f32_32x32x16_bf16 v[128:143], v[40:43], v[48:51], v[128:143]
ds_read_b128 v[72:75], v18 offset:0
v_mfma_f32_32x32x16_bf16 v[144:159], v[40:43], v[52:55], v[144:159]
ds_read_b128 v[80:83], v22 offset:0
v_mfma_f32_32x32x16_bf16 v[160:175], v[44:47], v[48:51], v[160:175]
ds_read_b128 v[84:87], v22 offset:4096
v_mfma_f32_32x32x16_bf16 v[176:191], v[44:47], v[52:55], v[176:191]
ds_read_b128 v[76:79], v18 offset:2048
s_waitcnt lgkmcnt(4)
v_mfma_f32_32x32x16_bf16 v[128:143], v[56:59], v[64:67], v[128:143]
ds_read_b128 v[88:91], v19 offset:0
v_mfma_f32_32x32x16_bf16 v[144:159], v[56:59], v[68:71], v[144:159]
ds_read_b128 v[96:99], v23 offset:0
v_mfma_f32_32x32x16_bf16 v[160:175], v[60:63], v[64:67], v[160:175]
ds_read_b128 v[100:103], v23 offset:4096
v_mfma_f32_32x32x16_bf16 v[176:191], v[60:63], v[68:71], v[176:191]
ds_read_b128 v[92:95], v19 offset:2048
s_add_u32 s53, s53, 32768
s_cmp_ge_u32 s53, 131072
s_cselect_b32 s53, 0, s53
s_waitcnt lgkmcnt(4)
v_mfma_f32_32x32x16_bf16 v[128:143], v[72:75], v[80:83], v[128:143]
v_mfma_f32_32x32x16_bf16 v[144:159], v[72:75], v[84:87], v[144:159]
v_mfma_f32_32x32x16_bf16 v[160:175], v[76:79], v[80:83], v[160:175]
v_mfma_f32_32x32x16_bf16 v[176:191], v[76:79], v[84:87], v[176:191]
s_waitcnt lgkmcnt(0)
s_barrier
v_mfma_f32_32x32x16_bf16 v[128:143], v[88:91], v[96:99], v[128:143]
v_mfma_f32_32x32x16_bf16 v[144:159], v[88:91], v[100:103], v[144:159]
v_mfma_f32_32x32x16_bf16 v[160:175], v[92:95], v[96:99], v[160:175]
v_mfma_f32_32x32x16_bf16 v[176:191], v[92:95], v[100:103], v[176:191]
v_mov_b32 v40, 0x24400
v_mov_b32 v41, 0
ds_write_b32 v40, v41
s_waitcnt vmcnt(0)
v_xor_b32 v32, 0x80000000, v32
v_xor_b32 v33, 0x80000000, v33
s_nop 7
s_nop 7
v_fmac_f32_dpp v128, v14, v32 row_newbcast:0 row_mask:0xf bank_mask:0xf
v_fmac_f32_dpp v144, v14, v33 row_newbcast:0 row_mask:0xf bank_mask:0xf
v_mul_f32_dpp v128, v30, v128 row_newbcast:0 row_mask:0xf bank_mask:0xf
v_mul_f32_dpp v144, v30, v144 row_newbcast:0 row_mask:0xf bank_mask:0xf
v_mov_b32 v104, v128
v_mov_b32 v105, v144
v_fmac_f32_dpp v129, v14, v32 row_newbcast:1 row_mask:0xf bank_mask:0xf
v_fmac_f32_dpp v145, v14, v33 row_newbcast:1 row_mask:0xf bank_mask:0xf
v_mul_f32_dpp v129, v30, v129 row_newbcast:1 row_mask:0xf bank_mask:0xf
v_mul_f32_dpp v145, v30, v145 row_newbcast:1 row_mask:0xf bank_mask:0xf
v_fma_f32 v106, v8, v104, v129
v_fma_f32 v107, v8, v105, v145
v_fma_f32 v106, -v9, v105, v106
v_fma_f32 v107, v9, v104, v107
v_fmac_f32_dpp v130, v14, v32 row_newbcast:2 row_mask:0xf bank_mask:0xf
v_fmac_f32_dpp v146, v14, v33 row_newbcast:2 row_mask:0xf bank_mask:0xf
v_mul_f32_dpp v130, v30, v130 row_newbcast:2 row_mask:0xf bank_mask:0xf
v_mul_f32_dpp v146, v30, v146 row_newbcast:2 row_mask:0xf bank_mask:0xf
v_fma_f32 v104, v8, v106, v130
v_fma_f32 v105, v8, v107, v146
v_fma_f32 v104, -v9, v107, v104
v_fma_f32 v105, v9, v106, v105
v_fmac_f32_dpp v131, v14, v32 row_newbcast:3 row_mask:0xf bank_mask:0xf
v_fmac_f32_dpp v147, v14, v33 row_newbcast:3 row_mask:0xf bank_mask:0xf
v_mul_f32_dpp v131, v30, v131 row_newbcast:3 row_mask:0xf bank_mask:0xf
v_mul_f32_dpp v147, v30, v147 row_newbcast:3 row_mask:0xf bank_mask:0xf
v_fma_f32 v106, v8, v104, v131
v_fma_f32 v107, v8, v105, v147
v_fma_f32 v106, -v9, v105, v106
v_fma_f32 v107, v9, v104, v107
v_fmac_f32_dpp v132, v14, v32 row_newbcast:4 row_mask:0xf bank_mask:0xf
v_fmac_f32_dpp v148, v14, v33 row_newbcast:4 row_mask:0xf bank_mask:0xf
v_mul_f32_dpp v132, v30, v132 row_newbcast:4 row_mask:0xf bank_mask:0xf
v_mul_f32_dpp v148, v30, v148 row_newbcast:4 row_mask:0xf bank_mask:0xf
v_fma_f32 v104, v8, v106, v132
v_fma_f32 v105, v8, v107, v148
v_fma_f32 v104, -v9, v107, v104
v_fma_f32 v105, v9, v106, v105
v_fmac_f32_dpp v133, v14, v32 row_newbcast:5 row_mask:0xf bank_mask:0xf
v_fmac_f32_dpp v149, v14, v33 row_newbcast:5 row_mask:0xf bank_mask:0xf
v_mul_f32_dpp v133, v30, v133 row_newbcast:5 row_mask:0xf bank_mask:0xf
v_mul_f32_dpp v149, v30, v149 row_newbcast:5 row_mask:0xf bank_mask:0xf
v_fma_f32 v106, v8, v104, v133
v_fma_f32 v107, v8, v105, v149
v_fma_f32 v106, -v9, v105, v106
v_fma_f32 v107, v9, v104, v107
v_fmac_f32_dpp v134, v14, v32 row_newbcast:6 row_mask:0xf bank_mask:0xf
v_fmac_f32_dpp v150, v14, v33 row_newbcast:6 row_mask:0xf bank_mask:0xf
v_mul_f32_dpp v134, v30, v134 row_newbcast:6 row_mask:0xf bank_mask:0xf
v_mul_f32_dpp v150, v30, v150 row_newbcast:6 row_mask:0xf bank_mask:0xf
v_fma_f32 v104, v8, v106, v134
v_fma_f32 v105, v8, v107, v150
v_fma_f32 v104, -v9, v107, v104
v_fma_f32 v105, v9, v106, v105
v_fmac_f32_dpp v135, v14, v32 row_newbcast:7 row_mask:0xf bank_mask:0xf
v_fmac_f32_dpp v151, v14, v33 row_newbcast:7 row_mask:0xf bank_mask:0xf
v_mul_f32_dpp v135, v30, v135 row_newbcast:7 row_mask:0xf bank_mask:0xf
v_mul_f32_dpp v151, v30, v151 row_newbcast:7 row_mask:0xf bank_mask:0xf
v_fma_f32 v106, v8, v104, v135
v_fma_f32 v107, v8, v105, v151
v_fma_f32 v106, -v9, v105, v106
v_fma_f32 v107, v9, v104, v107
v_fmac_f32_dpp v136, v14, v32 row_newbcast:8 row_mask:0xf bank_mask:0xf
v_fmac_f32_dpp v152, v14, v33 row_newbcast:8 row_mask:0xf bank_mask:0xf
v_mul_f32_dpp v136, v30, v136 row_newbcast:8 row_mask:0xf bank_mask:0xf
v_mul_f32_dpp v152, v30, v152 row_newbcast:8 row_mask:0xf bank_mask:0xf
v_fma_f32 v104, v8, v106, v136
v_fma_f32 v105, v8, v107, v152
v_fma_f32 v104, -v9, v107, v104
v_fma_f32 v105, v9, v106, v105
v_fmac_f32_dpp v137, v14, v32 row_newbcast:9 row_mask:0xf bank_mask:0xf
v_fmac_f32_dpp v153, v14, v33 row_newbcast:9 row_mask:0xf bank_mask:0xf
v_mul_f32_dpp v137, v30, v137 row_newbcast:9 row_mask:0xf bank_mask:0xf
v_mul_f32_dpp v153, v30, v153 row_newbcast:9 row_mask:0xf bank_mask:0xf
v_fma_f32 v106, v8, v104, v137
v_fma_f32 v107, v8, v105, v153
v_fma_f32 v106, -v9, v105, v106
v_fma_f32 v107, v9, v104, v107
v_fmac_f32_dpp v138, v14, v32 row_newbcast:10 row_mask:0xf bank_mask:0xf
v_fmac_f32_dpp v154, v14, v33 row_newbcast:10 row_mask:0xf bank_mask:0xf
v_mul_f32_dpp v138, v30, v138 row_newbcast:10 row_mask:0xf bank_mask:0xf
v_mul_f32_dpp v154, v30, v154 row_newbcast:10 row_mask:0xf bank_mask:0xf
v_fma_f32 v104, v8, v106, v138
v_fma_f32 v105, v8, v107, v154
v_fma_f32 v104, -v9, v107, v104
v_fma_f32 v105, v9, v106, v105
v_fmac_f32_dpp v139, v14, v32 row_newbcast:11 row_mask:0xf bank_mask:0xf
v_fmac_f32_dpp v155, v14, v33 row_newbcast:11 row_mask:0xf bank_mask:0xf
v_mul_f32_dpp v139, v30, v139 row_newbcast:11 row_mask:0xf bank_mask:0xf
v_mul_f32_dpp v155, v30, v155 row_newbcast:11 row_mask:0xf bank_mask:0xf
v_fma_f32 v106, v8, v104, v139
v_fma_f32 v107, v8, v105, v155
v_fma_f32 v106, -v9, v105, v106
v_fma_f32 v107, v9, v104, v107
v_fmac_f32_dpp v140, v14, v32 row_newbcast:12 row_mask:0xf bank_mask:0xf
v_fmac_f32_dpp v156, v14, v33 row_newbcast:12 row_mask:0xf bank_mask:0xf
v_mul_f32_dpp v140, v30, v140 row_newbcast:12 row_mask:0xf bank_mask:0xf
v_mul_f32_dpp v156, v30, v156 row_newbcast:12 row_mask:0xf bank_mask:0xf
v_fma_f32 v104, v8, v106, v140
v_fma_f32 v105, v8, v107, v156
v_fma_f32 v104, -v9, v107, v104
v_fma_f32 v105, v9, v106, v105
v_fmac_f32_dpp v141, v14, v32 row_newbcast:13 row_mask:0xf bank_mask:0xf
v_fmac_f32_dpp v157, v14, v33 row_newbcast:13 row_mask:0xf bank_mask:0xf
v_mul_f32_dpp v141, v30, v141 row_newbcast:13 row_mask:0xf bank_mask:0xf
v_mul_f32_dpp v157, v30, v157 row_newbcast:13 row_mask:0xf bank_mask:0xf
v_fma_f32 v106, v8, v104, v141
v_fma_f32 v107, v8, v105, v157
v_fma_f32 v106, -v9, v105, v106
v_fma_f32 v107, v9, v104, v107
v_fmac_f32_dpp v142, v14, v32 row_newbcast:14 row_mask:0xf bank_mask:0xf
v_fmac_f32_dpp v158, v14, v33 row_newbcast:14 row_mask:0xf bank_mask:0xf
v_mul_f32_dpp v142, v30, v142 row_newbcast:14 row_mask:0xf bank_mask:0xf
v_mul_f32_dpp v158, v30, v158 row_newbcast:14 row_mask:0xf bank_mask:0xf
v_fma_f32 v104, v8, v106, v142
v_fma_f32 v105, v8, v107, v158
v_fma_f32 v104, -v9, v107, v104
v_fma_f32 v105, v9, v106, v105
v_fmac_f32_dpp v143, v14, v32 row_newbcast:15 row_mask:0xf bank_mask:0xf
v_fmac_f32_dpp v159, v14, v33 row_newbcast:15 row_mask:0xf bank_mask:0xf
v_mul_f32_dpp v143, v30, v143 row_newbcast:15 row_mask:0xf bank_mask:0xf
v_mul_f32_dpp v159, v30, v159 row_newbcast:15 row_mask:0xf bank_mask:0xf
v_fma_f32 v106, v8, v104, v143
v_fma_f32 v107, v8, v105, v159
v_fma_f32 v106, -v9, v105, v106
v_fma_f32 v107, v9, v104, v107
v_fmac_f32_dpp v160, v15, v32 row_newbcast:0 row_mask:0xf bank_mask:0xf
v_fmac_f32_dpp v176, v15, v33 row_newbcast:0 row_mask:0xf bank_mask:0xf
v_mul_f32_dpp v160, v31, v160 row_newbcast:0 row_mask:0xf bank_mask:0xf
v_mul_f32_dpp v176, v31, v176 row_newbcast:0 row_mask:0xf bank_mask:0xf
v_fma_f32 v104, v8, v106, v160
v_fma_f32 v105, v8, v107, v176
v_fma_f32 v104, -v9, v107, v104
v_fma_f32 v105, v9, v106, v105
v_fmac_f32_dpp v161, v15, v32 row_newbcast:1 row_mask:0xf bank_mask:0xf
v_fmac_f32_dpp v177, v15, v33 row_newbcast:1 row_mask:0xf bank_mask:0xf
v_mul_f32_dpp v161, v31, v161 row_newbcast:1 row_mask:0xf bank_mask:0xf
v_mul_f32_dpp v177, v31, v177 row_newbcast:1 row_mask:0xf bank_mask:0xf
v_fma_f32 v106, v8, v104, v161
v_fma_f32 v107, v8, v105, v177
v_fma_f32 v106, -v9, v105, v106
v_fma_f32 v107, v9, v104, v107
v_fmac_f32_dpp v162, v15, v32 row_newbcast:2 row_mask:0xf bank_mask:0xf
v_fmac_f32_dpp v178, v15, v33 row_newbcast:2 row_mask:0xf bank_mask:0xf
v_mul_f32_dpp v162, v31, v162 row_newbcast:2 row_mask:0xf bank_mask:0xf
v_mul_f32_dpp v178, v31, v178 row_newbcast:2 row_mask:0xf bank_mask:0xf
v_fma_f32 v104, v8, v106, v162
v_fma_f32 v105, v8, v107, v178
v_fma_f32 v104, -v9, v107, v104
v_fma_f32 v105, v9, v106, v105
v_fmac_f32_dpp v163, v15, v32 row_newbcast:3 row_mask:0xf bank_mask:0xf
v_fmac_f32_dpp v179, v15, v33 row_newbcast:3 row_mask:0xf bank_mask:0xf
v_mul_f32_dpp v163, v31, v163 row_newbcast:3 row_mask:0xf bank_mask:0xf
v_mul_f32_dpp v179, v31, v179 row_newbcast:3 row_mask:0xf bank_mask:0xf
v_fma_f32 v106, v8, v104, v163
v_fma_f32 v107, v8, v105, v179
v_fma_f32 v106, -v9, v105, v106
v_fma_f32 v107, v9, v104, v107
v_fmac_f32_dpp v164, v15, v32 row_newbcast:4 row_mask:0xf bank_mask:0xf
v_fmac_f32_dpp v180, v15, v33 row_newbcast:4 row_mask:0xf bank_mask:0xf
v_mul_f32_dpp v164, v31, v164 row_newbcast:4 row_mask:0xf bank_mask:0xf
v_mul_f32_dpp v180, v31, v180 row_newbcast:4 row_mask:0xf bank_mask:0xf
v_fma_f32 v104, v8, v106, v164
v_fma_f32 v105, v8, v107, v180
v_fma_f32 v104, -v9, v107, v104
v_fma_f32 v105, v9, v106, v105
v_fmac_f32_dpp v165, v15, v32 row_newbcast:5 row_mask:0xf bank_mask:0xf
v_fmac_f32_dpp v181, v15, v33 row_newbcast:5 row_mask:0xf bank_mask:0xf
v_mul_f32_dpp v165, v31, v165 row_newbcast:5 row_mask:0xf bank_mask:0xf
v_mul_f32_dpp v181, v31, v181 row_newbcast:5 row_mask:0xf bank_mask:0xf
v_fma_f32 v106, v8, v104, v165
v_fma_f32 v107, v8, v105, v181
v_fma_f32 v106, -v9, v105, v106
v_fma_f32 v107, v9, v104, v107
v_fmac_f32_dpp v166, v15, v32 row_newbcast:6 row_mask:0xf bank_mask:0xf
v_fmac_f32_dpp v182, v15, v33 row_newbcast:6 row_mask:0xf bank_mask:0xf
v_mul_f32_dpp v166, v31, v166 row_newbcast:6 row_mask:0xf bank_mask:0xf
v_mul_f32_dpp v182, v31, v182 row_newbcast:6 row_mask:0xf bank_mask:0xf
v_fma_f32 v104, v8, v106, v166
v_fma_f32 v105, v8, v107, v182
v_fma_f32 v104, -v9, v107, v104
v_fma_f32 v105, v9, v106, v105
v_fmac_f32_dpp v167, v15, v32 row_newbcast:7 row_mask:0xf bank_mask:0xf
v_fmac_f32_dpp v183, v15, v33 row_newbcast:7 row_mask:0xf bank_mask:0xf
v_mul_f32_dpp v167, v31, v167 row_newbcast:7 row_mask:0xf bank_mask:0xf
v_mul_f32_dpp v183, v31, v183 row_newbcast:7 row_mask:0xf bank_mask:0xf
v_fma_f32 v106, v8, v104, v167
v_fma_f32 v107, v8, v105, v183
v_fma_f32 v106, -v9, v105, v106
v_fma_f32 v107, v9, v104, v107
v_fmac_f32_dpp v168, v15, v32 row_newbcast:8 row_mask:0xf bank_mask:0xf
v_fmac_f32_dpp v184, v15, v33 row_newbcast:8 row_mask:0xf bank_mask:0xf
v_mul_f32_dpp v168, v31, v168 row_newbcast:8 row_mask:0xf bank_mask:0xf
v_mul_f32_dpp v184, v31, v184 row_newbcast:8 row_mask:0xf bank_mask:0xf
v_fma_f32 v104, v8, v106, v168
v_fma_f32 v105, v8, v107, v184
v_fma_f32 v104, -v9, v107, v104
v_fma_f32 v105, v9, v106, v105
v_fmac_f32_dpp v169, v15, v32 row_newbcast:9 row_mask:0xf bank_mask:0xf
v_fmac_f32_dpp v185, v15, v33 row_newbcast:9 row_mask:0xf bank_mask:0xf
v_mul_f32_dpp v169, v31, v169 row_newbcast:9 row_mask:0xf bank_mask:0xf
v_mul_f32_dpp v185, v31, v185 row_newbcast:9 row_mask:0xf bank_mask:0xf
v_fma_f32 v106, v8, v104, v169
v_fma_f32 v107, v8, v105, v185
v_fma_f32 v106, -v9, v105, v106
v_fma_f32 v107, v9, v104, v107
v_fmac_f32_dpp v170, v15, v32 row_newbcast:10 row_mask:0xf bank_mask:0xf
v_fmac_f32_dpp v186, v15, v33 row_newbcast:10 row_mask:0xf bank_mask:0xf
v_mul_f32_dpp v170, v31, v170 row_newbcast:10 row_mask:0xf bank_mask:0xf
v_mul_f32_dpp v186, v31, v186 row_newbcast:10 row_mask:0xf bank_mask:0xf
v_fma_f32 v104, v8, v106, v170
v_fma_f32 v105, v8, v107, v186
v_fma_f32 v104, -v9, v107, v104
v_fma_f32 v105, v9, v106, v105
v_fmac_f32_dpp v171, v15, v32 row_newbcast:11 row_mask:0xf bank_mask:0xf
v_fmac_f32_dpp v187, v15, v33 row_newbcast:11 row_mask:0xf bank_mask:0xf
v_mul_f32_dpp v171, v31, v171 row_newbcast:11 row_mask:0xf bank_mask:0xf
v_mul_f32_dpp v187, v31, v187 row_newbcast:11 row_mask:0xf bank_mask:0xf
v_fma_f32 v106, v8, v104, v171
v_fma_f32 v107, v8, v105, v187
v_fma_f32 v106, -v9, v105, v106
v_fma_f32 v107, v9, v104, v107
v_fmac_f32_dpp v172, v15, v32 row_newbcast:12 row_mask:0xf bank_mask:0xf
v_fmac_f32_dpp v188, v15, v33 row_newbcast:12 row_mask:0xf bank_mask:0xf
v_mul_f32_dpp v172, v31, v172 row_newbcast:12 row_mask:0xf bank_mask:0xf
v_mul_f32_dpp v188, v31, v188 row_newbcast:12 row_mask:0xf bank_mask:0xf
v_fma_f32 v104, v8, v106, v172
v_fma_f32 v105, v8, v107, v188
v_fma_f32 v104, -v9, v107, v104
v_fma_f32 v105, v9, v106, v105
v_fmac_f32_dpp v173, v15, v32 row_newbcast:13 row_mask:0xf bank_mask:0xf
v_fmac_f32_dpp v189, v15, v33 row_newbcast:13 row_mask:0xf bank_mask:0xf
v_mul_f32_dpp v173, v31, v173 row_newbcast:13 row_mask:0xf bank_mask:0xf
v_mul_f32_dpp v189, v31, v189 row_newbcast:13 row_mask:0xf bank_mask:0xf
v_fma_f32 v106, v8, v104, v173
v_fma_f32 v107, v8, v105, v189
v_fma_f32 v106, -v9, v105, v106
v_fma_f32 v107, v9, v104, v107
v_fmac_f32_dpp v174, v15, v32 row_newbcast:14 row_mask:0xf bank_mask:0xf
v_fmac_f32_dpp v190, v15, v33 row_newbcast:14 row_mask:0xf bank_mask:0xf
v_mul_f32_dpp v174, v31, v174 row_newbcast:14 row_mask:0xf bank_mask:0xf
v_mul_f32_dpp v190, v31, v190 row_newbcast:14 row_mask:0xf bank_mask:0xf
v_fma_f32 v104, v8, v106, v174
v_fma_f32 v105, v8, v107, v190
v_fma_f32 v104, -v9, v107, v104
v_fma_f32 v105, v9, v106, v105
v_fmac_f32_dpp v175, v15, v32 row_newbcast:15 row_mask:0xf bank_mask:0xf
v_fmac_f32_dpp v191, v15, v33 row_newbcast:15 row_mask:0xf bank_mask:0xf
v_mul_f32_dpp v175, v31, v175 row_newbcast:15 row_mask:0xf bank_mask:0xf
v_mul_f32_dpp v191, v31, v191 row_newbcast:15 row_mask:0xf bank_mask:0xf
v_fma_f32 v106, v8, v104, v175
v_fma_f32 v107, v8, v105, v191
v_fma_f32 v106, -v9, v105, v106
v_fma_f32 v107, v9, v104, v107
v_mov_b32 v34, v106
v_mov_b32 v35, v107
s_nop 1
v_permlane32_swap_b32 v34, v106
v_permlane32_swap_b32 v35, v107
s_nop 1
v_fma_f32 v110, v12, v34, v106
v_fma_f32 v111, v12, v35, v107
v_fma_f32 v110, -v13, v35, v110
v_fma_f32 v111, v13, v34, v111
s_lshl_b32 s51, s3, 8
s_add_u32 s51, s51, 0x24d00
v_add_u32 v38, s51, v7
ds_write_b64 v38, v[110:111]
s_waitcnt lgkmcnt(0)
s_barrier
v_lshrrev_b32 v2, 5, v1
v_lshlrev_b32 v2, 12, v2
v_lshl_add_u32 v2, v7, 1, v2
s_lshl_b32 s81, s42, 5
s_add_u32 s81, s81, s80
s_lshl_b32 s81, s81, 4
s_add_u32 s81, s81, s23
s_lshl_b32 s81, s81, 9
s_add_u32 s82, s81, 0x400000
v_and_b32 v36, 15, v1
v_lshrrev_b32 v3, 4, v1
v_bfe_u32 v4, v36, 2, 1
v_lshlrev_b32 v4, 5, v4
v_lshrrev_b32 v37, 3, v36
v_lshl_add_u32 v4, v37, 2, v4
v_and_b32 v36, 3, v36
v_add_u32 v36, v36, v4
v_bfe_u32 v4, v36, 1, 2
v_bfe_u32 v37, v36, 5, 1
v_lshl_add_u32 v4, v37, 2, v4
s_lshl_b32 s48, s22, 6
v_add_u32 v36, s48, v36
v_xor_b32 v3, v3, v4
v_lshlrev_b32 v3, 4, v3
v_lshl_add_u32 v36, v36, 7, v3
v_add_u32 v24, 0, v36
s_barrier
ds_read_b64 v[104:105], v38 offset:1024
s_waitcnt lgkmcnt(0)
v_fma_f32 v106, v12, v104, v34
v_fma_f32 v107, v12, v105, v35
v_fma_f32 v106, -v13, v105, v106
v_fma_f32 v107, v13, v104, v107
v_cmp_lt_u32 vcc, 31, v1
s_nop 1
v_cndmask_b32 v104, v104, v106, vcc
v_cndmask_b32 v105, v105, v107, vcc
v_fma_f32 v106, v8, v104, v128
v_fma_f32 v107, v8, v105, v144
v_fma_f32 v106, -v9, v105, v106
v_fma_f32 v107, v9, v104, v107
v_mul_f32 v128, v10, v106
v_mul_f32 v144, v10, v107
v_fma_f32 v128, -v11, v107, v128
v_fma_f32 v144, -v11, v106, -v144
v_fma_f32 v104, v8, v106, v129
v_fma_f32 v105, v8, v107, v145
v_fma_f32 v104, -v9, v107, v104
v_fma_f32 v105, v9, v106, v105
v_mul_f32 v129, v10, v104
v_mul_f32 v145, v10, v105
v_fma_f32 v129, -v11, v105, v129
v_fma_f32 v145, -v11, v104, -v145
v_fma_f32 v106, v8, v104, v130
v_fma_f32 v107, v8, v105, v146
v_fma_f32 v106, -v9, v105, v106
v_fma_f32 v107, v9, v104, v107
v_mul_f32 v130, v10, v106
v_mul_f32 v146, v10, v107
v_fma_f32 v130, -v11, v107, v130
v_fma_f32 v146, -v11, v106, -v146
v_fma_f32 v104, v8, v106, v131
v_fma_f32 v105, v8, v107, v147
v_fma_f32 v104, -v9, v107, v104
v_fma_f32 v105, v9, v106, v105
v_mul_f32 v131, v10, v104
v_mul_f32 v147, v10, v105
v_fma_f32 v131, -v11, v105, v131
v_fma_f32 v147, -v11, v104, -v147
v_fma_f32 v106, v8, v104, v132
v_fma_f32 v107, v8, v105, v148
v_fma_f32 v106, -v9, v105, v106
v_fma_f32 v107, v9, v104, v107
v_mul_f32 v132, v10, v106
v_mul_f32 v148, v10, v107
v_fma_f32 v132, -v11, v107, v132
v_fma_f32 v148, -v11, v106, -v148
v_fma_f32 v104, v8, v106, v133
v_fma_f32 v105, v8, v107, v149
v_fma_f32 v104, -v9, v107, v104
v_fma_f32 v105, v9, v106, v105
v_mul_f32 v133, v10, v104
v_mul_f32 v149, v10, v105
v_fma_f32 v133, -v11, v105, v133
v_fma_f32 v149, -v11, v104, -v149
v_fma_f32 v106, v8, v104, v134
v_fma_f32 v107, v8, v105, v150
v_fma_f32 v106, -v9, v105, v106
v_fma_f32 v107, v9, v104, v107
v_mul_f32 v134, v10, v106
v_mul_f32 v150, v10, v107
v_fma_f32 v134, -v11, v107, v134
v_fma_f32 v150, -v11, v106, -v150
v_fma_f32 v104, v8, v106, v135
v_fma_f32 v105, v8, v107, v151
v_fma_f32 v104, -v9, v107, v104
v_fma_f32 v105, v9, v106, v105
v_mul_f32 v135, v10, v104
v_mul_f32 v151, v10, v105
v_fma_f32 v135, -v11, v105, v135
v_fma_f32 v151, -v11, v104, -v151
v_cvt_pk_bf16_f32 v128, v128, v129
v_cvt_pk_bf16_f32 v129, v130, v131
v_cvt_pk_bf16_f32 v130, v132, v133
v_cvt_pk_bf16_f32 v131, v134, v135
buffer_store_dwordx4 v[128:131], v2, s[64:67], s81 offen offset:0 sc1
v_cvt_pk_bf16_f32 v144, v144, v145
v_cvt_pk_bf16_f32 v145, v146, v147
v_cvt_pk_bf16_f32 v146, v148, v149
v_cvt_pk_bf16_f32 v147, v150, v151
buffer_store_dwordx4 v[144:147], v2, s[64:67], s82 offen offset:0 sc1
v_fma_f32 v106, v8, v104, v136
v_fma_f32 v107, v8, v105, v152
v_fma_f32 v106, -v9, v105, v106
v_fma_f32 v107, v9, v104, v107
v_mul_f32 v136, v10, v106
v_mul_f32 v152, v10, v107
v_fma_f32 v136, -v11, v107, v136
v_fma_f32 v152, -v11, v106, -v152
v_fma_f32 v104, v8, v106, v137
v_fma_f32 v105, v8, v107, v153
v_fma_f32 v104, -v9, v107, v104
v_fma_f32 v105, v9, v106, v105
v_mul_f32 v137, v10, v104
v_mul_f32 v153, v10, v105
v_fma_f32 v137, -v11, v105, v137
v_fma_f32 v153, -v11, v104, -v153
v_fma_f32 v106, v8, v104, v138
v_fma_f32 v107, v8, v105, v154
v_fma_f32 v106, -v9, v105, v106
v_fma_f32 v107, v9, v104, v107
v_mul_f32 v138, v10, v106
v_mul_f32 v154, v10, v107
v_fma_f32 v138, -v11, v107, v138
v_fma_f32 v154, -v11, v106, -v154
v_fma_f32 v104, v8, v106, v139
v_fma_f32 v105, v8, v107, v155
v_fma_f32 v104, -v9, v107, v104
v_fma_f32 v105, v9, v106, v105
v_mul_f32 v139, v10, v104
v_mul_f32 v155, v10, v105
v_fma_f32 v139, -v11, v105, v139
v_fma_f32 v155, -v11, v104, -v155
v_fma_f32 v106, v8, v104, v140
v_fma_f32 v107, v8, v105, v156
v_fma_f32 v106, -v9, v105, v106
v_fma_f32 v107, v9, v104, v107
v_mul_f32 v140, v10, v106
v_mul_f32 v156, v10, v107
v_fma_f32 v140, -v11, v107, v140
v_fma_f32 v156, -v11, v106, -v156
v_fma_f32 v104, v8, v106, v141
v_fma_f32 v105, v8, v107, v157
v_fma_f32 v104, -v9, v107, v104
v_fma_f32 v105, v9, v106, v105
v_mul_f32 v141, v10, v104
v_mul_f32 v157, v10, v105
v_fma_f32 v141, -v11, v105, v141
v_fma_f32 v157, -v11, v104, -v157
v_fma_f32 v106, v8, v104, v142
v_fma_f32 v107, v8, v105, v158
v_fma_f32 v106, -v9, v105, v106
v_fma_f32 v107, v9, v104, v107
v_mul_f32 v142, v10, v106
v_mul_f32 v158, v10, v107
v_fma_f32 v142, -v11, v107, v142
v_fma_f32 v158, -v11, v106, -v158
v_fma_f32 v104, v8, v106, v143
v_fma_f32 v105, v8, v107, v159
v_fma_f32 v104, -v9, v107, v104
v_fma_f32 v105, v9, v106, v105
v_mul_f32 v143, v10, v104
v_mul_f32 v159, v10, v105
v_fma_f32 v143, -v11, v105, v143
v_fma_f32 v159, -v11, v104, -v159
v_cvt_pk_bf16_f32 v136, v136, v137
v_cvt_pk_bf16_f32 v137, v138, v139
v_cvt_pk_bf16_f32 v138, v140, v141
v_cvt_pk_bf16_f32 v139, v142, v143
buffer_store_dwordx4 v[136:139], v2, s[64:67], s81 offen offset:1024 sc1
v_cvt_pk_bf16_f32 v152, v152, v153
v_cvt_pk_bf16_f32 v153, v154, v155
v_cvt_pk_bf16_f32 v154, v156, v157
v_cvt_pk_bf16_f32 v155, v158, v159
buffer_store_dwordx4 v[152:155], v2, s[64:67], s82 offen offset:1024 sc1
v_fma_f32 v106, v8, v104, v160
v_fma_f32 v107, v8, v105, v176
v_fma_f32 v106, -v9, v105, v106
v_fma_f32 v107, v9, v104, v107
v_mul_f32 v160, v10, v106
v_mul_f32 v176, v10, v107
v_fma_f32 v160, -v11, v107, v160
v_fma_f32 v176, -v11, v106, -v176
v_fma_f32 v104, v8, v106, v161
v_fma_f32 v105, v8, v107, v177
v_fma_f32 v104, -v9, v107, v104
v_fma_f32 v105, v9, v106, v105
v_mul_f32 v161, v10, v104
v_mul_f32 v177, v10, v105
v_fma_f32 v161, -v11, v105, v161
v_fma_f32 v177, -v11, v104, -v177
v_fma_f32 v106, v8, v104, v162
v_fma_f32 v107, v8, v105, v178
v_fma_f32 v106, -v9, v105, v106
v_fma_f32 v107, v9, v104, v107
v_mul_f32 v162, v10, v106
v_mul_f32 v178, v10, v107
v_fma_f32 v162, -v11, v107, v162
v_fma_f32 v178, -v11, v106, -v178
v_fma_f32 v104, v8, v106, v163
v_fma_f32 v105, v8, v107, v179
v_fma_f32 v104, -v9, v107, v104
v_fma_f32 v105, v9, v106, v105
v_mul_f32 v163, v10, v104
v_mul_f32 v179, v10, v105
v_fma_f32 v163, -v11, v105, v163
v_fma_f32 v179, -v11, v104, -v179
v_fma_f32 v106, v8, v104, v164
v_fma_f32 v107, v8, v105, v180
v_fma_f32 v106, -v9, v105, v106
v_fma_f32 v107, v9, v104, v107
v_mul_f32 v164, v10, v106
v_mul_f32 v180, v10, v107
v_fma_f32 v164, -v11, v107, v164
v_fma_f32 v180, -v11, v106, -v180
v_fma_f32 v104, v8, v106, v165
v_fma_f32 v105, v8, v107, v181
v_fma_f32 v104, -v9, v107, v104
v_fma_f32 v105, v9, v106, v105
v_mul_f32 v165, v10, v104
v_mul_f32 v181, v10, v105
v_fma_f32 v165, -v11, v105, v165
v_fma_f32 v181, -v11, v104, -v181
v_fma_f32 v106, v8, v104, v166
v_fma_f32 v107, v8, v105, v182
v_fma_f32 v106, -v9, v105, v106
v_fma_f32 v107, v9, v104, v107
v_mul_f32 v166, v10, v106
v_mul_f32 v182, v10, v107
v_fma_f32 v166, -v11, v107, v166
v_fma_f32 v182, -v11, v106, -v182
v_fma_f32 v104, v8, v106, v167
v_fma_f32 v105, v8, v107, v183
v_fma_f32 v104, -v9, v107, v104
v_fma_f32 v105, v9, v106, v105
v_mul_f32 v167, v10, v104
v_mul_f32 v183, v10, v105
v_fma_f32 v167, -v11, v105, v167
v_fma_f32 v183, -v11, v104, -v183
v_cvt_pk_bf16_f32 v160, v160, v161
v_cvt_pk_bf16_f32 v161, v162, v163
v_cvt_pk_bf16_f32 v162, v164, v165
v_cvt_pk_bf16_f32 v163, v166, v167
buffer_store_dwordx4 v[160:163], v2, s[64:67], s81 offen offset:2048 sc1
v_cvt_pk_bf16_f32 v176, v176, v177
v_cvt_pk_bf16_f32 v177, v178, v179
v_cvt_pk_bf16_f32 v178, v180, v181
v_cvt_pk_bf16_f32 v179, v182, v183
buffer_store_dwordx4 v[176:179], v2, s[64:67], s82 offen offset:2048 sc1
v_fma_f32 v106, v8, v104, v168
v_fma_f32 v107, v8, v105, v184
v_fma_f32 v106, -v9, v105, v106
v_fma_f32 v107, v9, v104, v107
v_mul_f32 v168, v10, v106
v_mul_f32 v184, v10, v107
v_fma_f32 v168, -v11, v107, v168
v_fma_f32 v184, -v11, v106, -v184
v_fma_f32 v104, v8, v106, v169
v_fma_f32 v105, v8, v107, v185
v_fma_f32 v104, -v9, v107, v104
v_fma_f32 v105, v9, v106, v105
v_mul_f32 v169, v10, v104
v_mul_f32 v185, v10, v105
v_fma_f32 v169, -v11, v105, v169
v_fma_f32 v185, -v11, v104, -v185
v_fma_f32 v106, v8, v104, v170
v_fma_f32 v107, v8, v105, v186
v_fma_f32 v106, -v9, v105, v106
v_fma_f32 v107, v9, v104, v107
v_mul_f32 v170, v10, v106
v_mul_f32 v186, v10, v107
v_fma_f32 v170, -v11, v107, v170
v_fma_f32 v186, -v11, v106, -v186
v_fma_f32 v104, v8, v106, v171
v_fma_f32 v105, v8, v107, v187
v_fma_f32 v104, -v9, v107, v104
v_fma_f32 v105, v9, v106, v105
v_mul_f32 v171, v10, v104
v_mul_f32 v187, v10, v105
v_fma_f32 v171, -v11, v105, v171
v_fma_f32 v187, -v11, v104, -v187
v_fma_f32 v106, v8, v104, v172
v_fma_f32 v107, v8, v105, v188
v_fma_f32 v106, -v9, v105, v106
v_fma_f32 v107, v9, v104, v107
v_mul_f32 v172, v10, v106
v_mul_f32 v188, v10, v107
v_fma_f32 v172, -v11, v107, v172
v_fma_f32 v188, -v11, v106, -v188
v_fma_f32 v104, v8, v106, v173
v_fma_f32 v105, v8, v107, v189
v_fma_f32 v104, -v9, v107, v104
v_fma_f32 v105, v9, v106, v105
v_mul_f32 v173, v10, v104
v_mul_f32 v189, v10, v105
v_fma_f32 v173, -v11, v105, v173
v_fma_f32 v189, -v11, v104, -v189
v_fma_f32 v106, v8, v104, v174
v_fma_f32 v107, v8, v105, v190
v_fma_f32 v106, -v9, v105, v106
v_fma_f32 v107, v9, v104, v107
v_mul_f32 v174, v10, v106
v_mul_f32 v190, v10, v107
v_fma_f32 v174, -v11, v107, v174
v_fma_f32 v190, -v11, v106, -v190
v_fma_f32 v104, v8, v106, v175
v_fma_f32 v105, v8, v107, v191
v_fma_f32 v104, -v9, v107, v104
v_fma_f32 v105, v9, v106, v105
v_mul_f32 v175, v10, v104
v_mul_f32 v191, v10, v105
v_fma_f32 v175, -v11, v105, v175
v_fma_f32 v191, -v11, v104, -v191
v_cvt_pk_bf16_f32 v168, v168, v169
v_cvt_pk_bf16_f32 v169, v170, v171
v_cvt_pk_bf16_f32 v170, v172, v173
v_cvt_pk_bf16_f32 v171, v174, v175
buffer_store_dwordx4 v[168:171], v2, s[64:67], s81 offen offset:3072 sc1
v_cvt_pk_bf16_f32 v184, v184, v185
v_cvt_pk_bf16_f32 v185, v186, v187
v_cvt_pk_bf16_f32 v186, v188, v189
v_cvt_pk_bf16_f32 v187, v190, v191
buffer_store_dwordx4 v[184:187], v2, s[64:67], s82 offen offset:3072 sc1
s_mov_b32 s84, 0
s_cmp_lg_u32 s84, 0
s_cbranch_scc1 Lf_14
s_waitcnt vmcnt(0)
v_mov_b32 v36, 0
v_mov_b32 v3, 1
s_mov_b64 exec, 1
buffer_store_dword v3, v36, s[60:63], s76 offen sc1
s_mov_b64 exec, -1
s_mov_b32 s84, 1
Lf_14:
s_lshl_b32 s81, s46, 1
s_and_b32 s48, s45, 1
s_add_u32 s81, s81, s48
s_lshl_b32 s81, s81, 7
s_add_u32 s81, s81, 4096
v_lshlrev_b32 v54, 2, v1
s_cmp_lg_u32 s3, 0
s_cbranch_scc1 Lw_17
s_mov_b32 exec_lo, -1
s_mov_b32 exec_hi, 0
buffer_load_dword v53, v54, s[60:63], s81 offen offset:0 sc1
s_mov_b32 exec_lo, -1
s_mov_b32 exec_hi, 0
s_mov_b32 s50, 32768
s_waitcnt vmcnt(0)
Lcp_15:
v_cmp_ne_u32 vcc, 1, v53
s_nop 1
s_cbranch_vccz Lco_16
s_sleep 16
buffer_load_dword v53, v54, s[60:63], s81 offen offset:0 sc1
s_waitcnt vmcnt(0)
s_sub_u32 s50, s50, 1
s_cbranch_scc0 Lcp_15
Lco_16:
s_mov_b64 exec, -1
v_mov_b32 v41, 0x40000000
ds_write_b32 v40, v41
s_waitcnt lgkmcnt(0)
Lw_17:
s_barrier
v_add_u32 v16, s53, v24
v_xor_b32 v17, 0x40, v16
v_add_u32 v20, s53, v28
v_xor_b32 v21, 0x40, v20
v_xor_b32 v22, 0x80, v20
v_xor_b32 v23, 0xc0, v20
s_waitcnt lgkmcnt(0)
s_barrier
ds_read_b64_tr_b16 v[40:41], v20 offset:0
ds_read_b64_tr_b16 v[42:43], v21 offset:0
ds_read_b64_tr_b16 v[44:45], v22 offset:2048
ds_read_b64_tr_b16 v[46:47], v23 offset:2048
ds_read_b128 v[72:75], v16 offset:0
ds_read_b64_tr_b16 v[48:49], v20 offset:4096
ds_read_b64_tr_b16 v[50:51], v21 offset:4096
ds_read_b64_tr_b16 v[52:53], v22 offset:6144
ds_read_b64_tr_b16 v[54:55], v23 offset:6144
ds_read_b128 v[76:79], v16 offset:1024
ds_read_b128 v[80:83], v16 offset:2048
s_waitcnt lgkmcnt(6)
v_mfma_f32_16x16x32_bf16 v[128:131], v[72:75], v[40:43], 0
ds_read_b128 v[84:87], v16 offset:3072
v_mfma_f32_16x16x32_bf16 v[132:135], v[72:75], v[44:47], 0
s_waitcnt lgkmcnt(5)
v_mfma_f32_16x16x32_bf16 v[136:139], v[72:75], v[48:51], 0
ds_read_b64_tr_b16 v[56:57], v20 offset:512
s_waitcnt lgkmcnt(4)
v_mfma_f32_16x16x32_bf16 v[140:143], v[72:75], v[52:55], 0
s_waitcnt lgkmcnt(3)
v_mfma_f32_16x16x32_bf16 v[156:159], v[76:79], v[52:55], 0
ds_read_b128 v[72:75], v16 offset:16384
v_mfma_f32_16x16x32_bf16 v[152:155], v[76:79], v[48:51], 0
ds_read_b64_tr_b16 v[58:59], v21 offset:512
v_mfma_f32_16x16x32_bf16 v[148:151], v[76:79], v[44:47], 0
v_mfma_f32_16x16x32_bf16 v[144:147], v[76:79], v[40:43], 0
ds_read_b64_tr_b16 v[60:61], v22 offset:2560
s_waitcnt lgkmcnt(5)
v_mfma_f32_16x16x32_bf16 v[160:163], v[80:83], v[40:43], 0
ds_read_b128 v[76:79], v16 offset:17408
v_mfma_f32_16x16x32_bf16 v[164:167], v[80:83], v[44:47], 0
v_mfma_f32_16x16x32_bf16 v[168:171], v[80:83], v[48:51], 0
ds_read_b64_tr_b16 v[62:63], v23 offset:2560
v_mfma_f32_16x16x32_bf16 v[172:175], v[80:83], v[52:55], 0
s_waitcnt lgkmcnt(6)
v_mfma_f32_16x16x32_bf16 v[188:191], v[84:87], v[52:55], 0
ds_read_b128 v[80:83], v16 offset:18432
v_mfma_f32_16x16x32_bf16 v[184:187], v[84:87], v[48:51], 0
ds_read_b64_tr_b16 v[64:65], v20 offset:4608
v_mfma_f32_16x16x32_bf16 v[180:183], v[84:87], v[44:47], 0
v_mfma_f32_16x16x32_bf16 v[176:179], v[84:87], v[40:43], 0
ds_read_b64_tr_b16 v[66:67], v21 offset:4608
s_waitcnt lgkmcnt(7)
v_mfma_f32_16x16x32_bf16 v[192:195], v[72:75], v[40:43], 0
ds_read_b128 v[84:87], v16 offset:19456
v_mfma_f32_16x16x32_bf16 v[196:199], v[72:75], v[44:47], 0
v_mfma_f32_16x16x32_bf16 v[200:203], v[72:75], v[48:51], 0
ds_read_b64_tr_b16 v[68:69], v22 offset:6656
v_mfma_f32_16x16x32_bf16 v[204:207], v[72:75], v[52:55], 0
s_waitcnt lgkmcnt(6)
v_mfma_f32_16x16x32_bf16 v[220:223], v[76:79], v[52:55], 0
ds_read_b128 v[72:75], v17 offset:0
v_mfma_f32_16x16x32_bf16 v[216:219], v[76:79], v[48:51], 0
ds_read_b64_tr_b16 v[70:71], v23 offset:6656
v_mfma_f32_16x16x32_bf16 v[212:215], v[76:79], v[44:47], 0
v_mfma_f32_16x16x32_bf16 v[208:211], v[76:79], v[40:43], 0
s_waitcnt lgkmcnt(6)
v_mfma_f32_16x16x32_bf16 v[224:227], v[80:83], v[40:43], 0
ds_read_b128 v[76:79], v17 offset:1024
v_mfma_f32_16x16x32_bf16 v[228:231], v[80:83], v[44:47], 0
v_mfma_f32_16x16x32_bf16 v[232:235], v[80:83], v[48:51], 0
ds_read_b128 v[8:11], v17 offset:17408
v_mfma_f32_16x16x32_bf16 v[236:239], v[80:83], v[52:55], 0
s_waitcnt lgkmcnt(5)
v_mfma_f32_16x16x32_bf16 v[252:255], v[84:87], v[52:55], 0
ds_read_b128 v[80:83], v17 offset:2048
v_mfma_f32_16x16x32_bf16 v[248:251], v[84:87], v[48:51], 0
v_mfma_f32_16x16x32_bf16 v[244:247], v[84:87], v[44:47], 0
ds_read_b128 v[12:15], v17 offset:18432
v_mfma_f32_16x16x32_bf16 v[240:243], v[84:87], v[40:43], 0
s_waitcnt lgkmcnt(5)
v_mfma_f32_16x16x32_bf16 v[128:131], v[72:75], v[56:59], v[128:131]
ds_read_b128 v[84:87], v17 offset:3072
v_mfma_f32_16x16x32_bf16 v[132:135], v[72:75], v[60:63], v[132:135]
v_mfma_f32_16x16x32_bf16 v[136:139], v[72:75], v[64:67], v[136:139]
ds_read_b128 v[30:33], v17 offset:19456
s_waitcnt lgkmcnt(6)
v_mfma_f32_16x16x32_bf16 v[140:143], v[72:75], v[68:71], v[140:143]
s_waitcnt lgkmcnt(5)
v_mfma_f32_16x16x32_bf16 v[156:159], v[76:79], v[68:71], v[156:159]
ds_read_b128 v[72:75], v17 offset:16384
v_mfma_f32_16x16x32_bf16 v[152:155], v[76:79], v[64:67], v[152:155]
v_mfma_f32_16x16x32_bf16 v[148:151], v[76:79], v[60:63], v[148:151]
s_add_u32 s53, s53, 49152
s_cmp_ge_u32 s53, 147456
s_cselect_b32 s53, 0, s53
v_mfma_f32_16x16x32_bf16 v[144:147], v[76:79], v[56:59], v[144:147]
v_add_u32 v16, s53, v24
s_waitcnt lgkmcnt(4)
v_mfma_f32_16x16x32_bf16 v[160:163], v[80:83], v[56:59], v[160:163]
v_xor_b32 v17, 0x40, v16
v_mfma_f32_16x16x32_bf16 v[164:167], v[80:83], v[60:63], v[164:167]
v_add_u32 v20, s53, v28
v_mfma_f32_16x16x32_bf16 v[168:171], v[80:83], v[64:67], v[168:171]
v_xor_b32 v21, 0x40, v20
v_mfma_f32_16x16x32_bf16 v[172:175], v[80:83], v[68:71], v[172:175]
v_xor_b32 v22, 0x80, v20
s_waitcnt lgkmcnt(2)
v_mfma_f32_16x16x32_bf16 v[188:191], v[84:87], v[68:71], v[188:191]
v_xor_b32 v23, 0xc0, v20
v_mfma_f32_16x16x32_bf16 v[184:187], v[84:87], v[64:67], v[184:187]
v_mfma_f32_16x16x32_bf16 v[180:183], v[84:87], v[60:63], v[180:183]
v_mfma_f32_16x16x32_bf16 v[176:179], v[84:87], v[56:59], v[176:179]
s_waitcnt lgkmcnt(0)
s_barrier
v_mfma_f32_16x16x32_bf16 v[192:195], v[72:75], v[56:59], v[192:195]
ds_read_b64_tr_b16 v[40:41], v20 offset:0
v_mfma_f32_16x16x32_bf16 v[196:199], v[72:75], v[60:63], v[196:199]
ds_read_b64_tr_b16 v[42:43], v21 offset:0
v_mfma_f32_16x16x32_bf16 v[200:203], v[72:75], v[64:67], v[200:203]
ds_read_b64_tr_b16 v[44:45], v22 offset:2048
v_mfma_f32_16x16x32_bf16 v[204:207], v[72:75], v[68:71], v[204:207]
ds_read_b64_tr_b16 v[46:47], v23 offset:2048
v_mfma_f32_16x16x32_bf16 v[220:223], v[8:11], v[68:71], v[220:223]
ds_read_b128 v[72:75], v16 offset:0
v_mfma_f32_16x16x32_bf16 v[216:219], v[8:11], v[64:67], v[216:219]
ds_read_b64_tr_b16 v[48:49], v20 offset:4096
v_mfma_f32_16x16x32_bf16 v[212:215], v[8:11], v[60:63], v[212:215]
ds_read_b64_tr_b16 v[50:51], v21 offset:4096
v_mfma_f32_16x16x32_bf16 v[208:211], v[8:11], v[56:59], v[208:211]
ds_read_b64_tr_b16 v[52:53], v22 offset:6144
v_mfma_f32_16x16x32_bf16 v[224:227], v[12:15], v[56:59], v[224:227]
ds_read_b64_tr_b16 v[54:55], v23 offset:6144
v_mfma_f32_16x16x32_bf16 v[228:231], v[12:15], v[60:63], v[228:231]
ds_read_b128 v[76:79], v16 offset:1024
v_mfma_f32_16x16x32_bf16 v[232:235], v[12:15], v[64:67], v[232:235]
ds_read_b128 v[80:83], v16 offset:2048
v_mfma_f32_16x16x32_bf16 v[236:239], v[12:15], v[68:71], v[236:239]
v_mfma_f32_16x16x32_bf16 v[252:255], v[30:33], v[68:71], v[252:255]
v_mfma_f32_16x16x32_bf16 v[248:251], v[30:33], v[64:67], v[248:251]
v_mfma_f32_16x16x32_bf16 v[244:247], v[30:33], v[60:63], v[244:247]
v_mfma_f32_16x16x32_bf16 v[240:243], v[30:33], v[56:59], v[240:243]
s_mov_b32 s52, 6
.p2align 5
Lg_18:
s_waitcnt lgkmcnt(6)
v_mfma_f32_16x16x32_bf16 v[128:131], v[72:75], v[40:43], v[128:131]
ds_read_b128 v[84:87], v16 offset:3072
v_mfma_f32_16x16x32_bf16 v[132:135], v[72:75], v[44:47], v[132:135]
s_waitcnt lgkmcnt(5)
v_mfma_f32_16x16x32_bf16 v[136:139], v[72:75], v[48:51], v[136:139]
ds_read_b64_tr_b16 v[56:57], v20 offset:512
s_waitcnt lgkmcnt(4)
v_mfma_f32_16x16x32_bf16 v[140:143], v[72:75], v[52:55], v[140:143]
s_waitcnt lgkmcnt(3)
v_mfma_f32_16x16x32_bf16 v[156:159], v[76:79], v[52:55], v[156:159]
ds_read_b128 v[72:75], v16 offset:16384
v_mfma_f32_16x16x32_bf16 v[152:155], v[76:79], v[48:51], v[152:155]
ds_read_b64_tr_b16 v[58:59], v21 offset:512
v_mfma_f32_16x16x32_bf16 v[148:151], v[76:79], v[44:47], v[148:151]
v_mfma_f32_16x16x32_bf16 v[144:147], v[76:79], v[40:43], v[144:147]
ds_read_b64_tr_b16 v[60:61], v22 offset:2560
s_waitcnt lgkmcnt(5)
v_mfma_f32_16x16x32_bf16 v[160:163], v[80:83], v[40:43], v[160:163]
ds_read_b128 v[76:79], v16 offset:17408
v_mfma_f32_16x16x32_bf16 v[164:167], v[80:83], v[44:47], v[164:167]
v_mfma_f32_16x16x32_bf16 v[168:171], v[80:83], v[48:51], v[168:171]
ds_read_b64_tr_b16 v[62:63], v23 offset:2560
v_mfma_f32_16x16x32_bf16 v[172:175], v[80:83], v[52:55], v[172:175]
s_waitcnt lgkmcnt(6)
v_mfma_f32_16x16x32_bf16 v[188:191], v[84:87], v[52:55], v[188:191]
ds_read_b128 v[80:83], v16 offset:18432
v_mfma_f32_16x16x32_bf16 v[184:187], v[84:87], v[48:51], v[184:187]
ds_read_b64_tr_b16 v[64:65], v20 offset:4608
v_mfma_f32_16x16x32_bf16 v[180:183], v[84:87], v[44:47], v[180:183]
v_mfma_f32_16x16x32_bf16 v[176:179], v[84:87], v[40:43], v[176:179]
ds_read_b64_tr_b16 v[66:67], v21 offset:4608
s_waitcnt lgkmcnt(7)
v_mfma_f32_16x16x32_bf16 v[192:195], v[72:75], v[40:43], v[192:195]
ds_read_b128 v[84:87], v16 offset:19456
v_mfma_f32_16x16x32_bf16 v[196:199], v[72:75], v[44:47], v[196:199]
v_mfma_f32_16x16x32_bf16 v[200:203], v[72:75], v[48:51], v[200:203]
ds_read_b64_tr_b16 v[68:69], v22 offset:6656
v_mfma_f32_16x16x32_bf16 v[204:207], v[72:75], v[52:55], v[204:207]
s_waitcnt lgkmcnt(6)
v_mfma_f32_16x16x32_bf16 v[220:223], v[76:79], v[52:55], v[220:223]
ds_read_b128 v[72:75], v17 offset:0
v_mfma_f32_16x16x32_bf16 v[216:219], v[76:79], v[48:51], v[216:219]
ds_read_b64_tr_b16 v[70:71], v23 offset:6656
v_mfma_f32_16x16x32_bf16 v[212:215], v[76:79], v[44:47], v[212:215]
v_mfma_f32_16x16x32_bf16 v[208:211], v[76:79], v[40:43], v[208:211]
s_waitcnt lgkmcnt(6)
v_mfma_f32_16x16x32_bf16 v[224:227], v[80:83], v[40:43], v[224:227]
ds_read_b128 v[76:79], v17 offset:1024
v_mfma_f32_16x16x32_bf16 v[228:231], v[80:83], v[44:47], v[228:231]
v_mfma_f32_16x16x32_bf16 v[232:235], v[80:83], v[48:51], v[232:235]
ds_read_b128 v[8:11], v17 offset:17408
v_mfma_f32_16x16x32_bf16 v[236:239], v[80:83], v[52:55], v[236:239]
s_waitcnt lgkmcnt(5)
v_mfma_f32_16x16x32_bf16 v[252:255], v[84:87], v[52:55], v[252:255]
ds_read_b128 v[80:83], v17 offset:2048
v_mfma_f32_16x16x32_bf16 v[248:251], v[84:87], v[48:51], v[248:251]
v_mfma_f32_16x16x32_bf16 v[244:247], v[84:87], v[44:47], v[244:247]
ds_read_b128 v[12:15], v17 offset:18432
v_mfma_f32_16x16x32_bf16 v[240:243], v[84:87], v[40:43], v[240:243]
s_waitcnt lgkmcnt(5)
v_mfma_f32_16x16x32_bf16 v[128:131], v[72:75], v[56:59], v[128:131]
ds_read_b128 v[84:87], v17 offset:3072
v_mfma_f32_16x16x32_bf16 v[132:135], v[72:75], v[60:63], v[132:135]
v_mfma_f32_16x16x32_bf16 v[136:139], v[72:75], v[64:67], v[136:139]
ds_read_b128 v[30:33], v17 offset:19456
s_waitcnt lgkmcnt(6)
v_mfma_f32_16x16x32_bf16 v[140:143], v[72:75], v[68:71], v[140:143]
s_waitcnt lgkmcnt(5)
v_mfma_f32_16x16x32_bf16 v[156:159], v[76:79], v[68:71], v[156:159]
ds_read_b128 v[72:75], v17 offset:16384
v_mfma_f32_16x16x32_bf16 v[152:155], v[76:79], v[64:67], v[152:155]
v_mfma_f32_16x16x32_bf16 v[148:151], v[76:79], v[60:63], v[148:151]
s_add_u32 s53, s53, 49152
s_cmp_ge_u32 s53, 147456
s_cselect_b32 s53, 0, s53
v_mfma_f32_16x16x32_bf16 v[144:147], v[76:79], v[56:59], v[144:147]
v_add_u32 v16, s53, v24
s_waitcnt lgkmcnt(4)
v_mfma_f32_16x16x32_bf16 v[160:163], v[80:83], v[56:59], v[160:163]
v_xor_b32 v17, 0x40, v16
v_mfma_f32_16x16x32_bf16 v[164:167], v[80:83], v[60:63], v[164:167]
v_add_u32 v20, s53, v28
v_mfma_f32_16x16x32_bf16 v[168:171], v[80:83], v[64:67], v[168:171]
v_xor_b32 v21, 0x40, v20
v_mfma_f32_16x16x32_bf16 v[172:175], v[80:83], v[68:71], v[172:175]
v_xor_b32 v22, 0x80, v20
s_waitcnt lgkmcnt(2)
v_mfma_f32_16x16x32_bf16 v[188:191], v[84:87], v[68:71], v[188:191]
v_xor_b32 v23, 0xc0, v20
v_mfma_f32_16x16x32_bf16 v[184:187], v[84:87], v[64:67], v[184:187]
v_mfma_f32_16x16x32_bf16 v[180:183], v[84:87], v[60:63], v[180:183]
v_mfma_f32_16x16x32_bf16 v[176:179], v[84:87], v[56:59], v[176:179]
s_waitcnt lgkmcnt(0)
s_barrier
v_mfma_f32_16x16x32_bf16 v[192:195], v[72:75], v[56:59], v[192:195]
ds_read_b64_tr_b16 v[40:41], v20 offset:0
v_mfma_f32_16x16x32_bf16 v[196:199], v[72:75], v[60:63], v[196:199]
ds_read_b64_tr_b16 v[42:43], v21 offset:0
v_mfma_f32_16x16x32_bf16 v[200:203], v[72:75], v[64:67], v[200:203]
ds_read_b64_tr_b16 v[44:45], v22 offset:2048
v_mfma_f32_16x16x32_bf16 v[204:207], v[72:75], v[68:71], v[204:207]
ds_read_b64_tr_b16 v[46:47], v23 offset:2048
v_mfma_f32_16x16x32_bf16 v[220:223], v[8:11], v[68:71], v[220:223]
ds_read_b128 v[72:75], v16 offset:0
v_mfma_f32_16x16x32_bf16 v[216:219], v[8:11], v[64:67], v[216:219]
ds_read_b64_tr_b16 v[48:49], v20 offset:4096
v_mfma_f32_16x16x32_bf16 v[212:215], v[8:11], v[60:63], v[212:215]
ds_read_b64_tr_b16 v[50:51], v21 offset:4096
v_mfma_f32_16x16x32_bf16 v[208:211], v[8:11], v[56:59], v[208:211]
ds_read_b64_tr_b16 v[52:53], v22 offset:6144
v_mfma_f32_16x16x32_bf16 v[224:227], v[12:15], v[56:59], v[224:227]
ds_read_b64_tr_b16 v[54:55], v23 offset:6144
v_mfma_f32_16x16x32_bf16 v[228:231], v[12:15], v[60:63], v[228:231]
ds_read_b128 v[76:79], v16 offset:1024
v_mfma_f32_16x16x32_bf16 v[232:235], v[12:15], v[64:67], v[232:235]
ds_read_b128 v[80:83], v16 offset:2048
v_mfma_f32_16x16x32_bf16 v[236:239], v[12:15], v[68:71], v[236:239]
v_mfma_f32_16x16x32_bf16 v[252:255], v[30:33], v[68:71], v[252:255]
v_mfma_f32_16x16x32_bf16 v[248:251], v[30:33], v[64:67], v[248:251]
v_mfma_f32_16x16x32_bf16 v[244:247], v[30:33], v[60:63], v[244:247]
v_mfma_f32_16x16x32_bf16 v[240:243], v[30:33], v[56:59], v[240:243]
s_sub_u32 s52, s52, 1
s_cmp_lg_u32 s52, 0
s_cbranch_scc1 Lg_18
s_waitcnt lgkmcnt(6)
v_mfma_f32_16x16x32_bf16 v[128:131], v[72:75], v[40:43], v[128:131]
ds_read_b128 v[84:87], v16 offset:3072
v_mfma_f32_16x16x32_bf16 v[132:135], v[72:75], v[44:47], v[132:135]
s_waitcnt lgkmcnt(5)
v_mfma_f32_16x16x32_bf16 v[136:139], v[72:75], v[48:51], v[136:139]
ds_read_b64_tr_b16 v[56:57], v20 offset:512
s_waitcnt lgkmcnt(4)
v_mfma_f32_16x16x32_bf16 v[140:143], v[72:75], v[52:55], v[140:143]
s_waitcnt lgkmcnt(3)
v_mfma_f32_16x16x32_bf16 v[156:159], v[76:79], v[52:55], v[156:159]
ds_read_b128 v[72:75], v16 offset:16384
v_mfma_f32_16x16x32_bf16 v[152:155], v[76:79], v[48:51], v[152:155]
ds_read_b64_tr_b16 v[58:59], v21 offset:512
v_mfma_f32_16x16x32_bf16 v[148:151], v[76:79], v[44:47], v[148:151]
v_mfma_f32_16x16x32_bf16 v[144:147], v[76:79], v[40:43], v[144:147]
ds_read_b64_tr_b16 v[60:61], v22 offset:2560
s_waitcnt lgkmcnt(5)
v_mfma_f32_16x16x32_bf16 v[160:163], v[80:83], v[40:43], v[160:163]
ds_read_b128 v[76:79], v16 offset:17408
v_mfma_f32_16x16x32_bf16 v[164:167], v[80:83], v[44:47], v[164:167]
v_mfma_f32_16x16x32_bf16 v[168:171], v[80:83], v[48:51], v[168:171]
ds_read_b64_tr_b16 v[62:63], v23 offset:2560
v_mfma_f32_16x16x32_bf16 v[172:175], v[80:83], v[52:55], v[172:175]
s_waitcnt lgkmcnt(6)
v_mfma_f32_16x16x32_bf16 v[188:191], v[84:87], v[52:55], v[188:191]
ds_read_b128 v[80:83], v16 offset:18432
v_mfma_f32_16x16x32_bf16 v[184:187], v[84:87], v[48:51], v[184:187]
ds_read_b64_tr_b16 v[64:65], v20 offset:4608
v_mfma_f32_16x16x32_bf16 v[180:183], v[84:87], v[44:47], v[180:183]
v_mfma_f32_16x16x32_bf16 v[176:179], v[84:87], v[40:43], v[176:179]
ds_read_b64_tr_b16 v[66:67], v21 offset:4608
s_waitcnt lgkmcnt(7)
v_mfma_f32_16x16x32_bf16 v[192:195], v[72:75], v[40:43], v[192:195]
ds_read_b128 v[84:87], v16 offset:19456
v_mfma_f32_16x16x32_bf16 v[196:199], v[72:75], v[44:47], v[196:199]
v_mfma_f32_16x16x32_bf16 v[200:203], v[72:75], v[48:51], v[200:203]
ds_read_b64_tr_b16 v[68:69], v22 offset:6656
v_mfma_f32_16x16x32_bf16 v[204:207], v[72:75], v[52:55], v[204:207]
s_waitcnt lgkmcnt(6)
v_mfma_f32_16x16x32_bf16 v[220:223], v[76:79], v[52:55], v[220:223]
ds_read_b128 v[72:75], v17 offset:0
v_mfma_f32_16x16x32_bf16 v[216:219], v[76:79], v[48:51], v[216:219]
ds_read_b64_tr_b16 v[70:71], v23 offset:6656
v_mfma_f32_16x16x32_bf16 v[212:215], v[76:79], v[44:47], v[212:215]
v_mfma_f32_16x16x32_bf16 v[208:211], v[76:79], v[40:43], v[208:211]
s_waitcnt lgkmcnt(6)
v_mfma_f32_16x16x32_bf16 v[224:227], v[80:83], v[40:43], v[224:227]
ds_read_b128 v[76:79], v17 offset:1024
v_mfma_f32_16x16x32_bf16 v[228:231], v[80:83], v[44:47], v[228:231]
v_mfma_f32_16x16x32_bf16 v[232:235], v[80:83], v[48:51], v[232:235]
ds_read_b128 v[8:11], v17 offset:17408
v_mfma_f32_16x16x32_bf16 v[236:239], v[80:83], v[52:55], v[236:239]
s_waitcnt lgkmcnt(5)
v_mfma_f32_16x16x32_bf16 v[252:255], v[84:87], v[52:55], v[252:255]
ds_read_b128 v[80:83], v17 offset:2048
v_mfma_f32_16x16x32_bf16 v[248:251], v[84:87], v[48:51], v[248:251]
v_mfma_f32_16x16x32_bf16 v[244:247], v[84:87], v[44:47], v[244:247]
ds_read_b128 v[12:15], v17 offset:18432
v_mfma_f32_16x16x32_bf16 v[240:243], v[84:87], v[40:43], v[240:243]
s_waitcnt lgkmcnt(5)
v_mfma_f32_16x16x32_bf16 v[128:131], v[72:75], v[56:59], v[128:131]
ds_read_b128 v[84:87], v17 offset:3072
v_mfma_f32_16x16x32_bf16 v[132:135], v[72:75], v[60:63], v[132:135]
v_mfma_f32_16x16x32_bf16 v[136:139], v[72:75], v[64:67], v[136:139]
ds_read_b128 v[30:33], v17 offset:19456
s_waitcnt lgkmcnt(6)
v_mfma_f32_16x16x32_bf16 v[140:143], v[72:75], v[68:71], v[140:143]
s_waitcnt lgkmcnt(5)
v_mfma_f32_16x16x32_bf16 v[156:159], v[76:79], v[68:71], v[156:159]
ds_read_b128 v[72:75], v17 offset:16384
v_mfma_f32_16x16x32_bf16 v[152:155], v[76:79], v[64:67], v[152:155]
v_mfma_f32_16x16x32_bf16 v[148:151], v[76:79], v[60:63], v[148:151]
s_add_u32 s53, s53, 49152
s_cmp_ge_u32 s53, 147456
s_cselect_b32 s53, 0, s53
v_mfma_f32_16x16x32_bf16 v[144:147], v[76:79], v[56:59], v[144:147]
v_add_u32 v16, s53, v29
s_waitcnt lgkmcnt(4)
v_mfma_f32_16x16x32_bf16 v[160:163], v[80:83], v[56:59], v[160:163]
v_add_u32 v20, s53, v39
v_mfma_f32_16x16x32_bf16 v[164:167], v[80:83], v[60:63], v[164:167]
v_xor_b32 v21, 0x20, v20
v_mfma_f32_16x16x32_bf16 v[168:171], v[80:83], v[64:67], v[168:171]
v_xor_b32 v22, 0x40, v20
v_mfma_f32_16x16x32_bf16 v[172:175], v[80:83], v[68:71], v[172:175]
v_xor_b32 v23, 0x60, v20
s_waitcnt lgkmcnt(2)
v_mfma_f32_16x16x32_bf16 v[188:191], v[84:87], v[68:71], v[188:191]
v_mfma_f32_16x16x32_bf16 v[184:187], v[84:87], v[64:67], v[184:187]
v_mfma_f32_16x16x32_bf16 v[180:183], v[84:87], v[60:63], v[180:183]
v_mfma_f32_16x16x32_bf16 v[176:179], v[84:87], v[56:59], v[176:179]
s_waitcnt lgkmcnt(0)
s_barrier
v_mfma_f32_16x16x32_bf16 v[192:195], v[72:75], v[56:59], v[192:195]
ds_read_b64_tr_b16 v[40:41], v20 offset:0
v_mfma_f32_16x16x32_bf16 v[196:199], v[72:75], v[60:63], v[196:199]
ds_read_b64_tr_b16 v[42:43], v20 offset:1024
v_mfma_f32_16x16x32_bf16 v[200:203], v[72:75], v[64:67], v[200:203]
ds_read_b64_tr_b16 v[44:45], v21 offset:0
v_mfma_f32_16x16x32_bf16 v[204:207], v[72:75], v[68:71], v[204:207]
ds_read_b64_tr_b16 v[46:47], v21 offset:1024
v_mfma_f32_16x16x32_bf16 v[220:223], v[8:11], v[68:71], v[220:223]
ds_read_b128 v[72:75], v16 offset:0
v_mfma_f32_16x16x32_bf16 v[216:219], v[8:11], v[64:67], v[216:219]
ds_read_b64_tr_b16 v[48:49], v22 offset:0
v_mfma_f32_16x16x32_bf16 v[212:215], v[8:11], v[60:63], v[212:215]
ds_read_b64_tr_b16 v[50:51], v22 offset:1024
v_mfma_f32_16x16x32_bf16 v[208:211], v[8:11], v[56:59], v[208:211]
ds_read_b64_tr_b16 v[52:53], v23 offset:0
v_mfma_f32_16x16x32_bf16 v[224:227], v[12:15], v[56:59], v[224:227]
ds_read_b64_tr_b16 v[54:55], v23 offset:1024
v_mfma_f32_16x16x32_bf16 v[228:231], v[12:15], v[60:63], v[228:231]
ds_read_b128 v[76:79], v16 offset:256
v_mfma_f32_16x16x32_bf16 v[232:235], v[12:15], v[64:67], v[232:235]
ds_read_b128 v[80:83], v16 offset:512
v_mfma_f32_16x16x32_bf16 v[236:239], v[12:15], v[68:71], v[236:239]
v_mfma_f32_16x16x32_bf16 v[252:255], v[30:33], v[68:71], v[252:255]
v_mfma_f32_16x16x32_bf16 v[248:251], v[30:33], v[64:67], v[248:251]
v_mfma_f32_16x16x32_bf16 v[244:247], v[30:33], v[60:63], v[244:247]
v_mfma_f32_16x16x32_bf16 v[240:243], v[30:33], v[56:59], v[240:243]
Lcj_7:
s_add_u32 s56, s36, 0x2000000
s_addc_u32 s57, s37, 0
s_mov_b32 s58, 0x1000000
s_mov_b32 s59, 0x20000
s_lshl_b32 s81, s46, 2
s_add_u32 s81, s81, s47
s_lshl_b32 s81, s81, 4
s_add_u32 s81, s81, s3
v_lshlrev_b32 v2, 4, v1
v_sub_u32 v3, s45, v1
v_add_u32 v3, 3, v3
v_and_b32 v3, 3, v3
v_lshl_add_u32 v3, v3, 2, s81
v_mul_u32_u24 v3, 64, v3
s_lshl_b32 s82, s81, 2
v_mov_b32 v36, 4
v_mad_u32_u24 v36, v36, v1, v3
v_mov_b32 v3, 1
s_mov_b32 s78, 65536
s_mul_i32 s48, s3, 8704
v_and_b32 v4, 15, v1
v_mul_u32_u24 v4, 272, v4
v_bfe_u32 v37, v1, 4, 1
v_lshl_add_u32 v4, v37, 7, v4
v_lshrrev_b32 v37, 5, v1
v_lshl_add_u32 v4, v37, 4, v4
v_add_u32 v4, s48, v4
v_add_u32 v3, 1, v1
v_xor_b32 v3, s45, v3
v_and_b32 v3, 3, v3
v_lshl_add_u32 v3, v3, 2, s81
v_mul_u32_u24 v3, 64, v3
v_mov_b32 v36, 4
v_mad_u32_u24 v36, v36, v1, v3
v_mov_b32 v3, 1
s_xor_b32 s96, s45, 1
s_lshl_b32 s96, s96, 4
s_add_u32 s96, s96, s82
s_add_u32 s96, s96, 0
s_lshl_b32 s96, s96, 12
s_xor_b32 s97, s45, 2
s_lshl_b32 s97, s97, 4
s_add_u32 s97, s97, s82
s_add_u32 s97, s97, 1
s_lshl_b32 s97, s97, 12
s_xor_b32 s98, s45, 3
s_lshl_b32 s98, s98, 4
s_add_u32 s98, s98, s82
s_add_u32 s98, s98, 2
s_lshl_b32 s98, s98, 12
s_mov_b32 s52, 11
.p2align 5
Lg_19:
s_waitcnt lgkmcnt(6)
v_mfma_f32_16x16x32_bf16 v[128:131], v[72:75], v[40:43], v[128:131]
ds_read_b128 v[84:87], v16 offset:768
v_mfma_f32_16x16x32_bf16 v[132:135], v[72:75], v[44:47], v[132:135]
s_waitcnt lgkmcnt(5)
v_mfma_f32_16x16x32_bf16 v[136:139], v[72:75], v[48:51], v[136:139]
ds_read_b64_tr_b16 v[56:57], v20 offset:8192
s_waitcnt lgkmcnt(4)
v_mfma_f32_16x16x32_bf16 v[140:143], v[72:75], v[52:55], v[140:143]
s_waitcnt lgkmcnt(3)
v_mfma_f32_16x16x32_bf16 v[156:159], v[76:79], v[52:55], v[156:159]
ds_read_b128 v[72:75], v16 offset:16384
v_mfma_f32_16x16x32_bf16 v[152:155], v[76:79], v[48:51], v[152:155]
ds_read_b64_tr_b16 v[58:59], v20 offset:9216
v_mfma_f32_16x16x32_bf16 v[148:151], v[76:79], v[44:47], v[148:151]
v_mfma_f32_16x16x32_bf16 v[144:147], v[76:79], v[40:43], v[144:147]
ds_read_b64_tr_b16 v[60:61], v21 offset:8192
s_waitcnt lgkmcnt(5)
v_mfma_f32_16x16x32_bf16 v[160:163], v[80:83], v[40:43], v[160:163]
ds_read_b128 v[76:79], v16 offset:16640
v_mfma_f32_16x16x32_bf16 v[164:167], v[80:83], v[44:47], v[164:167]
v_mfma_f32_16x16x32_bf16 v[168:171], v[80:83], v[48:51], v[168:171]
ds_read_b64_tr_b16 v[62:63], v21 offset:9216
v_mfma_f32_16x16x32_bf16 v[172:175], v[80:83], v[52:55], v[172:175]
s_waitcnt lgkmcnt(6)
v_mfma_f32_16x16x32_bf16 v[188:191], v[84:87], v[52:55], v[188:191]
ds_read_b128 v[80:83], v16 offset:16896
v_mfma_f32_16x16x32_bf16 v[184:187], v[84:87], v[48:51], v[184:187]
ds_read_b64_tr_b16 v[64:65], v22 offset:8192
v_mfma_f32_16x16x32_bf16 v[180:183], v[84:87], v[44:47], v[180:183]
v_mfma_f32_16x16x32_bf16 v[176:179], v[84:87], v[40:43], v[176:179]
ds_read_b64_tr_b16 v[66:67], v22 offset:9216
s_waitcnt lgkmcnt(7)
v_mfma_f32_16x16x32_bf16 v[192:195], v[72:75], v[40:43], v[192:195]
ds_read_b128 v[84:87], v16 offset:17152
v_mfma_f32_16x16x32_bf16 v[196:199], v[72:75], v[44:47], v[196:199]
v_mfma_f32_16x16x32_bf16 v[200:203], v[72:75], v[48:51], v[200:203]
ds_read_b64_tr_b16 v[68:69], v23 offset:8192
v_mfma_f32_16x16x32_bf16 v[204:207], v[72:75], v[52:55], v[204:207]
s_waitcnt lgkmcnt(6)
v_mfma_f32_16x16x32_bf16 v[220:223], v[76:79], v[52:55], v[220:223]
ds_read_b128 v[72:75], v16 offset:8192
v_mfma_f32_16x16x32_bf16 v[216:219], v[76:79], v[48:51], v[216:219]
ds_read_b64_tr_b16 v[70:71], v23 offset:9216
v_mfma_f32_16x16x32_bf16 v[212:215], v[76:79], v[44:47], v[212:215]
v_mfma_f32_16x16x32_bf16 v[208:211], v[76:79], v[40:43], v[208:211]
s_waitcnt lgkmcnt(6)
v_mfma_f32_16x16x32_bf16 v[224:227], v[80:83], v[40:43], v[224:227]
ds_read_b128 v[76:79], v16 offset:8448
v_mfma_f32_16x16x32_bf16 v[228:231], v[80:83], v[44:47], v[228:231]
v_mfma_f32_16x16x32_bf16 v[232:235], v[80:83], v[48:51], v[232:235]
ds_read_b128 v[8:11], v16 offset:24832
v_mfma_f32_16x16x32_bf16 v[236:239], v[80:83], v[52:55], v[236:239]
s_waitcnt lgkmcnt(5)
v_mfma_f32_16x16x32_bf16 v[252:255], v[84:87], v[52:55], v[252:255]
ds_read_b128 v[80:83], v16 offset:8704
v_mfma_f32_16x16x32_bf16 v[248:251], v[84:87], v[48:51], v[248:251]
v_mfma_f32_16x16x32_bf16 v[244:247], v[84:87], v[44:47], v[244:247]
ds_read_b128 v[12:15], v16 offset:25088
v_mfma_f32_16x16x32_bf16 v[240:243], v[84:87], v[40:43], v[240:243]
s_waitcnt lgkmcnt(5)
v_mfma_f32_16x16x32_bf16 v[128:131], v[72:75], v[56:59], v[128:131]
ds_read_b128 v[84:87], v16 offset:8960
v_mfma_f32_16x16x32_bf16 v[132:135], v[72:75], v[60:63], v[132:135]
v_mfma_f32_16x16x32_bf16 v[136:139], v[72:75], v[64:67], v[136:139]
ds_read_b128 v[30:33], v16 offset:25344
s_waitcnt lgkmcnt(6)
v_mfma_f32_16x16x32_bf16 v[140:143], v[72:75], v[68:71], v[140:143]
s_waitcnt lgkmcnt(5)
v_mfma_f32_16x16x32_bf16 v[156:159], v[76:79], v[68:71], v[156:159]
ds_read_b128 v[72:75], v16 offset:24576
v_mfma_f32_16x16x32_bf16 v[152:155], v[76:79], v[64:67], v[152:155]
v_mfma_f32_16x16x32_bf16 v[148:151], v[76:79], v[60:63], v[148:151]
s_add_u32 s53, s53, 49152
s_cmp_ge_u32 s53, 147456
s_cselect_b32 s53, 0, s53
v_mfma_f32_16x16x32_bf16 v[144:147], v[76:79], v[56:59], v[144:147]
v_add_u32 v16, s53, v29
s_waitcnt lgkmcnt(4)
v_mfma_f32_16x16x32_bf16 v[160:163], v[80:83], v[56:59], v[160:163]
v_add_u32 v20, s53, v39
v_mfma_f32_16x16x32_bf16 v[164:167], v[80:83], v[60:63], v[164:167]
v_xor_b32 v21, 0x20, v20
v_mfma_f32_16x16x32_bf16 v[168:171], v[80:83], v[64:67], v[168:171]
v_xor_b32 v22, 0x40, v20
v_mfma_f32_16x16x32_bf16 v[172:175], v[80:83], v[68:71], v[172:175]
v_xor_b32 v23, 0x60, v20
s_waitcnt lgkmcnt(2)
v_mfma_f32_16x16x32_bf16 v[188:191], v[84:87], v[68:71], v[188:191]
v_mfma_f32_16x16x32_bf16 v[184:187], v[84:87], v[64:67], v[184:187]
v_mfma_f32_16x16x32_bf16 v[180:183], v[84:87], v[60:63], v[180:183]
v_mfma_f32_16x16x32_bf16 v[176:179], v[84:87], v[56:59], v[176:179]
s_waitcnt lgkmcnt(0)
s_barrier
v_mfma_f32_16x16x32_bf16 v[192:195], v[72:75], v[56:59], v[192:195]
ds_read_b64_tr_b16 v[40:41], v20 offset:0
v_mfma_f32_16x16x32_bf16 v[196:199], v[72:75], v[60:63], v[196:199]
ds_read_b64_tr_b16 v[42:43], v20 offset:1024
v_mfma_f32_16x16x32_bf16 v[200:203], v[72:75], v[64:67], v[200:203]
ds_read_b64_tr_b16 v[44:45], v21 offset:0
v_mfma_f32_16x16x32_bf16 v[204:207], v[72:75], v[68:71], v[204:207]
ds_read_b64_tr_b16 v[46:47], v21 offset:1024
v_mfma_f32_16x16x32_bf16 v[220:223], v[8:11], v[68:71], v[220:223]
ds_read_b128 v[72:75], v16 offset:0
v_mfma_f32_16x16x32_bf16 v[216:219], v[8:11], v[64:67], v[216:219]
ds_read_b64_tr_b16 v[48:49], v22 offset:0
v_mfma_f32_16x16x32_bf16 v[212:215], v[8:11], v[60:63], v[212:215]
ds_read_b64_tr_b16 v[50:51], v22 offset:1024
v_mfma_f32_16x16x32_bf16 v[208:211], v[8:11], v[56:59], v[208:211]
ds_read_b64_tr_b16 v[52:53], v23 offset:0
v_mfma_f32_16x16x32_bf16 v[224:227], v[12:15], v[56:59], v[224:227]
ds_read_b64_tr_b16 v[54:55], v23 offset:1024
v_mfma_f32_16x16x32_bf16 v[228:231], v[12:15], v[60:63], v[228:231]
ds_read_b128 v[76:79], v16 offset:256
v_mfma_f32_16x16x32_bf16 v[232:235], v[12:15], v[64:67], v[232:235]
ds_read_b128 v[80:83], v16 offset:512
v_mfma_f32_16x16x32_bf16 v[236:239], v[12:15], v[68:71], v[236:239]
v_mfma_f32_16x16x32_bf16 v[252:255], v[30:33], v[68:71], v[252:255]
v_mfma_f32_16x16x32_bf16 v[248:251], v[30:33], v[64:67], v[248:251]
v_mfma_f32_16x16x32_bf16 v[244:247], v[30:33], v[60:63], v[244:247]
v_mfma_f32_16x16x32_bf16 v[240:243], v[30:33], v[56:59], v[240:243]
s_sub_u32 s52, s52, 1
s_cmp_lg_u32 s52, 0
s_cbranch_scc1 Lg_19
L_tail:
s_waitcnt lgkmcnt(4)
v_mfma_f32_16x16x32_bf16 v[136:139], v[72:75], v[48:51], v[136:139]
ds_read_b128 v[56:59], v16 offset:16384
s_waitcnt lgkmcnt(3)
v_mfma_f32_16x16x32_bf16 v[140:143], v[72:75], v[52:55], v[140:143]
ds_read_b128 v[60:63], v16 offset:768
s_waitcnt lgkmcnt(3)
v_mfma_f32_16x16x32_bf16 v[156:159], v[76:79], v[52:55], v[156:159]
ds_read_b128 v[64:67], v16 offset:16640
s_add_u32 s53, s53, 49152
s_cmp_ge_u32 s53, 147456
s_cselect_b32 s53, 0, s53
v_mfma_f32_16x16x32_bf16 v[152:155], v[76:79], v[48:51], v[152:155]
ds_read_b128 v[68:71], v16 offset:16896
s_waitcnt lgkmcnt(4)
v_mfma_f32_16x16x32_bf16 v[168:171], v[80:83], v[48:51], v[168:171]
ds_read_b128 v[84:87], v16 offset:17152
v_add_u32 v17, s53, v29
v_mfma_f32_16x16x32_bf16 v[172:175], v[80:83], v[52:55], v[172:175]
ds_read_b128 v[88:91], v16 offset:24576
s_waitcnt lgkmcnt(5)
v_mfma_f32_16x16x32_bf16 v[204:207], v[56:59], v[52:55], v[204:207]
ds_read_b64_tr_b16 v[92:93], v20 offset:8192
v_add_u32 v24, s53, v39
v_mfma_f32_16x16x32_bf16 v[200:203], v[56:59], v[48:51], v[200:203]
ds_read_b64_tr_b16 v[94:95], v20 offset:9216
v_mfma_f32_16x16x32_bf16 v[196:199], v[56:59], v[44:47], v[196:199]
ds_read_b64_tr_b16 v[96:97], v21 offset:8192
v_xor_b32 v25, 0x20, v24
v_mfma_f32_16x16x32_bf16 v[192:195], v[56:59], v[40:43], v[192:195]
ds_read_b64_tr_b16 v[98:99], v21 offset:9216
s_waitcnt lgkmcnt(8)
v_mfma_f32_16x16x32_bf16 v[184:187], v[60:63], v[48:51], v[184:187]
ds_read_b64_tr_b16 v[100:101], v22 offset:8192
v_xor_b32 v26, 0x40, v24
v_mfma_f32_16x16x32_bf16 v[188:191], v[60:63], v[52:55], v[188:191]
ds_read_b64_tr_b16 v[102:103], v22 offset:9216
s_waitcnt lgkmcnt(9)
v_mfma_f32_16x16x32_bf16 v[220:223], v[64:67], v[52:55], v[220:223]
ds_read_b64_tr_b16 v[104:105], v23 offset:8192
v_xor_b32 v27, 0x60, v24
v_mfma_f32_16x16x32_bf16 v[216:219], v[64:67], v[48:51], v[216:219]
ds_read_b64_tr_b16 v[106:107], v23 offset:9216
v_mfma_f32_16x16x32_bf16 v[212:215], v[64:67], v[44:47], v[212:215]
ds_read_b128 v[108:111], v16 offset:8192
s_add_u32 s53, s53, 49152
s_cmp_ge_u32 s53, 147456
s_cselect_b32 s53, 0, s53
v_mfma_f32_16x16x32_bf16 v[208:211], v[64:67], v[40:43], v[208:211]
ds_read_b128 v[112:115], v16 offset:24832
s_waitcnt lgkmcnt(12)
v_mfma_f32_16x16x32_bf16 v[224:227], v[68:71], v[40:43], v[224:227]
ds_read_b128 v[116:119], v16 offset:8448
v_add_u32 v18, s53, v29
v_mfma_f32_16x16x32_bf16 v[228:231], v[68:71], v[44:47], v[228:231]
ds_read_b128 v[120:123], v16 offset:25088
v_mfma_f32_16x16x32_bf16 v[232:235], v[68:71], v[48:51], v[232:235]
ds_read_b128 v[124:127], v16 offset:8704
v_add_u32 v32, s53, v39
v_mfma_f32_16x16x32_bf16 v[236:239], v[68:71], v[52:55], v[236:239]
ds_read_b128 v[8:11], v16 offset:25344
s_waitcnt lgkmcnt(15)
v_mfma_f32_16x16x32_bf16 v[252:255], v[84:87], v[52:55], v[252:255]
ds_read_b128 v[12:15], v16 offset:8960
v_xor_b32 v33, 0x20, v32
v_mfma_f32_16x16x32_bf16 v[248:251], v[84:87], v[48:51], v[248:251]
v_mfma_f32_16x16x32_bf16 v[244:247], v[84:87], v[44:47], v[244:247]
v_xor_b32 v34, 0x40, v32
v_mfma_f32_16x16x32_bf16 v[240:243], v[84:87], v[40:43], v[240:243]
s_waitcnt lgkmcnt(13)
v_mfma_f32_16x16x32_bf16 v[192:195], v[88:91], v[92:95], v[192:195]
v_xor_b32 v35, 0x60, v32
s_waitcnt lgkmcnt(11)
v_mfma_f32_16x16x32_bf16 v[196:199], v[88:91], v[96:99], v[196:199]
s_waitcnt lgkmcnt(9)
v_mfma_f32_16x16x32_bf16 v[200:203], v[88:91], v[100:103], v[200:203]
s_waitcnt lgkmcnt(7)
v_mfma_f32_16x16x32_bf16 v[204:207], v[88:91], v[104:107], v[204:207]
s_waitcnt lgkmcnt(6)
v_mfma_f32_16x16x32_bf16 v[140:143], v[108:111], v[104:107], v[140:143]
v_mfma_f32_16x16x32_bf16 v[136:139], v[108:111], v[100:103], v[136:139]
s_waitcnt lgkmcnt(5)
v_mfma_f32_16x16x32_bf16 v[208:211], v[112:115], v[92:95], v[208:211]
v_mfma_f32_16x16x32_bf16 v[212:215], v[112:115], v[96:99], v[212:215]
s_barrier
v_mfma_f32_16x16x32_bf16 v[216:219], v[112:115], v[100:103], v[216:219]
ds_read_b128 v[72:75], v17 offset:16384
v_mfma_f32_16x16x32_bf16 v[220:223], v[112:115], v[104:107], v[220:223]
ds_read_b64_tr_b16 v[76:77], v24 offset:0
s_waitcnt lgkmcnt(6)
v_mfma_f32_16x16x32_bf16 v[156:159], v[116:119], v[104:107], v[156:159]
ds_read_b64_tr_b16 v[78:79], v24 offset:1024
v_mfma_f32_16x16x32_bf16 v[152:155], v[116:119], v[100:103], v[152:155]
ds_read_b64_tr_b16 v[80:81], v25 offset:0
s_waitcnt lgkmcnt(7)
v_mfma_f32_16x16x32_bf16 v[224:227], v[120:123], v[92:95], v[224:227]
ds_read_b64_tr_b16 v[82:83], v25 offset:1024
v_mfma_f32_16x16x32_bf16 v[228:231], v[120:123], v[96:99], v[228:231]
ds_read_b64_tr_b16 v[56:57], v26 offset:0
v_mfma_f32_16x16x32_bf16 v[232:235], v[120:123], v[100:103], v[232:235]
ds_read_b64_tr_b16 v[58:59], v26 offset:1024
v_mfma_f32_16x16x32_bf16 v[236:239], v[120:123], v[104:107], v[236:239]
ds_read_b64_tr_b16 v[60:61], v27 offset:0
s_waitcnt lgkmcnt(10)
v_mfma_f32_16x16x32_bf16 v[172:175], v[124:127], v[104:107], v[172:175]
ds_read_b64_tr_b16 v[62:63], v27 offset:1024
v_mfma_f32_16x16x32_bf16 v[168:171], v[124:127], v[100:103], v[168:171]
ds_read_b128 v[64:67], v17 offset:0
s_waitcnt lgkmcnt(11)
v_mfma_f32_16x16x32_bf16 v[240:243], v[8:11], v[92:95], v[240:243]
ds_read_b128 v[68:71], v17 offset:16640
v_mfma_f32_16x16x32_bf16 v[244:247], v[8:11], v[96:99], v[244:247]
ds_read_b128 v[52:55], v17 offset:256
v_mfma_f32_16x16x32_bf16 v[248:251], v[8:11], v[100:103], v[248:251]
ds_read_b128 v[48:51], v17 offset:16896
v_mfma_f32_16x16x32_bf16 v[252:255], v[8:11], v[104:107], v[252:255]
ds_read_b128 v[44:47], v17 offset:512
s_waitcnt lgkmcnt(14)
v_mfma_f32_16x16x32_bf16 v[188:191], v[12:15], v[104:107], v[188:191]
ds_read_b128 v[84:87], v17 offset:17152
v_mfma_f32_16x16x32_bf16 v[184:187], v[12:15], v[100:103], v[184:187]
ds_read_b128 v[40:43], v17 offset:768
s_waitcnt lgkmcnt(13)
v_mfma_f32_16x16x32_bf16 v[192:195], v[72:75], v[76:79], v[192:195]
ds_read_b128 v[88:91], v17 offset:24576
s_waitcnt lgkmcnt(12)
v_mfma_f32_16x16x32_bf16 v[196:199], v[72:75], v[80:83], v[196:199]
ds_read_b64_tr_b16 v[108:109], v24 offset:8192
s_waitcnt lgkmcnt(11)
v_mfma_f32_16x16x32_bf16 v[200:203], v[72:75], v[56:59], v[200:203]
ds_read_b64_tr_b16 v[110:111], v24 offset:9216
s_waitcnt lgkmcnt(10)
v_mfma_f32_16x16x32_bf16 v[204:207], v[72:75], v[60:63], v[204:207]
ds_read_b64_tr_b16 v[112:113], v25 offset:8192
s_waitcnt lgkmcnt(10)
v_mfma_f32_16x16x32_bf16 v[140:143], v[64:67], v[60:63], v[140:143]
ds_read_b64_tr_b16 v[114:115], v25 offset:9216
v_mfma_f32_16x16x32_bf16 v[136:139], v[64:67], v[56:59], v[136:139]
ds_read_b64_tr_b16 v[116:117], v26 offset:8192
s_waitcnt lgkmcnt(11)
v_mfma_f32_16x16x32_bf16 v[208:211], v[68:71], v[76:79], v[208:211]
ds_read_b64_tr_b16 v[118:119], v26 offset:9216
v_mfma_f32_16x16x32_bf16 v[212:215], v[68:71], v[80:83], v[212:215]
ds_read_b64_tr_b16 v[120:121], v27 offset:8192
v_mfma_f32_16x16x32_bf16 v[216:219], v[68:71], v[56:59], v[216:219]
ds_read_b64_tr_b16 v[122:123], v27 offset:9216
v_mfma_f32_16x16x32_bf16 v[220:223], v[68:71], v[60:63], v[220:223]
ds_read_b128 v[124:127], v17 offset:8192
s_waitcnt lgkmcnt(14)
v_mfma_f32_16x16x32_bf16 v[156:159], v[52:55], v[60:63], v[156:159]
ds_read_b128 v[92:95], v17 offset:24832
v_mfma_f32_16x16x32_bf16 v[152:155], v[52:55], v[56:59], v[152:155]
ds_read_b128 v[96:99], v17 offset:8448
s_waitcnt lgkmcnt(15)
v_mfma_f32_16x16x32_bf16 v[224:227], v[48:51], v[76:79], v[224:227]
ds_read_b128 v[8:11], v17 offset:25088
v_mfma_f32_16x16x32_bf16 v[228:231], v[48:51], v[80:83], v[228:231]
ds_read_b128 v[104:107], v17 offset:8704
v_mfma_f32_16x16x32_bf16 v[232:235], v[48:51], v[56:59], v[232:235]
ds_read_b128 v[12:15], v17 offset:25344
v_mfma_f32_16x16x32_bf16 v[236:239], v[48:51], v[60:63], v[236:239]
ds_read_b128 v[100:103], v17 offset:8960
s_waitcnt lgkmcnt(15)
v_mfma_f32_16x16x32_bf16 v[172:175], v[44:47], v[60:63], v[172:175]
v_mfma_f32_16x16x32_bf16 v[168:171], v[44:47], v[56:59], v[168:171]
s_waitcnt lgkmcnt(15)
v_mfma_f32_16x16x32_bf16 v[240:243], v[84:87], v[76:79], v[240:243]
v_mfma_f32_16x16x32_bf16 v[244:247], v[84:87], v[80:83], v[244:247]
v_mfma_f32_16x16x32_bf16 v[248:251], v[84:87], v[56:59], v[248:251]
v_mfma_f32_16x16x32_bf16 v[252:255], v[84:87], v[60:63], v[252:255]
s_waitcnt lgkmcnt(15)
v_mfma_f32_16x16x32_bf16 v[188:191], v[40:43], v[60:63], v[188:191]
v_mfma_f32_16x16x32_bf16 v[184:187], v[40:43], v[56:59], v[184:187]
s_waitcnt lgkmcnt(13)
v_mfma_f32_16x16x32_bf16 v[192:195], v[88:91], v[108:111], v[192:195]
s_waitcnt lgkmcnt(11)
v_mfma_f32_16x16x32_bf16 v[196:199], v[88:91], v[112:115], v[196:199]
s_waitcnt lgkmcnt(9)
v_mfma_f32_16x16x32_bf16 v[200:203], v[88:91], v[116:119], v[200:203]
s_waitcnt lgkmcnt(7)
v_mfma_f32_16x16x32_bf16 v[204:207], v[88:91], v[120:123], v[204:207]
s_waitcnt lgkmcnt(6)
v_mfma_f32_16x16x32_bf16 v[140:143], v[124:127], v[120:123], v[140:143]
v_mfma_f32_16x16x32_bf16 v[136:139], v[124:127], v[116:119], v[136:139]
s_waitcnt lgkmcnt(5)
v_mfma_f32_16x16x32_bf16 v[208:211], v[92:95], v[108:111], v[208:211]
v_mfma_f32_16x16x32_bf16 v[212:215], v[92:95], v[112:115], v[212:215]
s_barrier
v_mfma_f32_16x16x32_bf16 v[216:219], v[92:95], v[116:119], v[216:219]
ds_read_b128 v[72:75], v18 offset:16384
v_mfma_f32_16x16x32_bf16 v[220:223], v[92:95], v[120:123], v[220:223]
ds_read_b64_tr_b16 v[64:65], v34 offset:0
s_waitcnt lgkmcnt(6)
v_mfma_f32_16x16x32_bf16 v[156:159], v[96:99], v[120:123], v[156:159]
ds_read_b64_tr_b16 v[66:67], v34 offset:1024
v_mfma_f32_16x16x32_bf16 v[152:155], v[96:99], v[116:119], v[152:155]
ds_read_b64_tr_b16 v[68:69], v35 offset:0
s_waitcnt lgkmcnt(7)
v_mfma_f32_16x16x32_bf16 v[224:227], v[8:11], v[108:111], v[224:227]
ds_read_b64_tr_b16 v[70:71], v35 offset:1024
v_mfma_f32_16x16x32_bf16 v[228:231], v[8:11], v[112:115], v[228:231]
ds_read_b128 v[52:55], v18 offset:16640
v_mfma_f32_16x16x32_bf16 v[232:235], v[8:11], v[116:119], v[232:235]
ds_read_b128 v[48:51], v18 offset:16896
v_mfma_f32_16x16x32_bf16 v[236:239], v[8:11], v[120:123], v[236:239]
ds_read_b128 v[44:47], v18 offset:17152
s_waitcnt lgkmcnt(10)
v_mfma_f32_16x16x32_bf16 v[172:175], v[104:107], v[120:123], v[172:175]
ds_read_b128 v[76:79], v18 offset:24576
v_mfma_f32_16x16x32_bf16 v[168:171], v[104:107], v[116:119], v[168:171]
ds_read_b64_tr_b16 v[80:81], v34 offset:8192
s_waitcnt lgkmcnt(11)
v_mfma_f32_16x16x32_bf16 v[240:243], v[12:15], v[108:111], v[240:243]
ds_read_b64_tr_b16 v[82:83], v34 offset:9216
v_mfma_f32_16x16x32_bf16 v[244:247], v[12:15], v[112:115], v[244:247]
ds_read_b64_tr_b16 v[84:85], v35 offset:8192
v_mfma_f32_16x16x32_bf16 v[248:251], v[12:15], v[116:119], v[248:251]
ds_read_b64_tr_b16 v[86:87], v35 offset:9216
v_mfma_f32_16x16x32_bf16 v[252:255], v[12:15], v[120:123], v[252:255]
ds_read_b128 v[60:63], v18 offset:24832
s_waitcnt lgkmcnt(14)
v_mfma_f32_16x16x32_bf16 v[188:191], v[100:103], v[120:123], v[188:191]
ds_read_b128 v[40:43], v18 offset:25088
v_mfma_f32_16x16x32_bf16 v[184:187], v[100:103], v[116:119], v[184:187]
ds_read_b128 v[56:59], v18 offset:25344
s_waitcnt lgkmcnt(13)
v_mfma_f32_16x16x32_bf16 v[200:203], v[72:75], v[64:67], v[200:203]
ds_read_b64_tr_b16 v[88:89], v32 offset:0
s_waitcnt lgkmcnt(12)
v_mfma_f32_16x16x32_bf16 v[204:207], v[72:75], v[68:71], v[204:207]
ds_read_b64_tr_b16 v[90:91], v32 offset:1024
s_waitcnt lgkmcnt(12)
v_mfma_f32_16x16x32_bf16 v[220:223], v[52:55], v[68:71], v[220:223]
ds_read_b64_tr_b16 v[124:125], v33 offset:0
v_mfma_f32_16x16x32_bf16 v[216:219], v[52:55], v[64:67], v[216:219]
ds_read_b64_tr_b16 v[126:127], v33 offset:1024
s_waitcnt lgkmcnt(13)
v_mfma_f32_16x16x32_bf16 v[232:235], v[48:51], v[64:67], v[232:235]
ds_read_b64_tr_b16 v[92:93], v32 offset:8192
v_mfma_f32_16x16x32_bf16 v[236:239], v[48:51], v[68:71], v[236:239]
ds_read_b64_tr_b16 v[94:95], v32 offset:9216
s_waitcnt lgkmcnt(14)
v_mfma_f32_16x16x32_bf16 v[252:255], v[44:47], v[68:71], v[252:255]
ds_read_b64_tr_b16 v[96:97], v33 offset:8192
v_mfma_f32_16x16x32_bf16 v[248:251], v[44:47], v[64:67], v[248:251]
ds_read_b64_tr_b16 v[98:99], v33 offset:9216
s_waitcnt lgkmcnt(13)
v_mfma_f32_16x16x32_bf16 v[200:203], v[76:79], v[80:83], v[200:203]
ds_read_b128 v[8:11], v18 offset:0
s_waitcnt lgkmcnt(12)
v_mfma_f32_16x16x32_bf16 v[204:207], v[76:79], v[84:87], v[204:207]
ds_read_b128 v[104:107], v18 offset:256
s_waitcnt lgkmcnt(12)
v_mfma_f32_16x16x32_bf16 v[220:223], v[60:63], v[84:87], v[220:223]
ds_read_b128 v[108:111], v18 offset:512
v_mfma_f32_16x16x32_bf16 v[216:219], v[60:63], v[80:83], v[216:219]
ds_read_b128 v[112:115], v18 offset:768
s_waitcnt lgkmcnt(13)
v_mfma_f32_16x16x32_bf16 v[232:235], v[40:43], v[80:83], v[232:235]
ds_read_b128 v[12:15], v18 offset:8192
v_cvt_pk_f16_f32 v200, v200, v201
v_cvt_pk_f16_f32 v201, v202, v203
v_cvt_pk_f16_f32 v202, v204, v205
v_mfma_f32_16x16x32_bf16 v[236:239], v[40:43], v[84:87], v[236:239]
ds_read_b128 v[120:123], v18 offset:8448
v_cvt_pk_f16_f32 v203, v206, v207
buffer_store_dwordx4 v[200:203], v2, s[56:59], s98 offen offset:0 sc1
s_waitcnt lgkmcnt(14)
v_mfma_f32_16x16x32_bf16 v[252:255], v[56:59], v[84:87], v[252:255]
ds_read_b128 v[100:103], v18 offset:8704
v_cvt_pk_f16_f32 v216, v216, v217
v_cvt_pk_f16_f32 v217, v218, v219
v_cvt_pk_f16_f32 v218, v220, v221
v_mfma_f32_16x16x32_bf16 v[248:251], v[56:59], v[80:83], v[248:251]
ds_read_b128 v[116:119], v18 offset:8960
v_cvt_pk_f16_f32 v219, v222, v223
s_waitcnt lgkmcnt(14)
v_mfma_f32_16x16x32_bf16 v[192:195], v[72:75], v[88:91], v[192:195]
s_waitcnt lgkmcnt(12)
v_mfma_f32_16x16x32_bf16 v[196:199], v[72:75], v[124:127], v[196:199]
v_mfma_f32_16x16x32_bf16 v[212:215], v[52:55], v[124:127], v[212:215]
v_mfma_f32_16x16x32_bf16 v[208:211], v[52:55], v[88:91], v[208:211]
buffer_store_dwordx4 v[216:219], v2, s[56:59], s98 offen offset:1024 sc1
v_cvt_pk_f16_f32 v232, v232, v233
v_cvt_pk_f16_f32 v233, v234, v235
v_mfma_f32_16x16x32_bf16 v[224:227], v[48:51], v[88:91], v[224:227]
v_cvt_pk_f16_f32 v234, v236, v237
v_cvt_pk_f16_f32 v235, v238, v239
v_mfma_f32_16x16x32_bf16 v[228:231], v[48:51], v[124:127], v[228:231]
v_mfma_f32_16x16x32_bf16 v[244:247], v[44:47], v[124:127], v[244:247]
v_mfma_f32_16x16x32_bf16 v[240:243], v[44:47], v[88:91], v[240:243]
s_waitcnt lgkmcnt(10)
v_mfma_f32_16x16x32_bf16 v[192:195], v[76:79], v[92:95], v[192:195]
ds_read_b128 v[72:75], v16 offset:0
s_waitcnt lgkmcnt(9)
v_mfma_f32_16x16x32_bf16 v[196:199], v[76:79], v[96:99], v[196:199]
ds_read_b64_tr_b16 v[52:53], v20 offset:0
buffer_store_dwordx4 v[232:235], v2, s[56:59], s98 offen offset:2048 sc1
v_cvt_pk_f16_f32 v248, v248, v249
v_mfma_f32_16x16x32_bf16 v[212:215], v[60:63], v[96:99], v[212:215]
ds_read_b64_tr_b16 v[54:55], v20 offset:1024
v_cvt_pk_f16_f32 v249, v250, v251
v_cvt_pk_f16_f32 v250, v252, v253
v_cvt_pk_f16_f32 v251, v254, v255
v_mfma_f32_16x16x32_bf16 v[208:211], v[60:63], v[92:95], v[208:211]
ds_read_b64_tr_b16 v[48:49], v21 offset:0
v_mfma_f32_16x16x32_bf16 v[224:227], v[40:43], v[92:95], v[224:227]
ds_read_b64_tr_b16 v[50:51], v21 offset:1024
v_mfma_f32_16x16x32_bf16 v[228:231], v[40:43], v[96:99], v[228:231]
ds_read_b128 v[44:47], v16 offset:256
v_mfma_f32_16x16x32_bf16 v[244:247], v[56:59], v[96:99], v[244:247]
ds_read_b128 v[76:79], v16 offset:512
v_mfma_f32_16x16x32_bf16 v[240:243], v[56:59], v[92:95], v[240:243]
ds_read_b128 v[60:63], v16 offset:768
buffer_store_dwordx4 v[248:251], v2, s[56:59], s98 offen offset:3072 sc1
v_cvt_pk_f16_f32 v192, v192, v193
s_waitcnt lgkmcnt(15)
v_mfma_f32_16x16x32_bf16 v[136:139], v[8:11], v[64:67], v[136:139]
ds_read_b128 v[40:43], v16 offset:8192
v_cvt_pk_f16_f32 v193, v194, v195
v_cvt_pk_f16_f32 v194, v196, v197
v_cvt_pk_f16_f32 v195, v198, v199
v_mfma_f32_16x16x32_bf16 v[140:143], v[8:11], v[68:71], v[140:143]
ds_read_b64_tr_b16 v[56:57], v20 offset:8192
s_waitcnt lgkmcnt(15)
v_mfma_f32_16x16x32_bf16 v[156:159], v[104:107], v[68:71], v[156:159]
ds_read_b64_tr_b16 v[58:59], v20 offset:9216
v_mfma_f32_16x16x32_bf16 v[152:155], v[104:107], v[64:67], v[152:155]
s_waitcnt lgkmcnt(15)
v_mfma_f32_16x16x32_bf16 v[168:171], v[108:111], v[64:67], v[168:171]
v_mfma_f32_16x16x32_bf16 v[172:175], v[108:111], v[68:71], v[172:175]
buffer_store_dwordx4 v[192:195], v2, s[56:59], s97 offen offset:0 sc1
v_cvt_pk_f16_f32 v208, v208, v209
v_cvt_pk_f16_f32 v209, v210, v211
s_waitcnt lgkmcnt(15)
v_mfma_f32_16x16x32_bf16 v[188:191], v[112:115], v[68:71], v[188:191]
ds_read_b64_tr_b16 v[68:69], v21 offset:8192
v_cvt_pk_f16_f32 v210, v212, v213
v_cvt_pk_f16_f32 v211, v214, v215
v_mfma_f32_16x16x32_bf16 v[184:187], v[112:115], v[64:67], v[184:187]
ds_read_b64_tr_b16 v[70:71], v21 offset:9216
s_waitcnt lgkmcnt(15)
v_mfma_f32_16x16x32_bf16 v[136:139], v[12:15], v[80:83], v[136:139]
ds_read_b128 v[64:67], v16 offset:8448
v_mfma_f32_16x16x32_bf16 v[140:143], v[12:15], v[84:87], v[140:143]
s_waitcnt lgkmcnt(15)
v_mfma_f32_16x16x32_bf16 v[156:159], v[120:123], v[84:87], v[156:159]
v_mfma_f32_16x16x32_bf16 v[152:155], v[120:123], v[80:83], v[152:155]
buffer_store_dwordx4 v[208:211], v2, s[56:59], s97 offen offset:1024 sc1
v_cvt_pk_f16_f32 v224, v224, v225
v_cvt_pk_f16_f32 v225, v226, v227
s_waitcnt lgkmcnt(15)
v_mfma_f32_16x16x32_bf16 v[168:171], v[100:103], v[80:83], v[168:171]
v_cvt_pk_f16_f32 v226, v228, v229
v_cvt_pk_f16_f32 v227, v230, v231
v_mfma_f32_16x16x32_bf16 v[172:175], v[100:103], v[84:87], v[172:175]
s_waitcnt lgkmcnt(14)
v_mfma_f32_16x16x32_bf16 v[188:191], v[116:119], v[84:87], v[188:191]
ds_read_b128 v[84:87], v16 offset:8704
v_mfma_f32_16x16x32_bf16 v[184:187], v[116:119], v[80:83], v[184:187]
ds_read_b128 v[80:83], v16 offset:8960
v_mfma_f32_16x16x32_bf16 v[128:131], v[8:11], v[88:91], v[128:131]
v_mfma_f32_16x16x32_bf16 v[132:135], v[8:11], v[124:127], v[132:135]
ds_read_b128 v[8:11], v17 offset:0
buffer_store_dwordx4 v[224:227], v2, s[56:59], s97 offen offset:2048 sc1
v_cvt_pk_f16_f32 v240, v240, v241
v_mfma_f32_16x16x32_bf16 v[148:151], v[104:107], v[124:127], v[148:151]
v_cvt_pk_f16_f32 v241, v242, v243
v_cvt_pk_f16_f32 v242, v244, v245
v_cvt_pk_f16_f32 v243, v246, v247
v_mfma_f32_16x16x32_bf16 v[144:147], v[104:107], v[88:91], v[144:147]
ds_read_b64_tr_b16 v[104:105], v24 offset:0
v_mfma_f32_16x16x32_bf16 v[160:163], v[108:111], v[88:91], v[160:163]
ds_read_b64_tr_b16 v[106:107], v24 offset:1024
v_mfma_f32_16x16x32_bf16 v[164:167], v[108:111], v[124:127], v[164:167]
ds_read_b64_tr_b16 v[108:109], v25 offset:0
v_mfma_f32_16x16x32_bf16 v[180:183], v[112:115], v[124:127], v[180:183]
ds_read_b64_tr_b16 v[110:111], v25 offset:1024
v_mfma_f32_16x16x32_bf16 v[176:179], v[112:115], v[88:91], v[176:179]
ds_read_b128 v[124:127], v17 offset:256
buffer_store_dwordx4 v[240:243], v2, s[56:59], s97 offen offset:3072 sc1
v_cvt_pk_f16_f32 v136, v136, v137
v_mfma_f32_16x16x32_bf16 v[128:131], v[12:15], v[92:95], v[128:131]
ds_read_b128 v[112:115], v17 offset:512
v_cvt_pk_f16_f32 v137, v138, v139
v_cvt_pk_f16_f32 v138, v140, v141
v_cvt_pk_f16_f32 v139, v142, v143
v_mfma_f32_16x16x32_bf16 v[132:135], v[12:15], v[96:99], v[132:135]
ds_read_b128 v[88:91], v17 offset:768
v_mfma_f32_16x16x32_bf16 v[148:151], v[120:123], v[96:99], v[148:151]
ds_read_b128 v[12:15], v17 offset:8192
v_mfma_f32_16x16x32_bf16 v[144:147], v[120:123], v[92:95], v[144:147]
ds_read_b64_tr_b16 v[120:121], v24 offset:8192
v_mfma_f32_16x16x32_bf16 v[160:163], v[100:103], v[92:95], v[160:163]
ds_read_b64_tr_b16 v[122:123], v24 offset:9216
v_mfma_f32_16x16x32_bf16 v[164:167], v[100:103], v[96:99], v[164:167]
ds_read_b64_tr_b16 v[100:101], v25 offset:8192
buffer_store_dwordx4 v[136:139], v2, s[56:59], s96 offen offset:0 sc1
v_cvt_pk_f16_f32 v152, v152, v153
v_mfma_f32_16x16x32_bf16 v[180:183], v[116:119], v[96:99], v[180:183]
ds_read_b64_tr_b16 v[102:103], v25 offset:9216
v_cvt_pk_f16_f32 v153, v154, v155
v_cvt_pk_f16_f32 v154, v156, v157
v_cvt_pk_f16_f32 v155, v158, v159
v_mfma_f32_16x16x32_bf16 v[176:179], v[116:119], v[92:95], v[176:179]
ds_read_b128 v[96:99], v17 offset:8448
s_waitcnt lgkmcnt(15)
v_mfma_f32_16x16x32_bf16 v[128:131], v[72:75], v[52:55], v[128:131]
ds_read_b128 v[116:119], v17 offset:8704
s_waitcnt lgkmcnt(15)
v_mfma_f32_16x16x32_bf16 v[132:135], v[72:75], v[48:51], v[132:135]
ds_read_b128 v[92:95], v17 offset:8960
s_waitcnt lgkmcnt(15)
v_mfma_f32_16x16x32_bf16 v[148:151], v[44:47], v[48:51], v[148:151]
v_mfma_f32_16x16x32_bf16 v[144:147], v[44:47], v[52:55], v[144:147]
buffer_store_dwordx4 v[152:155], v2, s[56:59], s96 offen offset:1024 sc1
v_cvt_pk_f16_f32 v168, v168, v169
v_cvt_pk_f16_f32 v169, v170, v171
s_waitcnt lgkmcnt(15)
v_mfma_f32_16x16x32_bf16 v[160:163], v[76:79], v[52:55], v[160:163]
v_cvt_pk_f16_f32 v170, v172, v173
v_cvt_pk_f16_f32 v171, v174, v175
v_mfma_f32_16x16x32_bf16 v[164:167], v[76:79], v[48:51], v[164:167]
s_waitcnt lgkmcnt(15)
v_mfma_f32_16x16x32_bf16 v[180:183], v[60:63], v[48:51], v[180:183]
s_waitcnt lgkmcnt(0)
s_barrier
v_mfma_f32_16x16x32_bf16 v[176:179], v[60:63], v[52:55], v[176:179]
v_mfma_f32_16x16x32_bf16 v[128:131], v[40:43], v[56:59], v[128:131]
v_mfma_f32_16x16x32_bf16 v[132:135], v[40:43], v[68:71], v[132:135]
buffer_store_dwordx4 v[168:171], v2, s[56:59], s96 offen offset:2048 sc1
v_cvt_pk_f16_f32 v184, v184, v185
v_cvt_pk_f16_f32 v185, v186, v187
v_mfma_f32_16x16x32_bf16 v[148:151], v[64:67], v[68:71], v[148:151]
v_cvt_pk_f16_f32 v186, v188, v189
v_cvt_pk_f16_f32 v187, v190, v191
v_mfma_f32_16x16x32_bf16 v[144:147], v[64:67], v[56:59], v[144:147]
v_mfma_f32_16x16x32_bf16 v[160:163], v[84:87], v[56:59], v[160:163]
v_mfma_f32_16x16x32_bf16 v[164:167], v[84:87], v[68:71], v[164:167]
v_mfma_f32_16x16x32_bf16 v[180:183], v[80:83], v[68:71], v[180:183]
v_mfma_f32_16x16x32_bf16 v[176:179], v[80:83], v[56:59], v[176:179]
buffer_store_dwordx4 v[184:187], v2, s[56:59], s96 offen offset:3072 sc1
v_mfma_f32_16x16x32_bf16 v[128:131], v[8:11], v[104:107], v[128:131]
v_mfma_f32_16x16x32_bf16 v[132:135], v[8:11], v[108:111], v[132:135]
v_mfma_f32_16x16x32_bf16 v[148:151], v[124:127], v[108:111], v[148:151]
v_mfma_f32_16x16x32_bf16 v[144:147], v[124:127], v[104:107], v[144:147]
v_mfma_f32_16x16x32_bf16 v[160:163], v[112:115], v[104:107], v[160:163]
v_mfma_f32_16x16x32_bf16 v[164:167], v[112:115], v[108:111], v[164:167]
v_mfma_f32_16x16x32_bf16 v[180:183], v[88:91], v[108:111], v[180:183]
v_mfma_f32_16x16x32_bf16 v[176:179], v[88:91], v[104:107], v[176:179]
v_mfma_f32_16x16x32_bf16 v[128:131], v[12:15], v[120:123], v[128:131]
v_mfma_f32_16x16x32_bf16 v[132:135], v[12:15], v[100:103], v[132:135]
v_mfma_f32_16x16x32_bf16 v[148:151], v[96:99], v[100:103], v[148:151]
v_mfma_f32_16x16x32_bf16 v[144:147], v[96:99], v[120:123], v[144:147]
v_mfma_f32_16x16x32_bf16 v[160:163], v[116:119], v[120:123], v[160:163]
v_mfma_f32_16x16x32_bf16 v[164:167], v[116:119], v[100:103], v[164:167]
v_mfma_f32_16x16x32_bf16 v[180:183], v[92:95], v[100:103], v[180:183]
v_mfma_f32_16x16x32_bf16 v[176:179], v[92:95], v[120:123], v[176:179]
s_nop 7
s_nop 3
ds_write_b128 v4, v[128:131] offset:0
ds_write_b128 v4, v[144:147] offset:32
ds_write_b128 v4, v[160:163] offset:64
ds_write_b128 v4, v[176:179] offset:96
ds_write_b128 v4, v[132:135] offset:4352
ds_write_b128 v4, v[148:151] offset:4384
ds_write_b128 v4, v[164:167] offset:4416
ds_write_b128 v4, v[180:183] offset:4448
s_waitcnt lgkmcnt(0)
s_barrier
s_waitcnt vmcnt(8)
s_mov_b64 exec, 4
buffer_store_dword v3, v36, s[60:63], s78 offen sc1
s_waitcnt vmcnt(5)
s_mov_b64 exec, 2
buffer_store_dword v3, v36, s[60:63], s78 offen sc1
s_waitcnt vmcnt(2)
s_mov_b64 exec, 1
buffer_store_dword v3, v36, s[60:63], s78 offen sc1
s_mov_b64 exec, -1
L_end:
s_endpgm
.section .rodata,"a"
.p2align 6
.amdhsa_kernel parallel_sum__ssm_conv_s5__mixer_token_mlp__prompt_kernel
  .amdhsa_next_free_vgpr 256
  .amdhsa_next_free_sgpr 102
  .amdhsa_accum_offset 256
  .amdhsa_group_segment_fixed_size 0
  .amdhsa_kernarg_size 136
  .amdhsa_user_sgpr_count 2
  .amdhsa_user_sgpr_kernarg_segment_ptr 1
  .amdhsa_system_sgpr_workgroup_id_x 1
  .amdhsa_float_denorm_mode_32 3
.end_amdhsa_kernel
```
